```python
import torch

def _softmax(x, axis=-1):
    return torch.softmax(x, dim=axis)

def _gelu(x):
    return torch.nn.functional.gelu(x, approximate='tanh')

def _silu(x):
    return torch.nn.functional.silu(x)

def _sigmoid(x):
    return torch.sigmoid(x)

def _layernorm(x, axis=-1, eps=1e-05):
    m = x.mean(dim=axis, keepdim=True)
    v = x.var(dim=axis, keepdim=True, unbiased=False)
    return (x - m) / torch.sqrt(v + eps)

def _scatter_add(tgt, idx, src, axis=0):
    return tgt.clone().index_add_(axis, idx, src)

def _segment_sum(src, seg, n):
    out = torch.zeros((n,) + src.shape[1:], dtype=src.dtype)
    return out.index_add_(0, seg, src)

def _pad(x, pw):
    flat = tuple((v for pair in reversed(pw) for v in pair))
    return torch.nn.functional.pad(x, flat)
kernel_name = 'sequential_preLN__mha_block__mixer_gmlp__prompt'

def setup_inputs():

    _w = lambda a: (lambda t: t.to(torch.bfloat16) if t.is_floating_point() else t)(torch.as_tensor(a))

    def _A_setup():
        B, S, D, H = (1, 2048, 448, 16)
        return {'x': _w((lambda *s: torch.randn(*s, dtype=torch.bfloat16) * 0.05)(B, S, D)), 'wqkv': _w((lambda *s: torch.randn(*s, dtype=torch.bfloat16) * 0.05)(D, 3 * D)), 'wo': _w((lambda *s: torch.randn(*s, dtype=torch.bfloat16) * 0.05)(D, D))}
    _A_in = _A_setup()

    def _B_setup():
        B, S, D, F = (1, 2048, 448, 1792)
        Fh = F // 2
        return {'x': _w((lambda *s: torch.randn(*s, dtype=torch.bfloat16) * 0.05)(B, S, D)), 'w_in': _w((lambda *s: torch.randn(*s, dtype=torch.bfloat16) * 0.4)(D, 2 * Fh)), 'w_sp': _w(0.01 * (lambda *s: torch.randn(*s, dtype=torch.bfloat16) * 0.4)(S, S)), 'b_sp': _w(1.0 + 0.01 * (lambda *s: torch.randn(*s, dtype=torch.bfloat16) * 0.05)(S)), 'w_out': _w((lambda *s: torch.randn(*s, dtype=torch.bfloat16) * 0.05)(Fh, D))}
    _B_in = _B_setup()
    return {'A_x': _A_in['x'], 'A_wqkv': _A_in['wqkv'], 'A_wo': _A_in['wo'], 'B_x': _B_in['x'], 'B_w_in': _B_in['w_in'], 'B_w_sp': _B_in['w_sp'], 'B_b_sp': _B_in['b_sp'], 'B_w_out': _B_in['w_out']}

def reference(A_x, A_wqkv, A_wo, B_x, B_w_in, B_w_sp, B_b_sp, B_w_out):

    def _A_ref(x, wqkv, wo):
        B, S, D = x.shape
        H = 16
        Dh = D // H
        qkv = (lambda x, *d: x.permute(*d))((x @ wqkv).reshape(B, S, 3, H, Dh), 2, 0, 3, 1, 4)
        q, k, v = (qkv[0], qkv[1], qkv[2])
        scores = torch.einsum('bhqd,bhkd->bhqk', q, k) * Dh ** (-0.5)
        p = _softmax(scores, axis=-1)
        o = torch.einsum('bhqk,bhkd->bhqd', p, v)
        return (lambda x, *d: x.permute(*d))(o, 0, 2, 1, 3).reshape(B, S, D) @ wo

    def _B_ref(x, w_in, w_sp, b_sp, w_out):
        B, S, D = x.shape
        F = w_in.shape[-1]
        Fh = F // 2
        z = _gelu(torch.einsum('bsd,df->bsf', x, w_in))
        z1 = z[..., :Fh].clone()
        z2 = _layernorm(z[..., Fh:], axis=-1)
        g = torch.einsum('ts,bsf->btf', w_sp, z2) + b_sp[None, :, None]
        return torch.einsum('bsf,fd->bsd', z1 * g, w_out)
    x = A_x
    h = x + _A_ref(_layernorm(x, axis=-1), A_wqkv, A_wo)
    h2 = h + _B_ref(_layernorm(h, axis=-1), B_w_in, B_w_sp, B_b_sp, B_w_out)
    return h2
```

```asm
; @launch grid=(256,1,1) block=(256,1,1) lds=163840
.amdgcn_target "amdgcn-amd-amdhsa--gfx950"
.text
.globl sequential_preLN__mha_block__mixer_gmlp__prompt_kernel
.p2align 8
.type sequential_preLN__mha_block__mixer_gmlp__prompt_kernel,@function
sequential_preLN__mha_block__mixer_gmlp__prompt_kernel:
    s_cmp_ge_u32 s2, 256
    s_cbranch_scc1 L_end
    s_load_dwordx16 s[4:19], s[0:1], 0
    s_load_dwordx4 s[20:23], s[0:1], 64
    s_load_dwordx2 s[24:25], s[0:1], 80
    v_lshrrev_b32 v1, 6, v0
    v_and_b32 v0, 63, v0
    v_readfirstlane_b32 s26, v1
    s_mov_b32 s76, s2
    s_and_b32 s62, s2, 7
    s_lshl_b32 s62, s62, 1
    s_lshr_b32 s63, s2, 7
    s_add_u32 s27, s62, s63
    s_bfe_u32 s44, s2, 0x40003
    s_lshr_b32 s55, s44, 1
    s_mul_i32 s63, s63, 3
    s_add_u32 s63, s63, s55
    s_and_b32 s62, s2, 7
    s_mul_i32 s62, s62, 2
    s_add_u32 s63, s63, s62
    s_mul_i32 s62, s63, 37
    s_lshr_b32 s62, s62, 8
    s_mul_i32 s62, s62, 7
    s_sub_u32 s49, s63, s62
    s_lshl_b32 s54, s27, 2
    s_add_u32 s54, s54, s26
    s_mul_i32 s64, s54, 28672
    v_lshrrev_b32 v7, 3, v0
    v_mul_u32_u24 v7, 896, v7
    v_lshrrev_b32 v8, 4, v0
    v_xor_b32 v8, v8, v0
    v_and_b32 v8, 7, v8
    v_lshl_add_u32 v7, v8, 4, v7
    v_xor_b32 v8, 64, v7
    v_add_u32 v188, s64, v7
    v_add_u32 v8, s64, v8
    v_add_u32 v189, 6144, v8
    v_add_u32 v190, 12288, v188
    v_add_u32 v191, 18432, v8
    v_lshrrev_b32 v7, 3, v0
    v_mul_u32_u24 v7, 2688, v7
    v_bfe_u32 v8, v0, 4, 1
    v_lshlrev_b32 v8, 2, v8
    v_xor_b32 v8, v8, v0
    v_and_b32 v8, 7, v8
    v_lshl_add_u32 v7, v8, 4, v7
    s_mul_i32 s62, s26, 43008
    s_lshl_b32 s63, s44, 7
    s_add_u32 s62, s62, s63
    s_add_u32 s62, s62, 896
    s_lshl_b32 s65, s26, 11
    v_add_u32 v196, s62, v7
    v_add_u32 v197, 20480, v196
    s_mul_i32 s66, s26, 12288
    s_add_u32 s66, s66, 57344
    s_mov_b32 s34, 0x1c0000
    s_mov_b32 s35, 0x20000
    s_mov_b32 s38, 0x126000
    s_mov_b32 s39, 0x20000
    s_mov_b32 s67, s49
    s_waitcnt lgkmcnt(0)
    s_mov_b32 s32, s4
    s_mov_b32 s33, s5
    s_mov_b32 s36, s6
    s_mov_b32 s37, s7
    s_mov_b32 s40, s22
    s_mov_b32 s41, s23
    s_mov_b32 s42, 0x100
    s_mov_b32 s43, 0x20000
    s_or_b32 s62, s76, s26
    s_cbranch_scc1 L_non_1
    s_memrealtime s[68:69]
    s_waitcnt lgkmcnt(0)
    s_lshl_b64 s[68:69], s[68:69], 4
    s_or_b32 s69, s69, 0x80000000
    v_mov_b32 v8, s68
    v_mov_b32 v9, s69
    v_lshlrev_b32 v7, 3, v0
    s_mov_b64 exec, 255
    buffer_store_dwordx2 v[8:9], v7, s[40:43], 0 offen sc1
    s_mov_b64 exec, -1
L_non_1:
    s_add_u32 m0, s65, 0
    s_mul_i32 s62, s67, 172032
    buffer_load_dwordx4 v196, s[36:39], s62 offen offset:0 lds
    buffer_load_dwordx4 v197, s[36:39], s62 offen offset:1024 lds
    s_add_u32 m0, s66, 0
    s_lshl_b32 s62, s67, 7
    buffer_load_dwordx4 v188, s[32:35], s62 offen offset:0 lds
    buffer_load_dwordx4 v189, s[32:35], s62 offen offset:1024 lds
    buffer_load_dwordx4 v190, s[32:35], s62 offen offset:2048 lds
    buffer_load_dwordx4 v191, s[32:35], s62 offen offset:3072 lds
    s_add_u32 s67, s67, 1
    s_cmp_eq_u32 s67, 7
    s_cselect_b32 s67, 0, s67
    s_add_u32 m0, s65, 8192
    s_mul_i32 s62, s67, 172032
    buffer_load_dwordx4 v196, s[36:39], s62 offen offset:0 lds
    buffer_load_dwordx4 v197, s[36:39], s62 offen offset:1024 lds
    s_add_u32 m0, s66, 4096
    s_lshl_b32 s62, s67, 7
    buffer_load_dwordx4 v188, s[32:35], s62 offen offset:0 lds
    buffer_load_dwordx4 v189, s[32:35], s62 offen offset:1024 lds
    buffer_load_dwordx4 v190, s[32:35], s62 offen offset:2048 lds
    buffer_load_dwordx4 v191, s[32:35], s62 offen offset:3072 lds
    s_add_u32 s67, s67, 1
    s_cmp_eq_u32 s67, 7
    s_cselect_b32 s67, 0, s67
    s_mov_b32 s28, s24
    s_mov_b32 s29, s25
    s_mov_b32 s30, 0x1280000
    s_mov_b32 s31, 0x20000
    s_getpc_b64 s[84:85]
L_pc_2:
    s_sub_u32 s84, s84, L_pc_2-sequential_preLN__mha_block__mixer_gmlp__prompt_kernel
    s_subb_u32 s85, s85, 0
    s_mov_b32 s86, L_code_end-sequential_preLN__mha_block__mixer_gmlp__prompt_kernel
    s_mov_b32 s87, 0x20000
    s_lshr_b32 s62, s76, 3
    s_lshl_b32 s62, s62, 2
    s_add_u32 s62, s62, s26
    s_lshl_b32 s62, s62, 9
    v_lshlrev_b32 v7, 3, v0
    buffer_load_dwordx2 a[250:251], v7, s[84:87], s62 offen offset:0
    s_getreg_b32 s45, hwreg(HW_REG_XCC_ID, 0, 4)
    s_mov_b32 s50, 0
    s_mov_b32 s51, -1
    s_mov_b32 s52, 0x3f803f80
    s_mov_b32 s58, 0xc0135761
    s_mov_b32 s60, 0xbdd2d3e8
    s_mov_b32 s61, 0xbdd2d3e8
    s_lshl_b32 s77, s27, 4
    s_add_u32 s77, s77, s44
    s_lshl_b32 s77, s77, 3
    s_and_b32 s63, s44, 1
    s_lshl_b32 s63, s63, 1
    s_lshr_b32 s56, s26, 1
    s_lshl_b32 s57, s27, 2
    s_add_u32 s57, s57, s63
    s_and_b32 s62, s26, 1
    s_add_u32 s57, s57, s62
    v_lshrrev_b32 v1, 5, v0
    v_and_b32 v2, 31, v0
    v_lshlrev_b32 v3, 4, v0
    v_bfe_u32 v7, v0, 2, 2
    v_lshl_add_u32 v8, v1, 3, v7
    v_lshlrev_b32 v4, 7, v8
    v_bfe_u32 v8, v0, 4, 1
    v_and_b32 v9, 1, v0
    v_lshl_add_u32 v8, v8, 1, v9
    v_bfe_u32 v9, v0, 3, 1
    v_lshlrev_b32 v9, 2, v9
    v_xor_b32 v9, v9, v8
    v_lshl_add_u32 v4, v9, 4, v4
    v_bfe_u32 v9, v0, 1, 1
    v_lshl_add_u32 v4, v9, 3, v4
    v_xor_b32 v5, 64, v4
    v_and_b32 v6, 0x13, v2
    v_bfe_u32 v7, v0, 2, 1
    v_lshl_or_b32 v6, v7, 3, v6
    v_bfe_u32 v8, v0, 3, 1
    v_lshl_or_b32 v6, v8, 2, v6
    v_bfe_u32 v8, v0, 4, 1
    v_cmp_eq_u32 vcc, v7, v8
    v_mov_b32 v8, s52
    s_nop 0
    v_cndmask_b32 v8, 0, v8, vcc
    v_accvgpr_write_b32 a252, v8
    v_accvgpr_write_b32 a253, v8
    v_accvgpr_write_b32 a254, v8
    v_accvgpr_write_b32 a255, v8
    s_lshl_b32 s63, s26, 5
    v_bfe_u32 v8, v2, 1, 3
    v_xor_b32 v8, v8, v1
    v_lshlrev_b32 v8, 4, v8
    v_lshl_add_u32 v8, v2, 7, v8
    v_xor_b32 v8, s63, v8
    v_xor_b32 v192, 0, v8
    v_add_u32 v192, s66, v192
    v_xor_b32 v193, 32, v8
    v_add_u32 v193, s66, v193
    v_xor_b32 v194, 64, v8
    v_add_u32 v194, s66, v194
    v_xor_b32 v195, 96, v8
    v_add_u32 v195, s66, v195
    s_xor_b32 s62, s65, 0
    v_or_b32 v198, s62, v4
    v_or_b32 v199, s62, v5
    s_xor_b32 s62, s65, 2048
    v_or_b32 v200, s62, v4
    v_or_b32 v201, s62, v5
    s_xor_b32 s62, s65, 4096
    v_or_b32 v202, s62, v4
    v_or_b32 v203, s62, v5
    s_xor_b32 s62, s65, 6144
    v_or_b32 v204, s62, v4
    v_or_b32 v205, s62, v5
    s_mul_i32 s62, s44, 56
    s_and_b32 s63, s44, 1
    s_lshl_b32 s63, s63, 3
    s_sub_u32 s62, s62, s63
    v_lshrrev_b32 v7, 2, v0
    v_mul_u32_u24 v7, 2688, v7
    v_and_b32 v8, 3, v0
    v_lshl_add_u32 v206, v8, 4, v7
    s_mul_i32 s63, s26, 43008
    s_add_u32 s62, s62, s63
    v_add_u32 v206, s62, v206
    s_lshl_b32 s82, s26, 10
    s_cmp_ge_u32 s44, 14
    s_cbranch_scc1 L_p1_N
    s_cmp_ge_u32 s44, 7
    s_cbranch_scc1 L_p1_V
    s_branch L_pg0
    .p2align 12
L_stub0:
    s_setpc_b64 s[70:71]
L_pg0:
L_p1_K:
    s_lshl_b32 s62, s44, 3
    v_add_u32 v7, s62, v1
    s_mov_b32 s63, 225792
    s_mul_i32 s64, s54, 3584
    s_add_u32 s64, s64, 2097152
    v_add_u32 v8, 0, v7
    v_mul_u32_u24 v9, 37, v8
    v_lshrrev_b32 v9, 8, v9
    v_mul_lo_u32 v9, v9, s63
    v_lshl_add_u32 v9, v8, 9, v9
    v_lshl_add_u32 v210, v2, 4, v9
    v_add_u32 v8, 2, v7
    v_mul_u32_u24 v9, 37, v8
    v_lshrrev_b32 v9, 8, v9
    v_mul_lo_u32 v9, v9, s63
    v_lshl_add_u32 v9, v8, 9, v9
    v_lshl_add_u32 v211, v2, 4, v9
    v_add_u32 v8, 4, v7
    v_mul_u32_u24 v9, 37, v8
    v_lshrrev_b32 v9, 8, v9
    v_mul_lo_u32 v9, v9, s63
    v_lshl_add_u32 v9, v8, 9, v9
    v_lshl_add_u32 v212, v2, 4, v9
    v_add_u32 v8, 6, v7
    v_mul_u32_u24 v9, 37, v8
    v_lshrrev_b32 v9, 8, v9
    v_mul_lo_u32 v9, v9, s63
    v_lshl_add_u32 v9, v8, 9, v9
    v_lshl_add_u32 v213, v2, 4, v9
    s_lshl_b32 s88, s54, 13
    s_add_u32 s88, s88, 18874368
    s_lshl_b32 s68, s44, 9
    s_add_u32 s89, s88, s68
    s_and_b32 s68, s68, 512
    s_add_u32 s88, s88, s68
    v_lshlrev_b32 v218, 4, v2
    v_lshl_add_u32 v222, v1, 12, v218
    v_mul_u32_u24 v223, 3072, v1
    v_add_u32 v223, v223, v218
    s_waitcnt vmcnt(7)
    s_barrier
    ds_read_b128 v[16:19], v192 offset:0
    ds_read_b128 v[20:23], v193 offset:0
    ds_read_b128 v[24:27], v194 offset:0
    ds_read_b128 v[28:31], v195 offset:0
    ds_read_b64_tr_b16 a[0:1], v198 offset:0
    ds_read_b64_tr_b16 a[2:3], v198 offset:512
    s_add_u32 m0, s65, 16384
    s_mul_i32 s62, s67, 172032
    buffer_load_dwordx4 v196, s[36:39], s62 offen offset:0 lds
    ds_read_b64_tr_b16 a[4:5], v199 offset:0
    ds_read_b64_tr_b16 a[6:7], v199 offset:512
    buffer_load_dwordx4 v197, s[36:39], s62 offen offset:1024 lds
    ds_read_b64_tr_b16 a[8:9], v200 offset:0
    ds_read_b64_tr_b16 a[10:11], v200 offset:512
    s_add_u32 m0, s66, 8192
    s_lshl_b32 s62, s67, 7
    buffer_load_dwordx4 v188, s[32:35], s62 offen offset:0 lds
    ds_read_b64_tr_b16 a[12:13], v201 offset:0
    ds_read_b64_tr_b16 a[14:15], v201 offset:512
    buffer_load_dwordx4 v189, s[32:35], s62 offen offset:1024 lds
    ds_read_b64_tr_b16 a[16:17], v202 offset:0
    ds_read_b64_tr_b16 a[18:19], v202 offset:512
    buffer_load_dwordx4 v190, s[32:35], s62 offen offset:2048 lds
    ds_read_b64_tr_b16 a[20:21], v203 offset:0
    ds_read_b64_tr_b16 a[22:23], v203 offset:512
    buffer_load_dwordx4 v191, s[32:35], s62 offen offset:3072 lds
    ds_read_b64_tr_b16 a[24:25], v204 offset:0
    ds_read_b64_tr_b16 a[26:27], v204 offset:512
    s_add_u32 s67, s67, 1
    s_cmp_eq_u32 s67, 7
    s_cselect_b32 s67, 0, s67
    ds_read_b64_tr_b16 a[28:29], v205 offset:0
    ds_read_b64_tr_b16 a[30:31], v205 offset:512
    s_waitcnt lgkmcnt(15)
    v_mfma_f32_32x32x16_bf16 v[160:175], v[16:19], v[16:19], 0
    s_waitcnt lgkmcnt(12)
    v_mfma_f32_32x32x16_bf16 v[128:143], a[0:3], v[16:19], 0
    s_waitcnt vmcnt(7)
    s_barrier
    ds_read_b128 v[32:35], v192 offset:4096
    v_mfma_f32_32x32x16_bf16 v[144:159], a[4:7], v[16:19], 0
    ds_read_b128 v[36:39], v193 offset:4096
    ds_read_b128 v[40:43], v194 offset:4096
    v_mfma_f32_16x16x32_bf16 v[176:179], a[252:255], v[16:19], 0
    ds_read_b128 v[44:47], v195 offset:4096
    ds_read_b64_tr_b16 a[32:33], v198 offset:8192
    ds_read_b64_tr_b16 a[34:35], v198 offset:8704
    v_mfma_f32_16x16x32_bf16 v[180:183], a[252:255], a[0:3], 0
    v_mov_b32 v208, 0
    buffer_load_dwordx2 v[208:209], v208, s[40:43], 0 offen offset:0 sc1
    ds_read_b64_tr_b16 a[36:37], v199 offset:8192
    ds_read_b64_tr_b16 a[38:39], v199 offset:8704
    v_mfma_f32_16x16x32_bf16 v[184:187], a[252:255], a[4:7], 0
    s_add_u32 m0, s65, 24576
    s_mul_i32 s62, s67, 172032
    buffer_load_dwordx4 v196, s[36:39], s62 offen offset:0 lds
    ds_read_b64_tr_b16 a[40:41], v200 offset:8192
    ds_read_b64_tr_b16 a[42:43], v200 offset:8704
    v_mfma_f32_32x32x16_bf16 v[160:175], v[20:23], v[20:23], v[160:175]
    buffer_load_dwordx4 v197, s[36:39], s62 offen offset:1024 lds
    ds_read_b64_tr_b16 a[44:45], v201 offset:8192
    ds_read_b64_tr_b16 a[46:47], v201 offset:8704
    s_waitcnt lgkmcnt(15)
    v_mfma_f32_32x32x16_bf16 v[128:143], a[8:11], v[20:23], v[128:143]
    s_add_u32 m0, s66, 0
    s_lshl_b32 s62, s67, 7
    buffer_load_dwordx4 v188, s[32:35], s62 offen offset:0 lds
    ds_read_b64_tr_b16 a[48:49], v202 offset:8192
    ds_read_b64_tr_b16 a[50:51], v202 offset:8704
    v_mfma_f32_32x32x16_bf16 v[144:159], a[12:15], v[20:23], v[144:159]
    buffer_load_dwordx4 v189, s[32:35], s62 offen offset:1024 lds
    ds_read_b64_tr_b16 a[52:53], v203 offset:8192
    ds_read_b64_tr_b16 a[54:55], v203 offset:8704
    v_mfma_f32_16x16x32_bf16 v[176:179], a[252:255], v[20:23], v[176:179]
    buffer_load_dwordx4 v190, s[32:35], s62 offen offset:2048 lds
    ds_read_b64_tr_b16 a[56:57], v204 offset:8192
    ds_read_b64_tr_b16 a[58:59], v204 offset:8704
    v_mfma_f32_32x32x16_bf16 v[160:175], v[24:27], v[24:27], v[160:175]
    buffer_load_dwordx4 v191, s[32:35], s62 offen offset:3072 lds
    ds_read_b64_tr_b16 a[60:61], v205 offset:8192
    ds_read_b64_tr_b16 a[62:63], v205 offset:8704
    v_mfma_f32_32x32x16_bf16 v[128:143], a[16:19], v[24:27], v[128:143]
    s_add_u32 s67, s67, 1
    s_cmp_eq_u32 s67, 7
    s_cselect_b32 s67, 0, s67
    v_mfma_f32_32x32x16_bf16 v[144:159], a[20:23], v[24:27], v[144:159]
    v_mfma_f32_16x16x32_bf16 v[176:179], a[252:255], v[24:27], v[176:179]
    v_mfma_f32_32x32x16_bf16 v[160:175], v[28:31], v[28:31], v[160:175]
    s_waitcnt lgkmcnt(15)
    v_mfma_f32_32x32x16_bf16 v[128:143], a[24:27], v[28:31], v[128:143]
    v_mfma_f32_32x32x16_bf16 v[144:159], a[28:31], v[28:31], v[144:159]
    v_mfma_f32_16x16x32_bf16 v[176:179], a[252:255], v[28:31], v[176:179]
    s_waitcnt lgkmcnt(12)
    v_mfma_f32_32x32x16_bf16 v[128:143], a[32:35], v[32:35], v[128:143]
    v_mfma_f32_32x32x16_bf16 v[144:159], a[36:39], v[32:35], v[144:159]
    s_waitcnt vmcnt(7)
    s_barrier
    ds_read_b128 v[48:51], v192 offset:8192
    ds_read_b128 v[52:55], v193 offset:8192
    s_mov_b32 vcc_lo, 0xaaaaaaaa
    s_mov_b32 vcc_hi, 0xaaaaaaaa
    v_mfma_f32_16x16x32_bf16 v[180:183], a[252:255], a[32:35], v[180:183]
    ds_read_b128 v[56:59], v194 offset:8192
    ds_read_b128 v[60:63], v195 offset:8192
    ds_read_b64_tr_b16 a[0:1], v198 offset:16384
    ds_read_b64_tr_b16 a[2:3], v198 offset:16896
    v_cndmask_b32 v160, v160, v161, vcc
    v_cndmask_b32 v161, v162, v163, vcc
    v_mfma_f32_16x16x32_bf16 v[184:187], a[252:255], a[36:39], v[184:187]
    s_add_u32 m0, s65, 32768
    s_mul_i32 s62, s67, 172032
    buffer_load_dwordx4 v196, s[36:39], s62 offen offset:0 lds
    ds_read_b64_tr_b16 a[4:5], v199 offset:16384
    ds_read_b64_tr_b16 a[6:7], v199 offset:16896
    buffer_load_dwordx4 v197, s[36:39], s62 offen offset:1024 lds
    v_cndmask_b32 v162, v164, v165, vcc
    v_cndmask_b32 v163, v166, v167, vcc
    s_waitcnt lgkmcnt(15)
    v_mfma_f32_32x32x16_bf16 v[128:143], a[40:43], v[36:39], v[128:143]
    ds_read_b64_tr_b16 a[8:9], v200 offset:16384
    ds_read_b64_tr_b16 a[10:11], v200 offset:16896
    s_add_u32 m0, s66, 4096
    s_lshl_b32 s62, s67, 7
    buffer_load_dwordx4 v188, s[32:35], s62 offen offset:0 lds
    ds_read_b64_tr_b16 a[12:13], v201 offset:16384
    ds_read_b64_tr_b16 a[14:15], v201 offset:16896
    v_cndmask_b32 v164, v168, v169, vcc
    v_cndmask_b32 v165, v170, v171, vcc
    v_mfma_f32_32x32x16_bf16 v[144:159], a[44:47], v[36:39], v[144:159]
    buffer_load_dwordx4 v189, s[32:35], s62 offen offset:1024 lds
    ds_read_b64_tr_b16 a[16:17], v202 offset:16384
    ds_read_b64_tr_b16 a[18:19], v202 offset:16896
    buffer_load_dwordx4 v190, s[32:35], s62 offen offset:2048 lds
    v_cndmask_b32 v166, v172, v173, vcc
    v_cndmask_b32 v167, v174, v175, vcc
    s_waitcnt lgkmcnt(15)
    v_mfma_f32_32x32x16_bf16 v[128:143], a[48:51], v[40:43], v[128:143]
    ds_read_b64_tr_b16 a[20:21], v203 offset:16384
    ds_read_b64_tr_b16 a[22:23], v203 offset:16896
    buffer_load_dwordx4 v191, s[32:35], s62 offen offset:3072 lds
    ds_read_b64_tr_b16 a[24:25], v204 offset:16384
    ds_read_b64_tr_b16 a[26:27], v204 offset:16896
    s_mov_b32 vcc_lo, 0xcccccccc
    s_mov_b32 vcc_hi, 0xcccccccc
    v_mfma_f32_32x32x16_bf16 v[144:159], a[52:55], v[40:43], v[144:159]
    s_add_u32 s67, s67, 1
    s_cmp_eq_u32 s67, 7
    s_cselect_b32 s67, 0, s67
    ds_read_b64_tr_b16 a[28:29], v205 offset:16384
    ds_read_b64_tr_b16 a[30:31], v205 offset:16896
    v_cndmask_b32 v160, v160, v161, vcc
    v_cndmask_b32 v161, v162, v163, vcc
    s_waitcnt lgkmcnt(15)
    v_mfma_f32_32x32x16_bf16 v[128:143], a[56:59], v[44:47], v[128:143]
    v_cndmask_b32 v162, v164, v165, vcc
    v_cndmask_b32 v163, v166, v167, vcc
    v_mfma_f32_32x32x16_bf16 v[144:159], a[60:63], v[44:47], v[144:159]
    s_mov_b32 vcc_lo, 0xff00ff00
    s_mov_b32 vcc_hi, 0xff00ff00
    s_waitcnt lgkmcnt(12)
    v_mfma_f32_32x32x16_bf16 v[128:143], a[0:3], v[48:51], v[128:143]
    v_mfma_f32_32x32x16_bf16 v[144:159], a[4:7], v[48:51], v[144:159]
    s_waitcnt vmcnt(6)
    s_barrier
    ds_read_b128 v[64:67], v192 offset:0
    ds_read_b128 v[68:71], v193 offset:0
    v_cndmask_b32 v160, v160, v161, vcc
    v_cndmask_b32 v161, v162, v163, vcc
    v_mfma_f32_16x16x32_bf16 v[180:183], a[252:255], a[0:3], v[180:183]
    ds_read_b128 v[72:75], v194 offset:0
    ds_read_b128 v[76:79], v195 offset:0
    ds_read_b64_tr_b16 a[32:33], v198 offset:24576
    ds_read_b64_tr_b16 a[34:35], v198 offset:25088
    s_mov_b32 vcc_lo, 0xffff0000
    s_mov_b32 vcc_hi, 0xffff0000
    v_mfma_f32_16x16x32_bf16 v[184:187], a[252:255], a[4:7], v[184:187]
    s_add_u32 m0, s65, 40960
    s_mul_i32 s62, s67, 172032
    buffer_load_dwordx4 v196, s[36:39], s62 offen offset:0 lds
    ds_read_b64_tr_b16 a[36:37], v199 offset:24576
    ds_read_b64_tr_b16 a[38:39], v199 offset:25088
    buffer_load_dwordx4 v197, s[36:39], s62 offen offset:1024 lds
    v_cndmask_b32 v160, v160, v161, vcc
    v_mov_b32 v161, v160
    s_waitcnt lgkmcnt(15)
    v_mfma_f32_32x32x16_bf16 v[128:143], a[8:11], v[52:55], v[128:143]
    ds_read_b64_tr_b16 a[40:41], v200 offset:24576
    ds_read_b64_tr_b16 a[42:43], v200 offset:25088
    s_add_u32 m0, s66, 8192
    s_lshl_b32 s62, s67, 7
    buffer_load_dwordx4 v188, s[32:35], s62 offen offset:0 lds
    ds_read_b64_tr_b16 a[44:45], v201 offset:24576
    ds_read_b64_tr_b16 a[46:47], v201 offset:25088
    s_mov_b32 vcc_lo, 0xf0f0f0f0
    s_mov_b32 vcc_hi, 0xf0f0f0f0
    v_mfma_f32_32x32x16_bf16 v[144:159], a[12:15], v[52:55], v[144:159]
    buffer_load_dwordx4 v189, s[32:35], s62 offen offset:1024 lds
    ds_read_b64_tr_b16 a[48:49], v202 offset:24576
    ds_read_b64_tr_b16 a[50:51], v202 offset:25088
    buffer_load_dwordx4 v190, s[32:35], s62 offen offset:2048 lds
    v_permlane32_swap_b32 v160, v161
    v_cndmask_b32 v215, v160, v161, vcc
    s_waitcnt lgkmcnt(15)
    v_mfma_f32_32x32x16_bf16 v[128:143], a[16:19], v[56:59], v[128:143]
    ds_read_b64_tr_b16 a[52:53], v203 offset:24576
    ds_read_b64_tr_b16 a[54:55], v203 offset:25088
    buffer_load_dwordx4 v191, s[32:35], s62 offen offset:3072 lds
    ds_read_b64_tr_b16 a[56:57], v204 offset:24576
    ds_read_b64_tr_b16 a[58:59], v204 offset:25088
    v_mov_b32 v214, v176
    v_mfma_f32_32x32x16_bf16 v[144:159], a[20:23], v[56:59], v[144:159]
    s_add_u32 s67, s67, 1
    s_cmp_eq_u32 s67, 7
    s_cselect_b32 s67, 0, s67
    ds_read_b64_tr_b16 a[60:61], v205 offset:24576
    ds_read_b64_tr_b16 a[62:63], v205 offset:25088
    s_waitcnt lgkmcnt(15)
    v_mfma_f32_32x32x16_bf16 v[128:143], a[24:27], v[60:63], v[128:143]
    v_mfma_f32_32x32x16_bf16 v[144:159], a[28:31], v[60:63], v[144:159]
    v_cmp_eq_u32 vcc, 0, v209
    s_cbranch_vccnz L_again_3
L_have_4:
    v_readfirstlane_b32 s46, v208
    v_readfirstlane_b32 s47, v209
    v_mov_b32 v216, v208
    v_mov_b32 v217, v209
    s_not_b64 exec, s[50:51]
    buffer_store_dwordx4 v[214:217], v218, s[28:31], s89 offen offset:0 sc1
    s_mov_b64 exec, -1
    s_waitcnt lgkmcnt(12)
    v_mfma_f32_32x32x16_bf16 v[128:143], a[32:35], v[64:67], v[128:143]
    v_mfma_f32_32x32x16_bf16 v[144:159], a[36:39], v[64:67], v[144:159]
    s_waitcnt vmcnt(7)
    s_barrier
    ds_read_b128 v[80:83], v192 offset:4096
    ds_read_b128 v[84:87], v193 offset:4096
    v_mfma_f32_16x16x32_bf16 v[180:183], a[252:255], a[32:35], v[180:183]
    ds_read_b128 v[88:91], v194 offset:4096
    ds_read_b128 v[92:95], v195 offset:4096
    ds_read_b64_tr_b16 a[0:1], v198 offset:32768
    ds_read_b64_tr_b16 a[2:3], v198 offset:33280
    v_mfma_f32_16x16x32_bf16 v[184:187], a[252:255], a[36:39], v[184:187]
    s_add_u32 m0, s65, 49152
    s_mul_i32 s62, s67, 172032
    buffer_load_dwordx4 v196, s[36:39], s62 offen offset:0 lds
    ds_read_b64_tr_b16 a[4:5], v199 offset:32768
    ds_read_b64_tr_b16 a[6:7], v199 offset:33280
    buffer_load_dwordx4 v197, s[36:39], s62 offen offset:1024 lds
    s_waitcnt lgkmcnt(15)
    v_mfma_f32_32x32x16_bf16 v[128:143], a[40:43], v[68:71], v[128:143]
    ds_read_b64_tr_b16 a[8:9], v200 offset:32768
    ds_read_b64_tr_b16 a[10:11], v200 offset:33280
    s_add_u32 m0, s66, 0
    s_lshl_b32 s62, s67, 7
    buffer_load_dwordx4 v188, s[32:35], s62 offen offset:0 lds
    ds_read_b64_tr_b16 a[12:13], v201 offset:32768
    ds_read_b64_tr_b16 a[14:15], v201 offset:33280
    v_mfma_f32_32x32x16_bf16 v[144:159], a[44:47], v[68:71], v[144:159]
    buffer_load_dwordx4 v189, s[32:35], s62 offen offset:1024 lds
    ds_read_b64_tr_b16 a[16:17], v202 offset:32768
    ds_read_b64_tr_b16 a[18:19], v202 offset:33280
    buffer_load_dwordx4 v190, s[32:35], s62 offen offset:2048 lds
    s_waitcnt lgkmcnt(15)
    v_mfma_f32_32x32x16_bf16 v[128:143], a[48:51], v[72:75], v[128:143]
    ds_read_b64_tr_b16 a[20:21], v203 offset:32768
    ds_read_b64_tr_b16 a[22:23], v203 offset:33280
    buffer_load_dwordx4 v191, s[32:35], s62 offen offset:3072 lds
    ds_read_b64_tr_b16 a[24:25], v204 offset:32768
    ds_read_b64_tr_b16 a[26:27], v204 offset:33280
    v_mfma_f32_32x32x16_bf16 v[144:159], a[52:55], v[72:75], v[144:159]
    s_add_u32 s67, s67, 1
    s_cmp_eq_u32 s67, 7
    s_cselect_b32 s67, 0, s67
    ds_read_b64_tr_b16 a[28:29], v205 offset:32768
    ds_read_b64_tr_b16 a[30:31], v205 offset:33280
    s_waitcnt lgkmcnt(15)
    v_mfma_f32_32x32x16_bf16 v[128:143], a[56:59], v[76:79], v[128:143]
    v_mfma_f32_32x32x16_bf16 v[144:159], a[60:63], v[76:79], v[144:159]
    s_waitcnt lgkmcnt(12)
    v_mfma_f32_32x32x16_bf16 v[128:143], a[0:3], v[80:83], v[128:143]
    v_mfma_f32_32x32x16_bf16 v[144:159], a[4:7], v[80:83], v[144:159]
    s_waitcnt vmcnt(7)
    s_barrier
    ds_read_b128 v[96:99], v192 offset:8192
    ds_read_b128 v[100:103], v193 offset:8192
    v_mfma_f32_16x16x32_bf16 v[180:183], a[252:255], a[0:3], v[180:183]
    ds_read_b128 v[104:107], v194 offset:8192
    ds_read_b128 v[108:111], v195 offset:8192
    ds_read_b64_tr_b16 a[32:33], v198 offset:40960
    ds_read_b64_tr_b16 a[34:35], v198 offset:41472
    v_mfma_f32_16x16x32_bf16 v[184:187], a[252:255], a[4:7], v[184:187]
    s_add_u32 m0, s82, 106496
    s_mul_i32 s62, s67, 172032
    buffer_load_dwordx4 v206, s[36:39], s62 offen offset:0 lds
    s_add_u32 s67, s67, 1
    s_cmp_eq_u32 s67, 7
    s_cselect_b32 s67, 0, s67
    ds_read_b64_tr_b16 a[36:37], v199 offset:40960
    ds_read_b64_tr_b16 a[38:39], v199 offset:41472
    s_add_u32 m0, s82, 110592
    s_mul_i32 s62, s67, 172032
    buffer_load_dwordx4 v206, s[36:39], s62 offen offset:0 lds
    s_add_u32 s67, s67, 1
    s_cmp_eq_u32 s67, 7
    s_cselect_b32 s67, 0, s67
    s_waitcnt lgkmcnt(15)
    v_mfma_f32_32x32x16_bf16 v[128:143], a[8:11], v[84:87], v[128:143]
    ds_read_b64_tr_b16 a[40:41], v200 offset:40960
    ds_read_b64_tr_b16 a[42:43], v200 offset:41472
    s_add_u32 m0, s82, 114688
    s_mul_i32 s62, s67, 172032
    buffer_load_dwordx4 v206, s[36:39], s62 offen offset:0 lds
    s_add_u32 s67, s67, 1
    s_cmp_eq_u32 s67, 7
    s_cselect_b32 s67, 0, s67
    ds_read_b64_tr_b16 a[44:45], v201 offset:40960
    ds_read_b64_tr_b16 a[46:47], v201 offset:41472
    v_mfma_f32_32x32x16_bf16 v[144:159], a[12:15], v[84:87], v[144:159]
    s_add_u32 m0, s82, 118784
    s_mul_i32 s62, s67, 172032
    buffer_load_dwordx4 v206, s[36:39], s62 offen offset:0 lds
    s_add_u32 s67, s67, 1
    s_cmp_eq_u32 s67, 7
    s_cselect_b32 s67, 0, s67
    ds_read_b64_tr_b16 a[48:49], v202 offset:40960
    ds_read_b64_tr_b16 a[50:51], v202 offset:41472
    ds_read_b64_tr_b16 a[52:53], v203 offset:40960
    ds_read_b64_tr_b16 a[54:55], v203 offset:41472
    s_waitcnt lgkmcnt(15)
    v_mfma_f32_32x32x16_bf16 v[128:143], a[16:19], v[88:91], v[128:143]
    ds_read_b64_tr_b16 a[56:57], v204 offset:40960
    ds_read_b64_tr_b16 a[58:59], v204 offset:41472
    ds_read_b64_tr_b16 a[60:61], v205 offset:40960
    ds_read_b64_tr_b16 a[62:63], v205 offset:41472
    v_mfma_f32_32x32x16_bf16 v[144:159], a[20:23], v[88:91], v[144:159]
    v_mfma_f32_32x32x16_bf16 v[128:143], a[24:27], v[92:95], v[128:143]
    v_mfma_f32_32x32x16_bf16 v[144:159], a[28:31], v[92:95], v[144:159]
    s_waitcnt lgkmcnt(15)
    s_waitcnt lgkmcnt(12)
    v_mfma_f32_32x32x16_bf16 v[128:143], a[32:35], v[96:99], v[128:143]
    v_mfma_f32_32x32x16_bf16 v[144:159], a[36:39], v[96:99], v[144:159]
    s_waitcnt vmcnt(4)
    s_barrier
    ds_read_b128 v[112:115], v192 offset:0
    ds_read_b128 v[116:119], v193 offset:0
    v_mfma_f32_16x16x32_bf16 v[180:183], a[252:255], a[32:35], v[180:183]
    ds_read_b128 v[120:123], v194 offset:0
    ds_read_b128 v[124:127], v195 offset:0
    ds_read_b64_tr_b16 a[0:1], v198 offset:49152
    ds_read_b64_tr_b16 a[2:3], v198 offset:49664
    v_mfma_f32_16x16x32_bf16 v[184:187], a[252:255], a[36:39], v[184:187]
    buffer_load_dwordx4 v[160:163], v222, s[28:31], s88 offen offset:0 sc1
    ds_read_b64_tr_b16 a[4:5], v199 offset:49152
    ds_read_b64_tr_b16 a[6:7], v199 offset:49664
    buffer_load_dwordx4 v[164:167], v222, s[28:31], s88 offen offset:1024 sc1
    s_waitcnt lgkmcnt(15)
    v_mfma_f32_32x32x16_bf16 v[128:143], a[40:43], v[100:103], v[128:143]
    ds_read_b64_tr_b16 a[8:9], v200 offset:49152
    ds_read_b64_tr_b16 a[10:11], v200 offset:49664
    buffer_load_dwordx4 v[168:171], v222, s[28:31], s88 offen offset:2048 sc1
    ds_read_b64_tr_b16 a[12:13], v201 offset:49152
    ds_read_b64_tr_b16 a[14:15], v201 offset:49664
    v_mfma_f32_32x32x16_bf16 v[144:159], a[44:47], v[100:103], v[144:159]
    buffer_load_dwordx4 v[172:175], v223, s[28:31], s88 offen offset:3072 sc1
    ds_read_b64_tr_b16 a[16:17], v202 offset:49152
    ds_read_b64_tr_b16 a[18:19], v202 offset:49664
    s_add_u32 m0, s82, 122880
    s_mul_i32 s62, s67, 172032
    buffer_load_dwordx4 v206, s[36:39], s62 offen offset:0 lds
    s_add_u32 s67, s67, 1
    s_cmp_eq_u32 s67, 7
    s_cselect_b32 s67, 0, s67
    s_waitcnt lgkmcnt(15)
    v_mfma_f32_32x32x16_bf16 v[128:143], a[48:51], v[104:107], v[128:143]
    ds_read_b64_tr_b16 a[20:21], v203 offset:49152
    ds_read_b64_tr_b16 a[22:23], v203 offset:49664
    s_add_u32 m0, s82, 126976
    s_mul_i32 s62, s67, 172032
    buffer_load_dwordx4 v206, s[36:39], s62 offen offset:0 lds
    s_add_u32 s67, s67, 1
    s_cmp_eq_u32 s67, 7
    s_cselect_b32 s67, 0, s67
    ds_read_b64_tr_b16 a[24:25], v204 offset:49152
    ds_read_b64_tr_b16 a[26:27], v204 offset:49664
    v_mfma_f32_32x32x16_bf16 v[144:159], a[52:55], v[104:107], v[144:159]
    s_add_u32 m0, s82, 131072
    s_mul_i32 s62, s67, 172032
    buffer_load_dwordx4 v206, s[36:39], s62 offen offset:0 lds
    s_add_u32 s67, s67, 1
    s_cmp_eq_u32 s67, 7
    s_cselect_b32 s67, 0, s67
    ds_read_b64_tr_b16 a[28:29], v205 offset:49152
    ds_read_b64_tr_b16 a[30:31], v205 offset:49664
    s_waitcnt lgkmcnt(15)
    v_mfma_f32_32x32x16_bf16 v[128:143], a[56:59], v[108:111], v[128:143]
    v_mfma_f32_32x32x16_bf16 v[144:159], a[60:63], v[108:111], v[144:159]
    s_waitcnt lgkmcnt(12)
    v_mfma_f32_32x32x16_bf16 v[128:143], a[0:3], v[112:115], v[128:143]
    v_mfma_f32_32x32x16_bf16 v[144:159], a[4:7], v[112:115], v[144:159]
    v_mfma_f32_16x16x32_bf16 v[180:183], a[252:255], a[0:3], v[180:183]
    v_mfma_f32_16x16x32_bf16 v[184:187], a[252:255], a[4:7], v[184:187]
    s_waitcnt lgkmcnt(8)
    v_mfma_f32_32x32x16_bf16 v[128:143], a[8:11], v[116:119], v[128:143]
    v_mfma_f32_32x32x16_bf16 v[144:159], a[12:15], v[116:119], v[144:159]
    s_lshl_b32 s62, s26, 2
    s_add_u32 s62, s62, 155648
    v_lshl_add_u32 v7, v2, 4, s62
    s_nop 0
    ds_write_b32 v7, v180
    ds_write_b32 v7, v184 offset:512
    v_lshlrev_b32 v7, 4, v2
    v_add_u32 v7, 155648, v7
    s_waitcnt lgkmcnt(0)
    s_barrier
    ds_read_b128 v[180:183], v7 offset:0
    ds_read_b128 v[184:187], v7 offset:512
    s_waitcnt vmcnt(3)
    v_cmp_ne_u64 vcc, s[46:47], v[162:163]
    v_cmp_ne_u64 s[62:63], s[46:47], v[166:167]
    v_cmp_ne_u64 s[90:91], s[46:47], v[170:171]
    v_cmp_ne_u64 s[68:69], s[46:47], v[174:175]
    s_nop 0
    s_or_b64 s[62:63], s[62:63], s[90:91]
    s_or_b64 vcc, vcc, s[68:69]
    s_or_b64 vcc, vcc, s[62:63]
    s_cbranch_vccnz L_again_5
L_have_6:
    v_mfma_f32_32x32x16_bf16 v[128:143], a[16:19], v[120:123], v[128:143]
    v_cndmask_b32 v172, v172, 0, s[50:51]
    v_add_f32 v160, v160, v164
    v_add_f32 v168, v168, v172
    v_add_f32 v160, v160, v168
    v_cndmask_b32 v173, v173, 0, s[50:51]
    v_add_f32 v161, v161, v165
    v_mfma_f32_32x32x16_bf16 v[144:159], a[20:23], v[120:123], v[144:159]
    v_add_f32 v169, v169, v173
    v_add_f32 v161, v161, v169
    v_mov_b32 v162, v160
    v_mov_b32 v163, v161
    s_nop 0
    v_permlane32_swap_b32 v162, v160
    v_mfma_f32_32x32x16_bf16 v[128:143], a[24:27], v[124:127], v[128:143]
    v_permlane32_swap_b32 v163, v161
    v_add_f32 v160, v160, v162
    v_add_f32 v161, v161, v163
    v_mul_f32 v10, 0x3b124925, v160
    v_mul_f32 v253, 0x3b124925, v161
    v_fma_f32 v253, -v10, v10, v253
    v_mfma_f32_32x32x16_bf16 v[144:159], a[28:31], v[124:127], v[144:159]
    v_max_f32 v253, 0, v253
    v_add_f32 v253, 0x3727c5ac, v253
    v_rsq_f32 v253, v253
    v_sub_f32 v11, 0, v10
    v_cndmask_b32 v11, v11, 0, s[50:51]
    v_cvt_pk_bf16_f32 v241, v11, 0
    v_lshlrev_b32 v240, 16, v241
    v_sub_f32 v240, v11, v240
    v_cvt_pk_bf16_f32 v240, v11, v240
    v_mov_b32 v242, 0
    v_mov_b32 v243, 0
    s_waitcnt lgkmcnt(0)
    v_add_f32 v180, v180, v181
    v_add_f32 v182, v182, v183
    v_add_f32 v180, v180, v182
    v_cvt_pk_bf16_f32 v232, v180, v180
    v_and_b32 v233, 0xffff0000, v232
    v_sub_f32 v233, v180, v233
    v_cvt_pk_bf16_f32 v233, v233, 0
    v_mov_b32 v234, 0
    v_mov_b32 v235, 0
    v_add_f32 v184, v184, v185
    v_add_f32 v186, v186, v187
    v_add_f32 v184, v184, v186
    v_cvt_pk_bf16_f32 v236, v184, v184
    v_and_b32 v237, 0xffff0000, v236
    v_sub_f32 v237, v184, v237
    v_cvt_pk_bf16_f32 v237, v237, 0
    v_mov_b32 v238, 0
    v_mov_b32 v239, 0
    s_waitcnt lgkmcnt(0)
    v_mfma_f32_32x32x16_bf16 v[128:143], v[232:235], v[240:243], v[128:143]
    v_mfma_f32_32x32x16_bf16 v[144:159], v[236:239], v[240:243], v[144:159]
    s_waitcnt lgkmcnt(0)
    s_nop 9
    v_pk_mul_f32 v[128:129], v[128:129], v[252:253] op_sel:[0,1] op_sel_hi:[1,1]
    v_pk_mul_f32 v[130:131], v[130:131], v[252:253] op_sel:[0,1] op_sel_hi:[1,1]
    v_pk_mul_f32 v[132:133], v[132:133], v[252:253] op_sel:[0,1] op_sel_hi:[1,1]
    v_pk_mul_f32 v[134:135], v[134:135], v[252:253] op_sel:[0,1] op_sel_hi:[1,1]
    v_cvt_pk_bf16_f32 v160, v128, v129
    v_cvt_pk_bf16_f32 v161, v130, v131
    v_cvt_pk_bf16_f32 v162, v132, v133
    v_cvt_pk_bf16_f32 v163, v134, v135
    buffer_store_dwordx4 v[160:163], v210, s[28:31], s64 offen offset:0 sc1
    v_pk_mul_f32 v[136:137], v[136:137], v[252:253] op_sel:[0,1] op_sel_hi:[1,1]
    v_pk_mul_f32 v[138:139], v[138:139], v[252:253] op_sel:[0,1] op_sel_hi:[1,1]
    v_pk_mul_f32 v[140:141], v[140:141], v[252:253] op_sel:[0,1] op_sel_hi:[1,1]
    v_pk_mul_f32 v[142:143], v[142:143], v[252:253] op_sel:[0,1] op_sel_hi:[1,1]
    v_cvt_pk_bf16_f32 v164, v136, v137
    v_cvt_pk_bf16_f32 v165, v138, v139
    v_cvt_pk_bf16_f32 v166, v140, v141
    v_cvt_pk_bf16_f32 v167, v142, v143
    buffer_store_dwordx4 v[164:167], v211, s[28:31], s64 offen offset:0 sc1
    v_pk_mul_f32 v[144:145], v[144:145], v[252:253] op_sel:[0,1] op_sel_hi:[1,1]
    v_pk_mul_f32 v[146:147], v[146:147], v[252:253] op_sel:[0,1] op_sel_hi:[1,1]
    v_pk_mul_f32 v[148:149], v[148:149], v[252:253] op_sel:[0,1] op_sel_hi:[1,1]
    v_pk_mul_f32 v[150:151], v[150:151], v[252:253] op_sel:[0,1] op_sel_hi:[1,1]
    v_cvt_pk_bf16_f32 v168, v144, v145
    v_cvt_pk_bf16_f32 v169, v146, v147
    v_cvt_pk_bf16_f32 v170, v148, v149
    v_cvt_pk_bf16_f32 v171, v150, v151
    buffer_store_dwordx4 v[168:171], v212, s[28:31], s64 offen offset:0 sc1
    v_pk_mul_f32 v[152:153], v[152:153], v[252:253] op_sel:[0,1] op_sel_hi:[1,1]
    v_pk_mul_f32 v[154:155], v[154:155], v[252:253] op_sel:[0,1] op_sel_hi:[1,1]
    v_pk_mul_f32 v[156:157], v[156:157], v[252:253] op_sel:[0,1] op_sel_hi:[1,1]
    v_pk_mul_f32 v[158:159], v[158:159], v[252:253] op_sel:[0,1] op_sel_hi:[1,1]
    v_cvt_pk_bf16_f32 v172, v152, v153
    v_cvt_pk_bf16_f32 v173, v154, v155
    v_cvt_pk_bf16_f32 v174, v156, v157
    v_cvt_pk_bf16_f32 v175, v158, v159
    buffer_store_dwordx4 v[172:175], v213, s[28:31], s64 offen offset:0 sc1
    s_branch L_p1_join
    s_branch L_pg1
    .p2align 12
L_stub1:
    s_setpc_b64 s[70:71]
L_pg1:
L_p1_V:
    s_sub_u32 s62, s44, 7
    s_lshl_b32 s62, s62, 6
    s_mov_b32 s63, 114240
    s_mul_i32 s64, s54, 1792
    s_add_u32 s64, s64, 4194304
    v_add_u32 v9, s62, v6
    v_add_u32 v9, 0, v9
    v_mul_u32_u24 v10, 2341, v9
    v_lshrrev_b32 v10, 16, v10
    v_mul_lo_u32 v10, v10, s63
    v_lshl_add_u32 v10, v9, 4, v10
    v_mul_u32_u24 v9, 448, v1
    v_add_u32 v210, v10, v9
    v_add_u32 v9, s62, v6
    v_add_u32 v9, 32, v9
    v_mul_u32_u24 v10, 2341, v9
    v_lshrrev_b32 v10, 16, v10
    v_mul_lo_u32 v10, v10, s63
    v_lshl_add_u32 v10, v9, 4, v10
    v_mul_u32_u24 v9, 448, v1
    v_add_u32 v211, v10, v9
    s_lshl_b32 s62, s26, 7
    s_add_u32 s62, s62, 157696
    v_lshl_add_u32 v212, v2, 2, s62
    v_lshl_add_u32 v213, v1, 4, s62
    s_lshl_b32 s88, s54, 13
    s_add_u32 s88, s88, 18874368
    s_lshl_b32 s68, s44, 9
    s_add_u32 s89, s88, s68
    s_and_b32 s68, s68, 512
    s_add_u32 s88, s88, s68
    v_lshlrev_b32 v218, 4, v2
    v_lshl_add_u32 v222, v1, 12, v218
    v_mul_u32_u24 v223, 3072, v1
    v_add_u32 v223, v223, v218
    s_waitcnt vmcnt(7)
    s_barrier
    ds_read_b128 v[16:19], v192 offset:0
    ds_read_b128 v[20:23], v193 offset:0
    ds_read_b128 v[24:27], v194 offset:0
    ds_read_b128 v[28:31], v195 offset:0
    ds_read_b64_tr_b16 a[0:1], v198 offset:0
    ds_read_b64_tr_b16 a[2:3], v198 offset:512
    s_add_u32 m0, s65, 16384
    s_mul_i32 s62, s67, 172032
    buffer_load_dwordx4 v196, s[36:39], s62 offen offset:0 lds
    ds_read_b64_tr_b16 a[4:5], v199 offset:0
    ds_read_b64_tr_b16 a[6:7], v199 offset:512
    buffer_load_dwordx4 v197, s[36:39], s62 offen offset:1024 lds
    ds_read_b64_tr_b16 a[8:9], v200 offset:0
    ds_read_b64_tr_b16 a[10:11], v200 offset:512
    s_add_u32 m0, s66, 8192
    s_lshl_b32 s62, s67, 7
    buffer_load_dwordx4 v188, s[32:35], s62 offen offset:0 lds
    ds_read_b64_tr_b16 a[12:13], v201 offset:0
    ds_read_b64_tr_b16 a[14:15], v201 offset:512
    buffer_load_dwordx4 v189, s[32:35], s62 offen offset:1024 lds
    ds_read_b64_tr_b16 a[16:17], v202 offset:0
    ds_read_b64_tr_b16 a[18:19], v202 offset:512
    buffer_load_dwordx4 v190, s[32:35], s62 offen offset:2048 lds
    ds_read_b64_tr_b16 a[20:21], v203 offset:0
    ds_read_b64_tr_b16 a[22:23], v203 offset:512
    buffer_load_dwordx4 v191, s[32:35], s62 offen offset:3072 lds
    ds_read_b64_tr_b16 a[24:25], v204 offset:0
    ds_read_b64_tr_b16 a[26:27], v204 offset:512
    s_add_u32 s67, s67, 1
    s_cmp_eq_u32 s67, 7
    s_cselect_b32 s67, 0, s67
    ds_read_b64_tr_b16 a[28:29], v205 offset:0
    ds_read_b64_tr_b16 a[30:31], v205 offset:512
    s_waitcnt lgkmcnt(15)
    v_mfma_f32_32x32x16_bf16 v[160:175], v[16:19], v[16:19], 0
    s_waitcnt lgkmcnt(12)
    v_mfma_f32_32x32x16_bf16 v[128:143], v[16:19], a[0:3], 0
    s_waitcnt vmcnt(7)
    s_barrier
    ds_read_b128 v[32:35], v192 offset:4096
    v_mfma_f32_32x32x16_bf16 v[144:159], v[16:19], a[4:7], 0
    ds_read_b128 v[36:39], v193 offset:4096
    ds_read_b128 v[40:43], v194 offset:4096
    v_mfma_f32_16x16x32_bf16 v[176:179], a[252:255], v[16:19], 0
    ds_read_b128 v[44:47], v195 offset:4096
    ds_read_b64_tr_b16 a[32:33], v198 offset:8192
    ds_read_b64_tr_b16 a[34:35], v198 offset:8704
    v_mfma_f32_16x16x32_bf16 v[180:183], a[252:255], a[0:3], 0
    v_mov_b32 v208, 0
    buffer_load_dwordx2 v[208:209], v208, s[40:43], 0 offen offset:0 sc1
    ds_read_b64_tr_b16 a[36:37], v199 offset:8192
    ds_read_b64_tr_b16 a[38:39], v199 offset:8704
    v_mfma_f32_16x16x32_bf16 v[184:187], a[252:255], a[4:7], 0
    s_add_u32 m0, s65, 24576
    s_mul_i32 s62, s67, 172032
    buffer_load_dwordx4 v196, s[36:39], s62 offen offset:0 lds
    ds_read_b64_tr_b16 a[40:41], v200 offset:8192
    ds_read_b64_tr_b16 a[42:43], v200 offset:8704
    v_mfma_f32_32x32x16_bf16 v[160:175], v[20:23], v[20:23], v[160:175]
    buffer_load_dwordx4 v197, s[36:39], s62 offen offset:1024 lds
    ds_read_b64_tr_b16 a[44:45], v201 offset:8192
    ds_read_b64_tr_b16 a[46:47], v201 offset:8704
    s_waitcnt lgkmcnt(15)
    v_mfma_f32_32x32x16_bf16 v[128:143], v[20:23], a[8:11], v[128:143]
    s_add_u32 m0, s66, 0
    s_lshl_b32 s62, s67, 7
    buffer_load_dwordx4 v188, s[32:35], s62 offen offset:0 lds
    ds_read_b64_tr_b16 a[48:49], v202 offset:8192
    ds_read_b64_tr_b16 a[50:51], v202 offset:8704
    v_mfma_f32_32x32x16_bf16 v[144:159], v[20:23], a[12:15], v[144:159]
    buffer_load_dwordx4 v189, s[32:35], s62 offen offset:1024 lds
    ds_read_b64_tr_b16 a[52:53], v203 offset:8192
    ds_read_b64_tr_b16 a[54:55], v203 offset:8704
    v_mfma_f32_16x16x32_bf16 v[176:179], a[252:255], v[20:23], v[176:179]
    buffer_load_dwordx4 v190, s[32:35], s62 offen offset:2048 lds
    ds_read_b64_tr_b16 a[56:57], v204 offset:8192
    ds_read_b64_tr_b16 a[58:59], v204 offset:8704
    v_mfma_f32_32x32x16_bf16 v[160:175], v[24:27], v[24:27], v[160:175]
    buffer_load_dwordx4 v191, s[32:35], s62 offen offset:3072 lds
    ds_read_b64_tr_b16 a[60:61], v205 offset:8192
    ds_read_b64_tr_b16 a[62:63], v205 offset:8704
    v_mfma_f32_32x32x16_bf16 v[128:143], v[24:27], a[16:19], v[128:143]
    s_add_u32 s67, s67, 1
    s_cmp_eq_u32 s67, 7
    s_cselect_b32 s67, 0, s67
    v_mfma_f32_32x32x16_bf16 v[144:159], v[24:27], a[20:23], v[144:159]
    v_mfma_f32_16x16x32_bf16 v[176:179], a[252:255], v[24:27], v[176:179]
    v_mfma_f32_32x32x16_bf16 v[160:175], v[28:31], v[28:31], v[160:175]
    s_waitcnt lgkmcnt(15)
    v_mfma_f32_32x32x16_bf16 v[128:143], v[28:31], a[24:27], v[128:143]
    v_mfma_f32_32x32x16_bf16 v[144:159], v[28:31], a[28:31], v[144:159]
    v_mfma_f32_16x16x32_bf16 v[176:179], a[252:255], v[28:31], v[176:179]
    s_waitcnt lgkmcnt(12)
    v_mfma_f32_32x32x16_bf16 v[128:143], v[32:35], a[32:35], v[128:143]
    v_mfma_f32_32x32x16_bf16 v[144:159], v[32:35], a[36:39], v[144:159]
    s_waitcnt vmcnt(7)
    s_barrier
    ds_read_b128 v[48:51], v192 offset:8192
    ds_read_b128 v[52:55], v193 offset:8192
    s_mov_b32 vcc_lo, 0xaaaaaaaa
    s_mov_b32 vcc_hi, 0xaaaaaaaa
    v_mfma_f32_16x16x32_bf16 v[180:183], a[252:255], a[32:35], v[180:183]
    ds_read_b128 v[56:59], v194 offset:8192
    ds_read_b128 v[60:63], v195 offset:8192
    ds_read_b64_tr_b16 a[0:1], v198 offset:16384
    ds_read_b64_tr_b16 a[2:3], v198 offset:16896
    v_cndmask_b32 v160, v160, v161, vcc
    v_cndmask_b32 v161, v162, v163, vcc
    v_mfma_f32_16x16x32_bf16 v[184:187], a[252:255], a[36:39], v[184:187]
    s_add_u32 m0, s65, 32768
    s_mul_i32 s62, s67, 172032
    buffer_load_dwordx4 v196, s[36:39], s62 offen offset:0 lds
    ds_read_b64_tr_b16 a[4:5], v199 offset:16384
    ds_read_b64_tr_b16 a[6:7], v199 offset:16896
    buffer_load_dwordx4 v197, s[36:39], s62 offen offset:1024 lds
    v_cndmask_b32 v162, v164, v165, vcc
    v_cndmask_b32 v163, v166, v167, vcc
    s_waitcnt lgkmcnt(15)
    v_mfma_f32_32x32x16_bf16 v[128:143], v[36:39], a[40:43], v[128:143]
    ds_read_b64_tr_b16 a[8:9], v200 offset:16384
    ds_read_b64_tr_b16 a[10:11], v200 offset:16896
    s_add_u32 m0, s66, 4096
    s_lshl_b32 s62, s67, 7
    buffer_load_dwordx4 v188, s[32:35], s62 offen offset:0 lds
    ds_read_b64_tr_b16 a[12:13], v201 offset:16384
    ds_read_b64_tr_b16 a[14:15], v201 offset:16896
    v_cndmask_b32 v164, v168, v169, vcc
    v_cndmask_b32 v165, v170, v171, vcc
    v_mfma_f32_32x32x16_bf16 v[144:159], v[36:39], a[44:47], v[144:159]
    buffer_load_dwordx4 v189, s[32:35], s62 offen offset:1024 lds
    ds_read_b64_tr_b16 a[16:17], v202 offset:16384
    ds_read_b64_tr_b16 a[18:19], v202 offset:16896
    buffer_load_dwordx4 v190, s[32:35], s62 offen offset:2048 lds
    v_cndmask_b32 v166, v172, v173, vcc
    v_cndmask_b32 v167, v174, v175, vcc
    s_waitcnt lgkmcnt(15)
    v_mfma_f32_32x32x16_bf16 v[128:143], v[40:43], a[48:51], v[128:143]
    ds_read_b64_tr_b16 a[20:21], v203 offset:16384
    ds_read_b64_tr_b16 a[22:23], v203 offset:16896
    buffer_load_dwordx4 v191, s[32:35], s62 offen offset:3072 lds
    ds_read_b64_tr_b16 a[24:25], v204 offset:16384
    ds_read_b64_tr_b16 a[26:27], v204 offset:16896
    s_mov_b32 vcc_lo, 0xcccccccc
    s_mov_b32 vcc_hi, 0xcccccccc
    v_mfma_f32_32x32x16_bf16 v[144:159], v[40:43], a[52:55], v[144:159]
    s_add_u32 s67, s67, 1
    s_cmp_eq_u32 s67, 7
    s_cselect_b32 s67, 0, s67
    ds_read_b64_tr_b16 a[28:29], v205 offset:16384
    ds_read_b64_tr_b16 a[30:31], v205 offset:16896
    v_cndmask_b32 v160, v160, v161, vcc
    v_cndmask_b32 v161, v162, v163, vcc
    s_waitcnt lgkmcnt(15)
    v_mfma_f32_32x32x16_bf16 v[128:143], v[44:47], a[56:59], v[128:143]
    v_cndmask_b32 v162, v164, v165, vcc
    v_cndmask_b32 v163, v166, v167, vcc
    v_mfma_f32_32x32x16_bf16 v[144:159], v[44:47], a[60:63], v[144:159]
    s_mov_b32 vcc_lo, 0xff00ff00
    s_mov_b32 vcc_hi, 0xff00ff00
    s_waitcnt lgkmcnt(12)
    v_mfma_f32_32x32x16_bf16 v[128:143], v[48:51], a[0:3], v[128:143]
    v_mfma_f32_32x32x16_bf16 v[144:159], v[48:51], a[4:7], v[144:159]
    s_waitcnt vmcnt(6)
    s_barrier
    ds_read_b128 v[64:67], v192 offset:0
    ds_read_b128 v[68:71], v193 offset:0
    v_cndmask_b32 v160, v160, v161, vcc
    v_cndmask_b32 v161, v162, v163, vcc
    v_mfma_f32_16x16x32_bf16 v[180:183], a[252:255], a[0:3], v[180:183]
    ds_read_b128 v[72:75], v194 offset:0
    ds_read_b128 v[76:79], v195 offset:0
    ds_read_b64_tr_b16 a[32:33], v198 offset:24576
    ds_read_b64_tr_b16 a[34:35], v198 offset:25088
    s_mov_b32 vcc_lo, 0xffff0000
    s_mov_b32 vcc_hi, 0xffff0000
    v_mfma_f32_16x16x32_bf16 v[184:187], a[252:255], a[4:7], v[184:187]
    s_add_u32 m0, s65, 40960
    s_mul_i32 s62, s67, 172032
    buffer_load_dwordx4 v196, s[36:39], s62 offen offset:0 lds
    ds_read_b64_tr_b16 a[36:37], v199 offset:24576
    ds_read_b64_tr_b16 a[38:39], v199 offset:25088
    buffer_load_dwordx4 v197, s[36:39], s62 offen offset:1024 lds
    v_cndmask_b32 v160, v160, v161, vcc
    v_mov_b32 v161, v160
    s_waitcnt lgkmcnt(15)
    v_mfma_f32_32x32x16_bf16 v[128:143], v[52:55], a[8:11], v[128:143]
    ds_read_b64_tr_b16 a[40:41], v200 offset:24576
    ds_read_b64_tr_b16 a[42:43], v200 offset:25088
    s_add_u32 m0, s66, 8192
    s_lshl_b32 s62, s67, 7
    buffer_load_dwordx4 v188, s[32:35], s62 offen offset:0 lds
    ds_read_b64_tr_b16 a[44:45], v201 offset:24576
    ds_read_b64_tr_b16 a[46:47], v201 offset:25088
    s_mov_b32 vcc_lo, 0xf0f0f0f0
    s_mov_b32 vcc_hi, 0xf0f0f0f0
    v_mfma_f32_32x32x16_bf16 v[144:159], v[52:55], a[12:15], v[144:159]
    buffer_load_dwordx4 v189, s[32:35], s62 offen offset:1024 lds
    ds_read_b64_tr_b16 a[48:49], v202 offset:24576
    ds_read_b64_tr_b16 a[50:51], v202 offset:25088
    buffer_load_dwordx4 v190, s[32:35], s62 offen offset:2048 lds
    v_permlane32_swap_b32 v160, v161
    v_cndmask_b32 v215, v160, v161, vcc
    s_waitcnt lgkmcnt(15)
    v_mfma_f32_32x32x16_bf16 v[128:143], v[56:59], a[16:19], v[128:143]
    ds_read_b64_tr_b16 a[52:53], v203 offset:24576
    ds_read_b64_tr_b16 a[54:55], v203 offset:25088
    buffer_load_dwordx4 v191, s[32:35], s62 offen offset:3072 lds
    ds_read_b64_tr_b16 a[56:57], v204 offset:24576
    ds_read_b64_tr_b16 a[58:59], v204 offset:25088
    v_mov_b32 v214, v176
    v_mfma_f32_32x32x16_bf16 v[144:159], v[56:59], a[20:23], v[144:159]
    s_add_u32 s67, s67, 1
    s_cmp_eq_u32 s67, 7
    s_cselect_b32 s67, 0, s67
    ds_read_b64_tr_b16 a[60:61], v205 offset:24576
    ds_read_b64_tr_b16 a[62:63], v205 offset:25088
    s_waitcnt lgkmcnt(15)
    v_mfma_f32_32x32x16_bf16 v[128:143], v[60:63], a[24:27], v[128:143]
    v_mfma_f32_32x32x16_bf16 v[144:159], v[60:63], a[28:31], v[144:159]
    v_cmp_eq_u32 vcc, 0, v209
    s_cbranch_vccnz L_again_7
L_have_8:
    v_readfirstlane_b32 s46, v208
    v_readfirstlane_b32 s47, v209
    v_mov_b32 v216, v208
    v_mov_b32 v217, v209
    s_not_b64 exec, s[50:51]
    buffer_store_dwordx4 v[214:217], v218, s[28:31], s89 offen offset:0 sc1
    s_mov_b64 exec, -1
    s_waitcnt lgkmcnt(12)
    v_mfma_f32_32x32x16_bf16 v[128:143], v[64:67], a[32:35], v[128:143]
    v_mfma_f32_32x32x16_bf16 v[144:159], v[64:67], a[36:39], v[144:159]
    s_waitcnt vmcnt(7)
    s_barrier
    ds_read_b128 v[80:83], v192 offset:4096
    ds_read_b128 v[84:87], v193 offset:4096
    v_mfma_f32_16x16x32_bf16 v[180:183], a[252:255], a[32:35], v[180:183]
    ds_read_b128 v[88:91], v194 offset:4096
    ds_read_b128 v[92:95], v195 offset:4096
    ds_read_b64_tr_b16 a[0:1], v198 offset:32768
    ds_read_b64_tr_b16 a[2:3], v198 offset:33280
    v_mfma_f32_16x16x32_bf16 v[184:187], a[252:255], a[36:39], v[184:187]
    s_add_u32 m0, s65, 49152
    s_mul_i32 s62, s67, 172032
    buffer_load_dwordx4 v196, s[36:39], s62 offen offset:0 lds
    ds_read_b64_tr_b16 a[4:5], v199 offset:32768
    ds_read_b64_tr_b16 a[6:7], v199 offset:33280
    buffer_load_dwordx4 v197, s[36:39], s62 offen offset:1024 lds
    s_waitcnt lgkmcnt(15)
    v_mfma_f32_32x32x16_bf16 v[128:143], v[68:71], a[40:43], v[128:143]
    ds_read_b64_tr_b16 a[8:9], v200 offset:32768
    ds_read_b64_tr_b16 a[10:11], v200 offset:33280
    s_add_u32 m0, s66, 0
    s_lshl_b32 s62, s67, 7
    buffer_load_dwordx4 v188, s[32:35], s62 offen offset:0 lds
    ds_read_b64_tr_b16 a[12:13], v201 offset:32768
    ds_read_b64_tr_b16 a[14:15], v201 offset:33280
    v_mfma_f32_32x32x16_bf16 v[144:159], v[68:71], a[44:47], v[144:159]
    buffer_load_dwordx4 v189, s[32:35], s62 offen offset:1024 lds
    ds_read_b64_tr_b16 a[16:17], v202 offset:32768
    ds_read_b64_tr_b16 a[18:19], v202 offset:33280
    buffer_load_dwordx4 v190, s[32:35], s62 offen offset:2048 lds
    s_waitcnt lgkmcnt(15)
    v_mfma_f32_32x32x16_bf16 v[128:143], v[72:75], a[48:51], v[128:143]
    ds_read_b64_tr_b16 a[20:21], v203 offset:32768
    ds_read_b64_tr_b16 a[22:23], v203 offset:33280
    buffer_load_dwordx4 v191, s[32:35], s62 offen offset:3072 lds
    ds_read_b64_tr_b16 a[24:25], v204 offset:32768
    ds_read_b64_tr_b16 a[26:27], v204 offset:33280
    v_mfma_f32_32x32x16_bf16 v[144:159], v[72:75], a[52:55], v[144:159]
    s_add_u32 s67, s67, 1
    s_cmp_eq_u32 s67, 7
    s_cselect_b32 s67, 0, s67
    ds_read_b64_tr_b16 a[28:29], v205 offset:32768
    ds_read_b64_tr_b16 a[30:31], v205 offset:33280
    s_waitcnt lgkmcnt(15)
    v_mfma_f32_32x32x16_bf16 v[128:143], v[76:79], a[56:59], v[128:143]
    v_mfma_f32_32x32x16_bf16 v[144:159], v[76:79], a[60:63], v[144:159]
    s_waitcnt lgkmcnt(12)
    v_mfma_f32_32x32x16_bf16 v[128:143], v[80:83], a[0:3], v[128:143]
    v_mfma_f32_32x32x16_bf16 v[144:159], v[80:83], a[4:7], v[144:159]
    s_waitcnt vmcnt(7)
    s_barrier
    ds_read_b128 v[96:99], v192 offset:8192
    ds_read_b128 v[100:103], v193 offset:8192
    v_mfma_f32_16x16x32_bf16 v[180:183], a[252:255], a[0:3], v[180:183]
    ds_read_b128 v[104:107], v194 offset:8192
    ds_read_b128 v[108:111], v195 offset:8192
    ds_read_b64_tr_b16 a[32:33], v198 offset:40960
    ds_read_b64_tr_b16 a[34:35], v198 offset:41472
    v_mfma_f32_16x16x32_bf16 v[184:187], a[252:255], a[4:7], v[184:187]
    s_add_u32 m0, s82, 106496
    s_mul_i32 s62, s67, 172032
    buffer_load_dwordx4 v206, s[36:39], s62 offen offset:0 lds
    s_add_u32 s67, s67, 1
    s_cmp_eq_u32 s67, 7
    s_cselect_b32 s67, 0, s67
    ds_read_b64_tr_b16 a[36:37], v199 offset:40960
    ds_read_b64_tr_b16 a[38:39], v199 offset:41472
    s_add_u32 m0, s82, 110592
    s_mul_i32 s62, s67, 172032
    buffer_load_dwordx4 v206, s[36:39], s62 offen offset:0 lds
    s_add_u32 s67, s67, 1
    s_cmp_eq_u32 s67, 7
    s_cselect_b32 s67, 0, s67
    s_waitcnt lgkmcnt(15)
    v_mfma_f32_32x32x16_bf16 v[128:143], v[84:87], a[8:11], v[128:143]
    ds_read_b64_tr_b16 a[40:41], v200 offset:40960
    ds_read_b64_tr_b16 a[42:43], v200 offset:41472
    s_add_u32 m0, s82, 114688
    s_mul_i32 s62, s67, 172032
    buffer_load_dwordx4 v206, s[36:39], s62 offen offset:0 lds
    s_add_u32 s67, s67, 1
    s_cmp_eq_u32 s67, 7
    s_cselect_b32 s67, 0, s67
    ds_read_b64_tr_b16 a[44:45], v201 offset:40960
    ds_read_b64_tr_b16 a[46:47], v201 offset:41472
    v_mfma_f32_32x32x16_bf16 v[144:159], v[84:87], a[12:15], v[144:159]
    s_add_u32 m0, s82, 118784
    s_mul_i32 s62, s67, 172032
    buffer_load_dwordx4 v206, s[36:39], s62 offen offset:0 lds
    s_add_u32 s67, s67, 1
    s_cmp_eq_u32 s67, 7
    s_cselect_b32 s67, 0, s67
    ds_read_b64_tr_b16 a[48:49], v202 offset:40960
    ds_read_b64_tr_b16 a[50:51], v202 offset:41472
    ds_read_b64_tr_b16 a[52:53], v203 offset:40960
    ds_read_b64_tr_b16 a[54:55], v203 offset:41472
    s_waitcnt lgkmcnt(15)
    v_mfma_f32_32x32x16_bf16 v[128:143], v[88:91], a[16:19], v[128:143]
    ds_read_b64_tr_b16 a[56:57], v204 offset:40960
    ds_read_b64_tr_b16 a[58:59], v204 offset:41472
    ds_read_b64_tr_b16 a[60:61], v205 offset:40960
    ds_read_b64_tr_b16 a[62:63], v205 offset:41472
    v_mfma_f32_32x32x16_bf16 v[144:159], v[88:91], a[20:23], v[144:159]
    v_mfma_f32_32x32x16_bf16 v[128:143], v[92:95], a[24:27], v[128:143]
    v_mfma_f32_32x32x16_bf16 v[144:159], v[92:95], a[28:31], v[144:159]
    s_waitcnt lgkmcnt(15)
    s_waitcnt lgkmcnt(12)
    v_mfma_f32_32x32x16_bf16 v[128:143], v[96:99], a[32:35], v[128:143]
    v_mfma_f32_32x32x16_bf16 v[144:159], v[96:99], a[36:39], v[144:159]
    s_waitcnt vmcnt(4)
    s_barrier
    ds_read_b128 v[112:115], v192 offset:0
    ds_read_b128 v[116:119], v193 offset:0
    v_mfma_f32_16x16x32_bf16 v[180:183], a[252:255], a[32:35], v[180:183]
    ds_read_b128 v[120:123], v194 offset:0
    ds_read_b128 v[124:127], v195 offset:0
    ds_read_b64_tr_b16 a[0:1], v198 offset:49152
    ds_read_b64_tr_b16 a[2:3], v198 offset:49664
    v_mfma_f32_16x16x32_bf16 v[184:187], a[252:255], a[36:39], v[184:187]
    buffer_load_dwordx4 v[160:163], v222, s[28:31], s88 offen offset:0 sc1
    ds_read_b64_tr_b16 a[4:5], v199 offset:49152
    ds_read_b64_tr_b16 a[6:7], v199 offset:49664
    buffer_load_dwordx4 v[164:167], v222, s[28:31], s88 offen offset:1024 sc1
    s_waitcnt lgkmcnt(15)
    v_mfma_f32_32x32x16_bf16 v[128:143], v[100:103], a[40:43], v[128:143]
    ds_read_b64_tr_b16 a[8:9], v200 offset:49152
    ds_read_b64_tr_b16 a[10:11], v200 offset:49664
    buffer_load_dwordx4 v[168:171], v222, s[28:31], s88 offen offset:2048 sc1
    ds_read_b64_tr_b16 a[12:13], v201 offset:49152
    ds_read_b64_tr_b16 a[14:15], v201 offset:49664
    v_mfma_f32_32x32x16_bf16 v[144:159], v[100:103], a[44:47], v[144:159]
    buffer_load_dwordx4 v[172:175], v223, s[28:31], s88 offen offset:3072 sc1
    ds_read_b64_tr_b16 a[16:17], v202 offset:49152
    ds_read_b64_tr_b16 a[18:19], v202 offset:49664
    s_add_u32 m0, s82, 122880
    s_mul_i32 s62, s67, 172032
    buffer_load_dwordx4 v206, s[36:39], s62 offen offset:0 lds
    s_add_u32 s67, s67, 1
    s_cmp_eq_u32 s67, 7
    s_cselect_b32 s67, 0, s67
    s_waitcnt lgkmcnt(15)
    v_mfma_f32_32x32x16_bf16 v[128:143], v[104:107], a[48:51], v[128:143]
    ds_read_b64_tr_b16 a[20:21], v203 offset:49152
    ds_read_b64_tr_b16 a[22:23], v203 offset:49664
    s_add_u32 m0, s82, 126976
    s_mul_i32 s62, s67, 172032
    buffer_load_dwordx4 v206, s[36:39], s62 offen offset:0 lds
    s_add_u32 s67, s67, 1
    s_cmp_eq_u32 s67, 7
    s_cselect_b32 s67, 0, s67
    ds_read_b64_tr_b16 a[24:25], v204 offset:49152
    ds_read_b64_tr_b16 a[26:27], v204 offset:49664
    v_mfma_f32_32x32x16_bf16 v[144:159], v[104:107], a[52:55], v[144:159]
    s_add_u32 m0, s82, 131072
    s_mul_i32 s62, s67, 172032
    buffer_load_dwordx4 v206, s[36:39], s62 offen offset:0 lds
    s_add_u32 s67, s67, 1
    s_cmp_eq_u32 s67, 7
    s_cselect_b32 s67, 0, s67
    ds_read_b64_tr_b16 a[28:29], v205 offset:49152
    ds_read_b64_tr_b16 a[30:31], v205 offset:49664
    s_waitcnt lgkmcnt(15)
    v_mfma_f32_32x32x16_bf16 v[128:143], v[108:111], a[56:59], v[128:143]
    v_mfma_f32_32x32x16_bf16 v[144:159], v[108:111], a[60:63], v[144:159]
    s_waitcnt lgkmcnt(12)
    v_mfma_f32_32x32x16_bf16 v[128:143], v[112:115], a[0:3], v[128:143]
    v_mfma_f32_32x32x16_bf16 v[144:159], v[112:115], a[4:7], v[144:159]
    v_mfma_f32_16x16x32_bf16 v[180:183], a[252:255], a[0:3], v[180:183]
    v_mfma_f32_16x16x32_bf16 v[184:187], a[252:255], a[4:7], v[184:187]
    s_waitcnt lgkmcnt(8)
    v_mfma_f32_32x32x16_bf16 v[128:143], v[116:119], a[8:11], v[128:143]
    v_mfma_f32_32x32x16_bf16 v[144:159], v[116:119], a[12:15], v[144:159]
    s_lshl_b32 s62, s26, 2
    s_add_u32 s62, s62, 155648
    v_lshl_add_u32 v7, v2, 4, s62
    s_nop 0
    ds_write_b32 v7, v180
    ds_write_b32 v7, v184 offset:512
    v_lshlrev_b32 v7, 4, v2
    v_add_u32 v7, 155648, v7
    s_waitcnt lgkmcnt(0)
    s_barrier
    ds_read_b128 v[180:183], v7 offset:0
    ds_read_b128 v[184:187], v7 offset:512
    s_waitcnt vmcnt(3)
    v_cmp_ne_u64 vcc, s[46:47], v[162:163]
    v_cmp_ne_u64 s[62:63], s[46:47], v[166:167]
    v_cmp_ne_u64 s[90:91], s[46:47], v[170:171]
    v_cmp_ne_u64 s[68:69], s[46:47], v[174:175]
    s_nop 0
    s_or_b64 s[62:63], s[62:63], s[90:91]
    s_or_b64 vcc, vcc, s[68:69]
    s_or_b64 vcc, vcc, s[62:63]
    s_cbranch_vccnz L_again_9
L_have_10:
    v_mfma_f32_32x32x16_bf16 v[128:143], v[120:123], a[16:19], v[128:143]
    v_cndmask_b32 v172, v172, 0, s[50:51]
    v_add_f32 v160, v160, v164
    v_add_f32 v168, v168, v172
    v_add_f32 v160, v160, v168
    v_cndmask_b32 v173, v173, 0, s[50:51]
    v_add_f32 v161, v161, v165
    v_mfma_f32_32x32x16_bf16 v[144:159], v[120:123], a[20:23], v[144:159]
    v_add_f32 v169, v169, v173
    v_add_f32 v161, v161, v169
    v_mov_b32 v162, v160
    v_mov_b32 v163, v161
    s_nop 0
    v_permlane32_swap_b32 v162, v160
    v_mfma_f32_32x32x16_bf16 v[128:143], v[124:127], a[24:27], v[128:143]
    v_permlane32_swap_b32 v163, v161
    v_add_f32 v160, v160, v162
    v_add_f32 v161, v161, v163
    v_mul_f32 v10, 0x3b124925, v160
    v_mul_f32 v253, 0x3b124925, v161
    v_fma_f32 v253, -v10, v10, v253
    v_mfma_f32_32x32x16_bf16 v[144:159], v[124:127], a[28:31], v[144:159]
    v_max_f32 v253, 0, v253
    v_add_f32 v253, 0x3727c5ac, v253
    v_rsq_f32 v253, v253
    v_sub_f32 v11, 0, v10
    v_cndmask_b32 v11, v11, 0, s[50:51]
    v_cvt_pk_bf16_f32 v241, v11, 0
    v_lshlrev_b32 v240, 16, v241
    v_sub_f32 v240, v11, v240
    v_cvt_pk_bf16_f32 v240, v11, v240
    v_mov_b32 v242, 0
    v_mov_b32 v243, 0
    ds_write_b32 v212, v253
    s_waitcnt lgkmcnt(1)
    v_add_f32 v180, v180, v181
    v_add_f32 v182, v182, v183
    v_add_f32 v180, v180, v182
    v_cvt_pk_bf16_f32 v232, v180, v180
    v_and_b32 v233, 0xffff0000, v232
    v_sub_f32 v233, v180, v233
    v_cvt_pk_bf16_f32 v233, v233, 0
    v_mov_b32 v234, 0
    v_mov_b32 v235, 0
    v_add_f32 v184, v184, v185
    v_add_f32 v186, v186, v187
    v_add_f32 v184, v184, v186
    v_cvt_pk_bf16_f32 v236, v184, v184
    v_and_b32 v237, 0xffff0000, v236
    v_sub_f32 v237, v184, v237
    v_cvt_pk_bf16_f32 v237, v237, 0
    v_mov_b32 v238, 0
    v_mov_b32 v239, 0
    s_waitcnt lgkmcnt(0)
    ds_read_b128 v[214:217], v213 offset:0
    ds_read_b128 v[218:221], v213 offset:32
    ds_read_b128 v[222:225], v213 offset:64
    ds_read_b128 v[226:229], v213 offset:96
    v_mfma_f32_32x32x16_bf16 v[128:143], v[240:243], v[232:235], v[128:143]
    v_mfma_f32_32x32x16_bf16 v[144:159], v[240:243], v[236:239], v[144:159]
    s_waitcnt lgkmcnt(0)
    s_nop 9
    v_pk_mul_f32 v[128:129], v[128:129], v[214:215]
    v_pk_mul_f32 v[130:131], v[130:131], v[216:217]
    v_pk_mul_f32 v[132:133], v[132:133], v[218:219]
    v_pk_mul_f32 v[134:135], v[134:135], v[220:221]
    v_cvt_pk_bf16_f32 v160, v128, v129
    v_cvt_pk_bf16_f32 v161, v130, v131
    v_cvt_pk_bf16_f32 v162, v132, v133
    v_cvt_pk_bf16_f32 v163, v134, v135
    buffer_store_dwordx4 v[160:163], v210, s[28:31], s64 offen offset:0 sc1
    v_pk_mul_f32 v[136:137], v[136:137], v[222:223]
    v_pk_mul_f32 v[138:139], v[138:139], v[224:225]
    v_pk_mul_f32 v[140:141], v[140:141], v[226:227]
    v_pk_mul_f32 v[142:143], v[142:143], v[228:229]
    v_cvt_pk_bf16_f32 v164, v136, v137
    v_cvt_pk_bf16_f32 v165, v138, v139
    v_cvt_pk_bf16_f32 v166, v140, v141
    v_cvt_pk_bf16_f32 v167, v142, v143
    buffer_store_dwordx4 v[164:167], v210, s[28:31], s64 offen offset:896 sc1
    v_pk_mul_f32 v[144:145], v[144:145], v[214:215]
    v_pk_mul_f32 v[146:147], v[146:147], v[216:217]
    v_pk_mul_f32 v[148:149], v[148:149], v[218:219]
    v_pk_mul_f32 v[150:151], v[150:151], v[220:221]
    v_cvt_pk_bf16_f32 v168, v144, v145
    v_cvt_pk_bf16_f32 v169, v146, v147
    v_cvt_pk_bf16_f32 v170, v148, v149
    v_cvt_pk_bf16_f32 v171, v150, v151
    buffer_store_dwordx4 v[168:171], v211, s[28:31], s64 offen offset:0 sc1
    v_pk_mul_f32 v[152:153], v[152:153], v[222:223]
    v_pk_mul_f32 v[154:155], v[154:155], v[224:225]
    v_pk_mul_f32 v[156:157], v[156:157], v[226:227]
    v_pk_mul_f32 v[158:159], v[158:159], v[228:229]
    v_cvt_pk_bf16_f32 v172, v152, v153
    v_cvt_pk_bf16_f32 v173, v154, v155
    v_cvt_pk_bf16_f32 v174, v156, v157
    v_cvt_pk_bf16_f32 v175, v158, v159
    buffer_store_dwordx4 v[172:175], v211, s[28:31], s64 offen offset:896 sc1
    s_branch L_p1_join
    s_branch L_pg2
    .p2align 12
L_stub2:
    s_setpc_b64 s[70:71]
L_pg2:
L_p1_N:
    s_waitcnt vmcnt(7)
    ds_read_b128 v[16:19], v192 offset:0
    ds_read_b128 v[20:23], v193 offset:0
    ds_read_b128 v[24:27], v194 offset:0
    ds_read_b128 v[28:31], v195 offset:0
    s_add_u32 m0, s66, 8192
    s_lshl_b32 s62, s67, 7
    buffer_load_dwordx4 v188, s[32:35], s62 offen offset:0 lds
    buffer_load_dwordx4 v189, s[32:35], s62 offen offset:1024 lds
    buffer_load_dwordx4 v190, s[32:35], s62 offen offset:2048 lds
    buffer_load_dwordx4 v191, s[32:35], s62 offen offset:3072 lds
    s_add_u32 s67, s67, 1
    s_cmp_eq_u32 s67, 7
    s_cselect_b32 s67, 0, s67
    s_waitcnt lgkmcnt(0)
    v_mfma_f32_32x32x16_bf16 v[160:175], v[16:19], v[16:19], 0
    v_mfma_f32_16x16x32_bf16 v[176:179], a[252:255], v[16:19], 0
    s_waitcnt vmcnt(5)
    ds_read_b128 v[32:35], v192 offset:4096
    v_mfma_f32_32x32x16_bf16 v[160:175], v[20:23], v[20:23], v[160:175]
    ds_read_b128 v[36:39], v193 offset:4096
    ds_read_b128 v[40:43], v194 offset:4096
    v_mfma_f32_16x16x32_bf16 v[176:179], a[252:255], v[20:23], v[176:179]
    ds_read_b128 v[44:47], v195 offset:4096
    s_add_u32 m0, s66, 0
    s_lshl_b32 s62, s67, 7
    buffer_load_dwordx4 v188, s[32:35], s62 offen offset:0 lds
    v_mfma_f32_32x32x16_bf16 v[160:175], v[24:27], v[24:27], v[160:175]
    buffer_load_dwordx4 v189, s[32:35], s62 offen offset:1024 lds
    buffer_load_dwordx4 v190, s[32:35], s62 offen offset:2048 lds
    v_mfma_f32_16x16x32_bf16 v[176:179], a[252:255], v[24:27], v[176:179]
    buffer_load_dwordx4 v191, s[32:35], s62 offen offset:3072 lds
    s_add_u32 s67, s67, 1
    s_cmp_eq_u32 s67, 7
    s_cselect_b32 s67, 0, s67
    v_mfma_f32_32x32x16_bf16 v[160:175], v[28:31], v[28:31], v[160:175]
    v_mfma_f32_16x16x32_bf16 v[176:179], a[252:255], v[28:31], v[176:179]
    s_waitcnt lgkmcnt(0)
    v_mfma_f32_32x32x16_bf16 v[160:175], v[32:35], v[32:35], v[160:175]
    v_mfma_f32_16x16x32_bf16 v[176:179], a[252:255], v[32:35], v[176:179]
    s_waitcnt vmcnt(4)
    ds_read_b128 v[48:51], v192 offset:8192
    v_mfma_f32_32x32x16_bf16 v[160:175], v[36:39], v[36:39], v[160:175]
    ds_read_b128 v[52:55], v193 offset:8192
    ds_read_b128 v[56:59], v194 offset:8192
    v_mfma_f32_16x16x32_bf16 v[176:179], a[252:255], v[36:39], v[176:179]
    ds_read_b128 v[60:63], v195 offset:8192
    s_add_u32 m0, s66, 4096
    s_lshl_b32 s62, s67, 7
    buffer_load_dwordx4 v188, s[32:35], s62 offen offset:0 lds
    v_mfma_f32_32x32x16_bf16 v[160:175], v[40:43], v[40:43], v[160:175]
    buffer_load_dwordx4 v189, s[32:35], s62 offen offset:1024 lds
    buffer_load_dwordx4 v190, s[32:35], s62 offen offset:2048 lds
    v_mfma_f32_16x16x32_bf16 v[176:179], a[252:255], v[40:43], v[176:179]
    buffer_load_dwordx4 v191, s[32:35], s62 offen offset:3072 lds
    s_add_u32 s67, s67, 1
    s_cmp_eq_u32 s67, 7
    s_cselect_b32 s67, 0, s67
    v_mfma_f32_32x32x16_bf16 v[160:175], v[44:47], v[44:47], v[160:175]
    v_mfma_f32_16x16x32_bf16 v[176:179], a[252:255], v[44:47], v[176:179]
    s_waitcnt lgkmcnt(0)
    v_mfma_f32_32x32x16_bf16 v[160:175], v[48:51], v[48:51], v[160:175]
    v_mfma_f32_16x16x32_bf16 v[176:179], a[252:255], v[48:51], v[176:179]
    s_waitcnt vmcnt(4)
    ds_read_b128 v[64:67], v192 offset:0
    v_mfma_f32_32x32x16_bf16 v[160:175], v[52:55], v[52:55], v[160:175]
    ds_read_b128 v[68:71], v193 offset:0
    ds_read_b128 v[72:75], v194 offset:0
    v_mfma_f32_16x16x32_bf16 v[176:179], a[252:255], v[52:55], v[176:179]
    ds_read_b128 v[76:79], v195 offset:0
    v_mov_b32 v208, 0
    buffer_load_dwordx2 v[208:209], v208, s[40:43], 0 offen offset:0 sc1
    v_mfma_f32_32x32x16_bf16 v[160:175], v[56:59], v[56:59], v[160:175]
    s_add_u32 m0, s66, 8192
    s_lshl_b32 s62, s67, 7
    buffer_load_dwordx4 v188, s[32:35], s62 offen offset:0 lds
    buffer_load_dwordx4 v189, s[32:35], s62 offen offset:1024 lds
    v_mfma_f32_16x16x32_bf16 v[176:179], a[252:255], v[56:59], v[176:179]
    buffer_load_dwordx4 v190, s[32:35], s62 offen offset:2048 lds
    buffer_load_dwordx4 v191, s[32:35], s62 offen offset:3072 lds
    v_mfma_f32_32x32x16_bf16 v[160:175], v[60:63], v[60:63], v[160:175]
    s_add_u32 s67, s67, 1
    s_cmp_eq_u32 s67, 7
    s_cselect_b32 s67, 0, s67
    v_mfma_f32_16x16x32_bf16 v[176:179], a[252:255], v[60:63], v[176:179]
    s_waitcnt lgkmcnt(0)
    v_mfma_f32_32x32x16_bf16 v[160:175], v[64:67], v[64:67], v[160:175]
    v_mfma_f32_16x16x32_bf16 v[176:179], a[252:255], v[64:67], v[176:179]
    s_waitcnt vmcnt(5)
    ds_read_b128 v[80:83], v192 offset:4096
    v_mfma_f32_32x32x16_bf16 v[160:175], v[68:71], v[68:71], v[160:175]
    ds_read_b128 v[84:87], v193 offset:4096
    ds_read_b128 v[88:91], v194 offset:4096
    v_mfma_f32_16x16x32_bf16 v[176:179], a[252:255], v[68:71], v[176:179]
    ds_read_b128 v[92:95], v195 offset:4096
    s_add_u32 m0, s66, 0
    s_lshl_b32 s62, s67, 7
    buffer_load_dwordx4 v188, s[32:35], s62 offen offset:0 lds
    v_mfma_f32_32x32x16_bf16 v[160:175], v[72:75], v[72:75], v[160:175]
    buffer_load_dwordx4 v189, s[32:35], s62 offen offset:1024 lds
    buffer_load_dwordx4 v190, s[32:35], s62 offen offset:2048 lds
    v_mfma_f32_16x16x32_bf16 v[176:179], a[252:255], v[72:75], v[176:179]
    buffer_load_dwordx4 v191, s[32:35], s62 offen offset:3072 lds
    s_add_u32 s67, s67, 1
    s_cmp_eq_u32 s67, 7
    s_cselect_b32 s67, 0, s67
    v_mfma_f32_32x32x16_bf16 v[160:175], v[76:79], v[76:79], v[160:175]
    v_mfma_f32_16x16x32_bf16 v[176:179], a[252:255], v[76:79], v[176:179]
    s_waitcnt lgkmcnt(0)
    v_mfma_f32_32x32x16_bf16 v[160:175], v[80:83], v[80:83], v[160:175]
    v_mfma_f32_16x16x32_bf16 v[176:179], a[252:255], v[80:83], v[176:179]
    s_waitcnt vmcnt(4)
    ds_read_b128 v[96:99], v192 offset:8192
    v_mfma_f32_32x32x16_bf16 v[160:175], v[84:87], v[84:87], v[160:175]
    ds_read_b128 v[100:103], v193 offset:8192
    ds_read_b128 v[104:107], v194 offset:8192
    v_mfma_f32_16x16x32_bf16 v[176:179], a[252:255], v[84:87], v[176:179]
    ds_read_b128 v[108:111], v195 offset:8192
    s_add_u32 m0, s82, 106496
    s_mul_i32 s62, s67, 172032
    buffer_load_dwordx4 v206, s[36:39], s62 offen offset:0 lds
    s_add_u32 s67, s67, 1
    s_cmp_eq_u32 s67, 7
    s_cselect_b32 s67, 0, s67
    v_mfma_f32_32x32x16_bf16 v[160:175], v[88:91], v[88:91], v[160:175]
    s_add_u32 m0, s82, 110592
    s_mul_i32 s62, s67, 172032
    buffer_load_dwordx4 v206, s[36:39], s62 offen offset:0 lds
    s_add_u32 s67, s67, 1
    s_cmp_eq_u32 s67, 7
    s_cselect_b32 s67, 0, s67
    s_add_u32 m0, s82, 114688
    s_mul_i32 s62, s67, 172032
    buffer_load_dwordx4 v206, s[36:39], s62 offen offset:0 lds
    s_add_u32 s67, s67, 1
    s_cmp_eq_u32 s67, 7
    s_cselect_b32 s67, 0, s67
    v_mfma_f32_16x16x32_bf16 v[176:179], a[252:255], v[88:91], v[176:179]
    s_add_u32 m0, s82, 118784
    s_mul_i32 s62, s67, 172032
    buffer_load_dwordx4 v206, s[36:39], s62 offen offset:0 lds
    s_add_u32 s67, s67, 1
    s_cmp_eq_u32 s67, 7
    s_cselect_b32 s67, 0, s67
    v_mfma_f32_32x32x16_bf16 v[160:175], v[92:95], v[92:95], v[160:175]
    v_mfma_f32_16x16x32_bf16 v[176:179], a[252:255], v[92:95], v[176:179]
    s_waitcnt lgkmcnt(0)
    v_mfma_f32_32x32x16_bf16 v[160:175], v[96:99], v[96:99], v[160:175]
    v_mfma_f32_16x16x32_bf16 v[176:179], a[252:255], v[96:99], v[176:179]
    s_waitcnt vmcnt(4)
    ds_read_b128 v[112:115], v192 offset:0
    v_mfma_f32_32x32x16_bf16 v[160:175], v[100:103], v[100:103], v[160:175]
    ds_read_b128 v[116:119], v193 offset:0
    ds_read_b128 v[120:123], v194 offset:0
    v_mfma_f32_16x16x32_bf16 v[176:179], a[252:255], v[100:103], v[176:179]
    ds_read_b128 v[124:127], v195 offset:0
    s_add_u32 m0, s82, 122880
    s_mul_i32 s62, s67, 172032
    buffer_load_dwordx4 v206, s[36:39], s62 offen offset:0 lds
    s_add_u32 s67, s67, 1
    s_cmp_eq_u32 s67, 7
    s_cselect_b32 s67, 0, s67
    v_mfma_f32_32x32x16_bf16 v[160:175], v[104:107], v[104:107], v[160:175]
    s_add_u32 m0, s82, 126976
    s_mul_i32 s62, s67, 172032
    buffer_load_dwordx4 v206, s[36:39], s62 offen offset:0 lds
    s_add_u32 s67, s67, 1
    s_cmp_eq_u32 s67, 7
    s_cselect_b32 s67, 0, s67
    s_add_u32 m0, s82, 131072
    s_mul_i32 s62, s67, 172032
    buffer_load_dwordx4 v206, s[36:39], s62 offen offset:0 lds
    s_add_u32 s67, s67, 1
    s_cmp_eq_u32 s67, 7
    s_cselect_b32 s67, 0, s67
    v_mfma_f32_16x16x32_bf16 v[176:179], a[252:255], v[104:107], v[176:179]
    v_mfma_f32_32x32x16_bf16 v[160:175], v[108:111], v[108:111], v[160:175]
    v_mfma_f32_16x16x32_bf16 v[176:179], a[252:255], v[108:111], v[176:179]
    s_waitcnt lgkmcnt(0)
    v_mfma_f32_32x32x16_bf16 v[160:175], v[112:115], v[112:115], v[160:175]
    v_mfma_f32_16x16x32_bf16 v[176:179], a[252:255], v[112:115], v[176:179]
    v_mfma_f32_32x32x16_bf16 v[160:175], v[116:119], v[116:119], v[160:175]
    v_mfma_f32_16x16x32_bf16 v[176:179], a[252:255], v[116:119], v[176:179]
    v_mfma_f32_32x32x16_bf16 v[160:175], v[120:123], v[120:123], v[160:175]
    v_mfma_f32_16x16x32_bf16 v[176:179], a[252:255], v[120:123], v[176:179]
    v_mfma_f32_32x32x16_bf16 v[160:175], v[124:127], v[124:127], v[160:175]
    v_mfma_f32_16x16x32_bf16 v[176:179], a[252:255], v[124:127], v[176:179]
    s_mov_b32 vcc_lo, 0xaaaaaaaa
    s_mov_b32 vcc_hi, 0xaaaaaaaa
    s_nop 8
    v_cndmask_b32 v160, v160, v161, vcc
    v_cndmask_b32 v161, v162, v163, vcc
    v_cndmask_b32 v162, v164, v165, vcc
    v_cndmask_b32 v163, v166, v167, vcc
    v_cndmask_b32 v164, v168, v169, vcc
    v_cndmask_b32 v165, v170, v171, vcc
    v_cndmask_b32 v166, v172, v173, vcc
    v_cndmask_b32 v167, v174, v175, vcc
    s_mov_b32 vcc_lo, 0xcccccccc
    s_mov_b32 vcc_hi, 0xcccccccc
    v_cndmask_b32 v160, v160, v161, vcc
    v_cndmask_b32 v161, v162, v163, vcc
    v_cndmask_b32 v162, v164, v165, vcc
    v_cndmask_b32 v163, v166, v167, vcc
    s_mov_b32 vcc_lo, 0xff00ff00
    s_mov_b32 vcc_hi, 0xff00ff00
    v_cndmask_b32 v160, v160, v161, vcc
    v_cndmask_b32 v161, v162, v163, vcc
    s_mov_b32 vcc_lo, 0xffff0000
    s_mov_b32 vcc_hi, 0xffff0000
    v_cndmask_b32 v160, v160, v161, vcc
    v_mov_b32 v161, v160
    s_mov_b32 vcc_lo, 0xf0f0f0f0
    s_mov_b32 vcc_hi, 0xf0f0f0f0
    v_permlane32_swap_b32 v160, v161
    v_cndmask_b32 v9, v160, v161, vcc
    v_mul_f32 v10, 0x3b124925, v176
    v_mul_f32 v253, 0x3b124925, v9
    v_fma_f32 v253, -v10, v10, v253
    v_max_f32 v253, 0, v253
    v_add_f32 v253, 0x3727c5ac, v253
    v_rsq_f32 v253, v253
    v_sub_f32 v11, 0, v10
    v_cndmask_b32 v11, v11, 0, s[50:51]
    v_cvt_pk_bf16_f32 v241, v11, 0
    v_lshlrev_b32 v240, 16, v241
    v_sub_f32 v240, v11, v240
    v_cvt_pk_bf16_f32 v240, v11, v240
    v_mov_b32 v242, 0
    v_mov_b32 v243, 0
    s_lshl_b32 s62, s27, 1
    s_add_u32 s62, s62, s44
    s_sub_u32 s62, s62, 14
    s_lshl_b32 s62, s62, 2
    s_add_u32 s62, s62, s26
    s_mov_b32 s32, s8
    s_mov_b32 s33, s9
    s_mov_b32 s34, 0x62000
    s_mov_b32 s35, 0x20000
    s_lshl_b32 s63, s62, 12
    buffer_load_dwordx4 a[64:67], v3, s[32:35], s63 offen offset:0
    buffer_load_dwordx4 a[68:71], v3, s[32:35], s63 offen offset:1024
    buffer_load_dwordx4 a[72:75], v3, s[32:35], s63 offen offset:2048
    buffer_load_dwordx4 a[76:79], v3, s[32:35], s63 offen offset:3072
    s_mov_b32 s32, s12
    s_mov_b32 s33, s13
    s_mov_b32 s34, 0x188000
    s_mov_b32 s35, 0x20000
    s_mul_i32 s63, s62, 13312
    buffer_load_dwordx4 a[80:83], v3, s[32:35], s63 offen offset:0
    buffer_load_dwordx4 a[84:87], v3, s[32:35], s63 offen offset:1024
    buffer_load_dwordx4 a[88:91], v3, s[32:35], s63 offen offset:2048
    buffer_load_dwordx4 a[92:95], v3, s[32:35], s63 offen offset:3072
    s_add_u32 s63, s63, 4096
    buffer_load_dwordx4 a[96:99], v3, s[32:35], s63 offen offset:0
    buffer_load_dwordx4 a[100:103], v3, s[32:35], s63 offen offset:1024
    buffer_load_dwordx4 a[104:107], v3, s[32:35], s63 offen offset:2048
    buffer_load_dwordx4 a[108:111], v3, s[32:35], s63 offen offset:3072
    s_add_u32 s63, s63, 4096
    buffer_load_dwordx4 a[112:115], v3, s[32:35], s63 offen offset:0
    buffer_load_dwordx4 a[116:119], v3, s[32:35], s63 offen offset:1024
    buffer_load_dwordx4 a[120:123], v3, s[32:35], s63 offen offset:2048
    buffer_load_dwordx4 a[124:127], v3, s[32:35], s63 offen offset:3072
    s_add_u32 s63, s63, 4096
    buffer_load_dwordx4 a[128:131], v3, s[32:35], s63 offen offset:0
L_p1_join:
    s_mov_b32 s84, s4
    s_mov_b32 s85, s5
    s_mov_b32 s86, 0x1c0000
    s_mov_b32 s87, 0x20000
    s_mov_b32 s88, s16
    s_mov_b32 s89, s17
    s_mov_b32 s90, 0x1000
    s_mov_b32 s91, 0x20000
    s_mov_b32 s92, s14
    s_mov_b32 s93, s15
    s_mov_b32 s94, 0x800000
    s_mov_b32 s95, 0x20000
    s_mov_b32 s96, s18
    s_mov_b32 s97, s19
    s_mov_b32 s98, 0xc4000
    s_mov_b32 s99, 0x20000
    s_mul_i32 s62, s57, 28672
    s_lshl_b32 s63, s55, 7
    s_add_u32 s62, s62, s63
    s_lshl_b32 s63, s56, 6
    s_add_u32 s62, s62, s63
    v_mul_u32_u24 v224, 896, v2
    v_lshl_add_u32 v224, v1, 4, v224
    v_add_u32 v224, s62, v224
    s_lshl_b32 s62, s54, 6
    v_lshl_add_u32 v252, v2, 1, s62
    s_lshl_b32 s62, s44, 2
    s_add_u32 s62, s62, s26
    s_lshl_b32 s62, s62, 13
    s_lshl_b32 s63, s27, 19
    s_add_u32 s62, s62, s63
    v_add_u32 v225, s62, v3
    s_lshl_b32 s62, s76, 2
    s_add_u32 s62, s62, s26
    s_lshl_b32 s82, s62, 10
    s_movk_i32 s101, 4096
    s_lshl_b32 s62, s54, 15
    s_lshl_b32 s63, s44, 11
    s_add_u32 s64, s62, s63
    s_add_u32 s73, s64, 6291456
    s_lshl_b32 s62, s54, 13
    s_lshl_b32 s63, s44, 9
    s_add_u32 s62, s62, s63
    s_add_u32 s62, s62, 1048064
    s_lshl_b32 s63, s27, 7
    v_and_b32 v222, 3, v0
    v_lshlrev_b32 v222, 12, v222
    v_add_u32 v222, 4096, v222
    v_add_u32 v222, s63, v222
    v_add_u32 v223, s62, v3
    v_cndmask_b32 v222, v222, v223, s[50:51]
    buffer_load_dword a208, v222, s[28:31], 0 offen offset:0 sc1
    buffer_load_dwordx4 a[216:219], v225, s[92:95], 0 offen offset:0
    buffer_load_dwordx4 a[220:223], v225, s[92:95], 0 offen offset:1024
    buffer_load_dwordx4 a[224:227], v225, s[92:95], 0 offen offset:2048
    buffer_load_dwordx4 a[228:231], v225, s[92:95], 0 offen offset:3072
    s_mov_b32 s72, 0
    s_lshl_b32 s67, s77, 3
    s_add_u32 s67, s67, 32768
    s_waitcnt vmcnt(5)
L_tag_11:
    v_readfirstlane_b32 s46, v208
    v_readfirstlane_b32 s47, v209
    s_nop 1
    s_cmp_lg_u32 s47, 0
    s_cbranch_scc1 L_tag_11_d
    v_mov_b32 v7, 0
    buffer_load_dwordx2 v[208:209], v7, s[40:43], 0 offen sc1
    s_add_u32 s72, s72, 1
    s_waitcnt vmcnt(0)
    s_cmp_lt_u32 s72, 100000
    s_cbranch_scc1 L_tag_11
L_tag_11_d:
    s_or_b32 s62, s46, s45
    v_mov_b32 v8, s62
    v_mov_b32 v9, s47
    s_cmp_eq_u32 s26, 0
    s_barrier
    s_cbranch_scc0 L_pub_12
    s_mov_b64 exec, 15
    buffer_store_dwordx4 v[8:11], v3, s[28:31], s67 offen sc1
    s_mov_b64 exec, -1
L_pub_12:
    s_lshl_b32 s62, s76, 10
    s_add_u32 s62, s62, 262144
    v_mov_b32 v214, s52
    v_mov_b32 v215, s52
    v_mov_b32 v216, s52
    v_mov_b32 v217, s52
    buffer_store_dwordx4 v[214:217], v3, s[28:31], s62 offen offset:0 sc1
    v_bfe_u32 v7, v0, 2, 2
    v_lshl_add_u32 v7, v1, 3, v7
    v_lshlrev_b32 v7, 6, v7
    v_bfe_u32 v8, v0, 4, 1
    v_lshl_add_u32 v7, v8, 5, v7
    v_and_b32 v8, 1, v0
    v_lshl_add_u32 v7, v8, 4, v7
    v_bfe_u32 v8, v0, 1, 1
    v_lshl_add_u32 v7, v8, 3, v7
    s_xor_b32 s62, s26, 0
    s_lshl_b32 s62, s62, 10
    s_add_u32 s62, s62, 106496
    v_add_u32 v198, s62, v7
    s_xor_b32 s62, s26, 1
    s_lshl_b32 s62, s62, 10
    s_add_u32 s62, s62, 106496
    v_add_u32 v199, s62, v7
    s_xor_b32 s62, s26, 2
    s_lshl_b32 s62, s62, 10
    s_add_u32 s62, s62, 106496
    v_add_u32 v200, s62, v7
    s_xor_b32 s62, s26, 3
    s_lshl_b32 s62, s62, 10
    s_add_u32 s62, s62, 106496
    v_add_u32 v201, s62, v7
    ds_read_b64_tr_b16 a[0:1], v198 offset:0
    ds_read_b64_tr_b16 a[2:3], v198 offset:256
    ds_read_b64_tr_b16 a[4:5], v199 offset:0
    ds_read_b64_tr_b16 a[6:7], v199 offset:256
    ds_read_b64_tr_b16 a[8:9], v200 offset:0
    ds_read_b64_tr_b16 a[10:11], v200 offset:256
    ds_read_b64_tr_b16 a[12:13], v201 offset:0
    ds_read_b64_tr_b16 a[14:15], v201 offset:256
    s_waitcnt lgkmcnt(6)
    v_mfma_f32_32x32x16_bf16 v[128:143], a[0:3], v[16:19], 0
    ds_read_b64_tr_b16 a[16:17], v198 offset:4096
    ds_read_b64_tr_b16 a[18:19], v198 offset:4352
    s_lshr_b32 s62, s44, 1
    s_mul_i32 s66, s62, 229376
    s_and_b32 s62, s44, 1
    v_mfma_f32_16x16x32_bf16 v[176:179], a[252:255], a[0:3], 0
    buffer_load_dwordx4 a[232:235], v225, s[92:95], s101 offen offset:0
    s_mul_i32 s62, s62, 1536
    s_add_u32 s66, s66, s62
    s_waitcnt lgkmcnt(6)
    v_mfma_f32_32x32x16_bf16 v[128:143], a[4:7], v[20:23], v[128:143]
    ds_read_b64_tr_b16 a[20:21], v199 offset:4096
    ds_read_b64_tr_b16 a[22:23], v199 offset:4352
    s_add_u32 s66, s66, 2097152
    s_mul_i32 s63, s44, 114688
    s_add_u32 s63, s63, 4194304
    v_mfma_f32_16x16x32_bf16 v[176:179], a[252:255], a[4:7], v[176:179]
    buffer_load_dwordx4 a[236:239], v225, s[92:95], s101 offen offset:1024
    s_mul_i32 s62, s26, 57344
    s_add_u32 s66, s66, s62
    s_waitcnt lgkmcnt(6)
    v_mfma_f32_32x32x16_bf16 v[128:143], a[8:11], v[24:27], v[128:143]
    ds_read_b64_tr_b16 a[24:25], v200 offset:4096
    ds_read_b64_tr_b16 a[26:27], v200 offset:4352
    s_mul_i32 s62, s26, 28672
    s_add_u32 s63, s63, s62
    v_mul_u32_u24 v7, 448, v1
    v_mfma_f32_16x16x32_bf16 v[176:179], a[252:255], a[8:11], v[176:179]
    buffer_load_dwordx4 a[240:243], v225, s[92:95], s101 offen offset:2048
    v_lshl_add_u32 v7, v6, 4, v7
    v_add_u32 v7, s63, v7
    s_waitcnt lgkmcnt(6)
    v_mfma_f32_32x32x16_bf16 v[128:143], a[12:15], v[28:31], v[128:143]
    ds_read_b64_tr_b16 a[28:29], v201 offset:4096
    ds_read_b64_tr_b16 a[30:31], v201 offset:4352
    s_lshl_b32 s62, s76, 10
    s_add_u32 s62, s62, 262144
    v_mov_b32 v8, s62
    v_mfma_f32_16x16x32_bf16 v[176:179], a[252:255], a[12:15], v[176:179]
    buffer_load_dwordx4 a[244:247], v225, s[92:95], s101 offen offset:3072
    v_cmp_lt_u32 vcc, 28, v2
    v_mov_b32 v9, 0x7ff00000
    s_waitcnt lgkmcnt(6)
    v_mfma_f32_32x32x16_bf16 v[128:143], a[16:19], v[32:35], v[128:143]
    ds_read_b64_tr_b16 a[0:1], v198 offset:8192
    ds_read_b64_tr_b16 a[2:3], v198 offset:8448
    v_cndmask_b32 v8, v8, v9, vcc
    v_mov_b32 v9, 1792
    v_cmp_gt_u32 vcc, 28, v2
    v_mfma_f32_16x16x32_bf16 v[176:179], a[252:255], a[16:19], v[176:179]
    buffer_load_dwordx4 a[248:251], v3, s[96:99], s82 offen offset:0
    v_cndmask_b32 v217, v8, v7, vcc
    v_cndmask_b32 v218, 0, v9, vcc
    s_waitcnt lgkmcnt(6)
    v_mfma_f32_32x32x16_bf16 v[128:143], a[20:23], v[36:39], v[128:143]
    ds_read_b64_tr_b16 a[4:5], v199 offset:8192
    ds_read_b64_tr_b16 a[6:7], v199 offset:8448
    s_mov_b32 s32, s8
    s_mov_b32 s33, s9
    s_mov_b32 s34, 0x62000
    v_mfma_f32_16x16x32_bf16 v[176:179], a[252:255], a[20:23], v[176:179]
    buffer_load_dwordx4 v[244:247], v224, s[84:87], 0 offen offset:0
    s_mov_b32 s35, 0x20000
    s_mov_b32 s36, s12
    s_waitcnt lgkmcnt(6)
    v_mfma_f32_32x32x16_bf16 v[128:143], a[24:27], v[40:43], v[128:143]
    ds_read_b64_tr_b16 a[8:9], v200 offset:8192
    ds_read_b64_tr_b16 a[10:11], v200 offset:8448
    s_mov_b32 s37, s13
    s_mov_b32 s38, 0x188000
    s_mov_b32 s39, 0x20000
    v_mfma_f32_16x16x32_bf16 v[176:179], a[252:255], a[24:27], v[176:179]
    buffer_load_dwordx4 v[248:251], v224, s[84:87], 0 offen offset:32
    s_lshl_b32 s64, s55, 7
    v_lshrrev_b32 v220, 3, v0
    s_waitcnt lgkmcnt(6)
    v_mfma_f32_32x32x16_bf16 v[128:143], a[28:31], v[44:47], v[128:143]
    ds_read_b64_tr_b16 a[12:13], v201 offset:8192
    ds_read_b64_tr_b16 a[14:15], v201 offset:8448
    v_mul_u32_u24 v220, 896, v220
    v_bfe_u32 v221, v0, 4, 1
    v_lshlrev_b32 v221, 2, v221
    v_mfma_f32_16x16x32_bf16 v[176:179], a[252:255], a[28:31], v[176:179]
    buffer_load_ushort v252, v252, s[88:91], 0 offen
    v_xor_b32 v221, v221, v0
    v_and_b32 v221, 7, v221
    s_waitcnt lgkmcnt(6)
    v_mfma_f32_32x32x16_bf16 v[128:143], a[0:3], v[48:51], v[128:143]
    ds_read_b64_tr_b16 a[16:17], v198 offset:12288
    ds_read_b64_tr_b16 a[18:19], v198 offset:12544
    v_lshl_add_u32 v220, v221, 4, v220
    s_mul_i32 s62, s26, 100352
    s_add_u32 s62, s62, s64
    v_mfma_f32_16x16x32_bf16 v[176:179], a[252:255], a[0:3], v[176:179]
    v_add_u32 v220, s62, v220
    v_add_u32 v221, 6144, v220
    s_waitcnt lgkmcnt(6)
    v_mfma_f32_32x32x16_bf16 v[128:143], a[4:7], v[52:55], v[128:143]
    ds_read_b64_tr_b16 a[20:21], v199 offset:12288
    ds_read_b64_tr_b16 a[22:23], v199 offset:12544
    s_lshl_b32 s64, s44, 7
    s_add_u32 s64, s64, 1792
    v_lshrrev_b32 v222, 3, v0
    v_mfma_f32_16x16x32_bf16 v[176:179], a[252:255], a[4:7], v[176:179]
    v_mul_u32_u24 v222, 3584, v222
    v_bfe_u32 v223, v0, 4, 1
    s_waitcnt lgkmcnt(6)
    v_mfma_f32_32x32x16_bf16 v[128:143], a[8:11], v[56:59], v[128:143]
    ds_read_b64_tr_b16 a[24:25], v200 offset:12288
    ds_read_b64_tr_b16 a[26:27], v200 offset:12544
    v_lshlrev_b32 v223, 2, v223
    v_xor_b32 v223, v223, v0
    v_and_b32 v223, 7, v223
    v_mfma_f32_16x16x32_bf16 v[176:179], a[252:255], a[8:11], v[176:179]
    v_lshl_add_u32 v222, v223, 4, v222
    s_mul_i32 s62, s26, 401408
    s_waitcnt lgkmcnt(6)
    v_mfma_f32_32x32x16_bf16 v[128:143], a[12:15], v[60:63], v[128:143]
    ds_read_b64_tr_b16 a[28:29], v201 offset:12288
    ds_read_b64_tr_b16 a[30:31], v201 offset:12544
    s_add_u32 s62, s62, s64
    v_add_u32 v222, s62, v222
    v_add_u32 v223, 27648, v222
    v_mfma_f32_16x16x32_bf16 v[176:179], a[252:255], a[12:15], v[176:179]
    s_add_u32 s62, s26, 1
    s_and_b32 s62, s62, 3
    s_waitcnt lgkmcnt(6)
    v_mfma_f32_32x32x16_bf16 v[128:143], a[16:19], v[64:67], v[128:143]
    ds_read_b64_tr_b16 a[0:1], v198 offset:16384
    ds_read_b64_tr_b16 a[2:3], v198 offset:16640
    s_mul_i32 s63, s62, 12288
    s_add_u32 s63, s63, 114688
    v_add_u32 v226, s63, v3
    v_mfma_f32_16x16x32_bf16 v[176:179], a[252:255], a[16:19], v[176:179]
    s_lshl_b32 s62, s62, 11
    s_add_u32 s62, s62, 155648
    s_waitcnt lgkmcnt(6)
    v_mfma_f32_32x32x16_bf16 v[128:143], a[20:23], v[68:71], v[128:143]
    ds_read_b64_tr_b16 a[4:5], v199 offset:16384
    ds_read_b64_tr_b16 a[6:7], v199 offset:16640
    v_add_u32 v230, s62, v3
    s_add_u32 s62, s26, 2
    s_and_b32 s62, s62, 3
    v_mfma_f32_16x16x32_bf16 v[176:179], a[252:255], a[20:23], v[176:179]
    s_mul_i32 s63, s62, 12288
    s_add_u32 s63, s63, 118784
    s_waitcnt lgkmcnt(6)
    v_mfma_f32_32x32x16_bf16 v[128:143], a[24:27], v[72:75], v[128:143]
    ds_read_b64_tr_b16 a[8:9], v200 offset:16384
    ds_read_b64_tr_b16 a[10:11], v200 offset:16640
    v_add_u32 v227, s63, v3
    s_lshl_b32 s62, s62, 11
    s_add_u32 s62, s62, 155648
    v_mfma_f32_16x16x32_bf16 v[176:179], a[252:255], a[24:27], v[176:179]
    v_add_u32 v231, s62, v3
    s_add_u32 s62, s26, 3
    s_waitcnt lgkmcnt(6)
    v_mfma_f32_32x32x16_bf16 v[128:143], a[28:31], v[76:79], v[128:143]
    ds_read_b64_tr_b16 a[12:13], v201 offset:16384
    ds_read_b64_tr_b16 a[14:15], v201 offset:16640
    s_and_b32 s62, s62, 3
    s_mul_i32 s63, s62, 12288
    s_add_u32 s63, s63, 122880
    v_mfma_f32_16x16x32_bf16 v[176:179], a[252:255], a[28:31], v[176:179]
    v_add_u32 v228, s63, v3
    s_lshl_b32 s62, s62, 11
    s_waitcnt lgkmcnt(6)
    v_mfma_f32_32x32x16_bf16 v[128:143], a[0:3], v[80:83], v[128:143]
    ds_read_b64_tr_b16 a[16:17], v198 offset:20480
    ds_read_b64_tr_b16 a[18:19], v198 offset:20736
    s_add_u32 s62, s62, 155648
    v_add_u32 v232, s62, v3
    s_add_u32 s62, s26, 4
    v_mfma_f32_16x16x32_bf16 v[176:179], a[252:255], a[0:3], v[176:179]
    s_and_b32 s62, s62, 3
    s_mul_i32 s63, s62, 12288
    s_waitcnt lgkmcnt(6)
    v_mfma_f32_32x32x16_bf16 v[128:143], a[4:7], v[84:87], v[128:143]
    ds_read_b64_tr_b16 a[20:21], v199 offset:20480
    ds_read_b64_tr_b16 a[22:23], v199 offset:20736
    s_add_u32 s63, s63, 114688
    v_add_u32 v229, s63, v3
    s_lshl_b32 s62, s62, 11
    v_mfma_f32_16x16x32_bf16 v[176:179], a[252:255], a[4:7], v[176:179]
    s_add_u32 s62, s62, 155648
    v_add_u32 v233, s62, v3
    s_waitcnt lgkmcnt(6)
    v_mfma_f32_32x32x16_bf16 v[128:143], a[8:11], v[88:91], v[128:143]
    ds_read_b64_tr_b16 a[24:25], v200 offset:20480
    ds_read_b64_tr_b16 a[26:27], v200 offset:20736
    s_lshl_b32 s62, s54, 17
    s_mul_i32 s100, s26, 12288
    s_add_u32 s100, s100, 114688
    v_mfma_f32_16x16x32_bf16 v[176:179], a[252:255], a[8:11], v[176:179]
    v_lshrrev_b32 v7, 3, v0
    v_mul_u32_u24 v7, 4096, v7
    s_waitcnt lgkmcnt(6)
    v_mfma_f32_32x32x16_bf16 v[128:143], a[12:15], v[92:95], v[128:143]
    ds_read_b64_tr_b16 a[28:29], v201 offset:20480
    ds_read_b64_tr_b16 a[30:31], v201 offset:20736
    v_lshrrev_b32 v8, 4, v0
    v_xor_b32 v8, v8, v0
    v_and_b32 v8, 7, v8
    v_mfma_f32_16x16x32_bf16 v[176:179], a[252:255], a[12:15], v[176:179]
    v_lshl_add_u32 v7, v8, 4, v7
    v_xor_b32 v8, 64, v7
    s_waitcnt lgkmcnt(6)
    v_mfma_f32_32x32x16_bf16 v[128:143], a[16:19], v[96:99], v[128:143]
    ds_read_b64_tr_b16 a[0:1], v198 offset:24576
    ds_read_b64_tr_b16 a[2:3], v198 offset:24832
    v_add_u32 v234, s62, v7
    v_add_u32 v8, s62, v8
    v_add_u32 v235, 31744, v8
    v_mfma_f32_16x16x32_bf16 v[176:179], a[252:255], a[16:19], v[176:179]
    v_add_u32 v236, 63488, v234
    v_add_u32 v237, 95232, v8
    s_waitcnt lgkmcnt(6)
    v_mfma_f32_32x32x16_bf16 v[128:143], a[20:23], v[100:103], v[128:143]
    ds_read_b64_tr_b16 a[4:5], v199 offset:24576
    ds_read_b64_tr_b16 a[6:7], v199 offset:24832
    v_bfe_u32 v8, v2, 1, 3
    v_xor_b32 v8, v8, v1
    v_lshlrev_b32 v8, 4, v8
    v_mfma_f32_16x16x32_bf16 v[176:179], a[252:255], a[20:23], v[176:179]
    v_lshl_add_u32 v8, v2, 7, v8
    v_xor_b32 v12, 0, v8
    s_waitcnt lgkmcnt(6)
    v_mfma_f32_32x32x16_bf16 v[128:143], a[24:27], v[104:107], v[128:143]
    ds_read_b64_tr_b16 a[8:9], v200 offset:24576
    ds_read_b64_tr_b16 a[10:11], v200 offset:24832
    v_add_u32 v12, s100, v12
    v_xor_b32 v13, 32, v8
    v_add_u32 v13, s100, v13
    v_mfma_f32_16x16x32_bf16 v[176:179], a[252:255], a[24:27], v[176:179]
    v_xor_b32 v14, 64, v8
    v_add_u32 v14, s100, v14
    s_waitcnt lgkmcnt(6)
    v_mfma_f32_32x32x16_bf16 v[128:143], a[28:31], v[108:111], v[128:143]
    ds_read_b64_tr_b16 a[12:13], v201 offset:24576
    ds_read_b64_tr_b16 a[14:15], v201 offset:24832
    v_xor_b32 v15, 96, v8
    v_add_u32 v15, s100, v15
    s_lshl_b32 s62, s27, 10
    v_mfma_f32_16x16x32_bf16 v[176:179], a[252:255], a[28:31], v[176:179]
    s_add_u32 s62, s62, 32768
    v_and_b32 v219, 15, v0
    s_waitcnt lgkmcnt(6)
    v_mfma_f32_32x32x16_bf16 v[128:143], a[0:3], v[112:115], v[128:143]
    v_lshl_add_u32 v219, v219, 6, s62
    v_mfma_f32_16x16x32_bf16 v[176:179], a[252:255], a[0:3], v[176:179]
    s_waitcnt lgkmcnt(4)
    v_mfma_f32_32x32x16_bf16 v[128:143], a[4:7], v[116:119], v[128:143]
    v_mfma_f32_16x16x32_bf16 v[176:179], a[252:255], a[4:7], v[176:179]
    s_waitcnt lgkmcnt(2)
    v_mfma_f32_32x32x16_bf16 v[128:143], a[8:11], v[120:123], v[128:143]
    v_mfma_f32_16x16x32_bf16 v[176:179], a[252:255], a[8:11], v[176:179]
    s_waitcnt lgkmcnt(0)
    s_branch L_pg3
    .p2align 12
L_stub3:
    s_setpc_b64 s[70:71]
L_pg3:
    v_mfma_f32_32x32x16_bf16 v[128:143], a[12:15], v[124:127], v[128:143]
    v_mfma_f32_16x16x32_bf16 v[176:179], a[252:255], a[12:15], v[176:179]
    v_mul_f32 v10, 0x3e8b97f6, v253
    s_bitcmp1_b32 s44, 0
    s_cselect_b64 s[62:63], -1, 0
    s_andn2_b64 s[64:65], s[62:63], s[50:51]
    s_andn2_b64 s[68:69], s[50:51], s[62:63]
    s_lshl_b32 s62, s26, 11
    s_add_u32 s62, s62, 155648
    v_add_u32 v7, s62, v3
    v_cvt_pk_bf16_f32 v168, v176, v176
    v_and_b32 v169, 0xffff0000, v168
    v_sub_f32 v169, v176, v169
    v_cvt_pk_bf16_f32 v169, v169, 0
    v_mov_b32 v170, 0
    v_mov_b32 v171, 0
    s_nop 1
    v_mfma_f32_32x32x16_bf16 v[128:143], v[168:171], v[240:243], v[128:143]
    s_nop 11
    v_pk_mul_f32 v[128:129], v[128:129], v[10:11] op_sel_hi:[1,0]
    v_pk_mul_f32 v[130:131], v[130:131], v[10:11] op_sel_hi:[1,0]
    v_pk_mul_f32 v[132:133], v[132:133], v[10:11] op_sel_hi:[1,0]
    v_pk_mul_f32 v[134:135], v[134:135], v[10:11] op_sel_hi:[1,0]
    v_pk_mul_f32 v[136:137], v[136:137], v[10:11] op_sel_hi:[1,0]
    v_pk_mul_f32 v[138:139], v[138:139], v[10:11] op_sel_hi:[1,0]
    v_pk_mul_f32 v[140:141], v[140:141], v[10:11] op_sel_hi:[1,0]
    v_pk_mul_f32 v[142:143], v[142:143], v[10:11] op_sel_hi:[1,0]
    v_cvt_pk_bf16_f32 v160, v128, v129
    v_cvt_pk_bf16_f32 v161, v130, v131
    v_cvt_pk_bf16_f32 v162, v132, v133
    v_cvt_pk_bf16_f32 v163, v134, v135
    v_cvt_pk_bf16_f32 v164, v136, v137
    v_cvt_pk_bf16_f32 v165, v138, v139
    v_cvt_pk_bf16_f32 v166, v140, v141
    v_cvt_pk_bf16_f32 v167, v142, v143
    v_cndmask_b32 v160, v160, 0, s[64:65]
    v_cndmask_b32 v166, v166, 0, s[68:69]
    v_cndmask_b32 v161, v161, 0, s[64:65]
    v_cndmask_b32 v167, v167, 0, s[68:69]
    ds_write_b128 v7, v[160:163]
    ds_write_b128 v7, v[164:167] offset:1024
    s_waitcnt lgkmcnt(0)
    s_cmp_eq_u32 s26, 1
    s_cbranch_scc0 L_tch_36
    s_call_b64 s[70:71], L_stub4
    s_call_b64 s[70:71], L_stub7
    s_call_b64 s[70:71], L_stub10
L_tch_36:
    s_cmp_eq_u32 s26, 2
    s_cbranch_scc0 L_tch_37
    s_call_b64 s[70:71], L_stub5
    s_call_b64 s[70:71], L_stub8
    s_call_b64 s[70:71], L_stub11
L_tch_37:
    s_cmp_eq_u32 s26, 3
    s_cbranch_scc0 L_tch_38
    s_call_b64 s[70:71], L_stub6
    s_call_b64 s[70:71], L_stub9
    s_call_b64 s[70:71], L_stub12
L_tch_38:
    s_cmp_eq_u32 s26, 0
    s_cbranch_scc0 L_s1skip_13
    s_mov_b32 s72, 0
    v_lshlrev_b32 v136, 6, v0
L_s1_14:
    s_mov_b32 s62, 32768
    buffer_load_dwordx2 v[128:129], v136, s[28:31], s62 offen sc1
    s_mov_b32 s62, 36864
    buffer_load_dwordx2 v[130:131], v136, s[28:31], s62 offen sc1
    s_mov_b32 s62, 40960
    buffer_load_dwordx2 v[132:133], v136, s[28:31], s62 offen sc1
    s_mov_b32 s62, 45056
    buffer_load_dwordx2 v[134:135], v136, s[28:31], s62 offen sc1
    s_add_u32 s72, s72, 1
    s_waitcnt vmcnt(0)
    v_and_b32 v128, -16, v128
    v_and_b32 v130, -16, v130
    v_and_b32 v132, -16, v132
    v_and_b32 v134, -16, v134
    v_cmp_ne_u64 vcc, s[46:47], v[128:129]
    v_cmp_ne_u64 s[62:63], s[46:47], v[130:131]
    v_cmp_ne_u64 s[64:65], s[46:47], v[132:133]
    v_cmp_ne_u64 s[68:69], s[46:47], v[134:135]
    s_or_b64 s[62:63], s[62:63], vcc
    s_nop 0
    s_or_b64 s[64:65], s[64:65], s[68:69]
    s_or_b64 s[62:63], s[62:63], s[64:65]
    s_cbranch_scc0 L_s1skip_13
    s_cmp_lt_u32 s72, 100000
    s_cbranch_scc1 L_s1_14
L_s1skip_13:
    s_barrier
    s_waitcnt vmcnt(8)
    buffer_load_dwordx4 v[152:155], v3, s[28:31], s66 offen offset:0 sc1
    buffer_load_dwordx4 v[156:159], v3, s[28:31], s66 offen offset:1024 sc1
    buffer_load_dwordx4 v[160:163], v217, s[28:31], 0 offen offset:0 sc1
    buffer_load_dwordx4 v[164:167], v217, s[28:31], 0 offen offset:896 sc1
    s_add_u32 s66, s66, 3584
    v_add_u32 v217, v218, v217
    ds_read_b128 v[16:19], v230
    ds_read_b128 v[20:23], v230 offset:1024
    ds_read_b128 v[24:27], v231
    ds_read_b128 v[28:31], v231 offset:1024
    ds_read_b128 v[32:35], v232
    ds_read_b128 v[36:39], v232 offset:1024
    ds_read_b128 v[40:43], v233
    ds_read_b128 v[44:47], v233 offset:1024
    buffer_load_dwordx4 v[168:171], v3, s[28:31], s66 offen offset:0 sc1
    buffer_load_dwordx4 v[172:175], v3, s[28:31], s66 offen offset:1024 sc1
    buffer_load_dwordx4 v[176:179], v217, s[28:31], 0 offen offset:0 sc1
    buffer_load_dwordx4 v[180:183], v217, s[28:31], 0 offen offset:896 sc1
    s_add_u32 s66, s66, 3584
    v_add_u32 v217, v218, v217
    buffer_load_dwordx4 v[184:187], v3, s[28:31], s66 offen offset:0 sc1
    buffer_load_dwordx4 v[188:191], v3, s[28:31], s66 offen offset:1024 sc1
    buffer_load_dwordx4 v[192:195], v217, s[28:31], 0 offen offset:0 sc1
    buffer_load_dwordx4 v[196:199], v217, s[28:31], 0 offen offset:896 sc1
    s_add_u32 s66, s66, 3584
    v_add_u32 v217, v218, v217
    s_waitcnt lgkmcnt(0)
    s_barrier
    s_waitcnt vmcnt(10)
    v_mfma_f32_32x32x16_bf16 v[112:127], v[152:155], v[16:19], 0
    v_mfma_f32_32x32x16_bf16 v[112:127], v[156:159], v[20:23], v[112:127]
    v_mfma_f32_32x32x16_bf16 v[128:143], v[152:155], v[24:27], 0
    s_nop 10
    v_exp_f32 v112, v112
    v_exp_f32 v113, v113
    v_exp_f32 v114, v114
    v_exp_f32 v115, v115
    v_exp_f32 v116, v116
    v_exp_f32 v117, v117
    v_exp_f32 v118, v118
    v_exp_f32 v119, v119
    v_cvt_pk_bf16_f32 v144, v112, v113
    v_cvt_pk_bf16_f32 v145, v114, v115
    v_mfma_f32_32x32x16_bf16 v[128:143], v[156:159], v[28:31], v[128:143]
    v_exp_f32 v120, v120
    v_exp_f32 v121, v121
    v_exp_f32 v122, v122
    v_exp_f32 v123, v123
    v_cvt_pk_bf16_f32 v146, v116, v117
    v_cvt_pk_bf16_f32 v147, v118, v119
    v_exp_f32 v124, v124
    v_exp_f32 v125, v125
    v_exp_f32 v126, v126
    v_exp_f32 v127, v127
    v_cvt_pk_bf16_f32 v148, v120, v121
    v_cvt_pk_bf16_f32 v149, v122, v123
    v_cvt_pk_bf16_f32 v150, v124, v125
    v_cvt_pk_bf16_f32 v151, v126, v127
    buffer_load_dwordx4 v[200:203], v3, s[28:31], s66 offen offset:0 sc1
    buffer_load_dwordx4 v[204:207], v3, s[28:31], s66 offen offset:1024 sc1
    buffer_load_dwordx4 v[208:211], v217, s[28:31], 0 offen offset:0 sc1
    buffer_load_dwordx4 v[212:215], v217, s[28:31], 0 offen offset:896 sc1
    s_add_u32 s66, s66, 3584
    v_add_u32 v217, v218, v217
    v_mfma_f32_32x32x16_bf16 v[112:127], v[152:155], v[32:35], 0
    v_exp_f32 v128, v128
    v_exp_f32 v129, v129
    v_exp_f32 v130, v130
    v_exp_f32 v131, v131
    s_waitcnt vmcnt(12)
    v_mfma_f32_32x32x16_bf16 v[48:63], v[160:163], v[144:147], 0
    v_exp_f32 v132, v132
    v_exp_f32 v133, v133
    v_exp_f32 v134, v134
    v_exp_f32 v135, v135
    v_cvt_pk_bf16_f32 v144, v128, v129
    v_cvt_pk_bf16_f32 v145, v130, v131
    v_mfma_f32_32x32x16_bf16 v[112:127], v[156:159], v[36:39], v[112:127]
    v_exp_f32 v136, v136
    v_exp_f32 v137, v137
    v_exp_f32 v138, v138
    v_exp_f32 v139, v139
    v_cvt_pk_bf16_f32 v146, v132, v133
    v_cvt_pk_bf16_f32 v147, v134, v135
    v_mfma_f32_32x32x16_bf16 v[48:63], v[164:167], v[148:151], v[48:63]
    v_exp_f32 v140, v140
    v_exp_f32 v141, v141
    v_exp_f32 v142, v142
    v_exp_f32 v143, v143
    v_cvt_pk_bf16_f32 v148, v136, v137
    v_cvt_pk_bf16_f32 v149, v138, v139
    v_cvt_pk_bf16_f32 v150, v140, v141
    v_cvt_pk_bf16_f32 v151, v142, v143
    v_mfma_f32_32x32x16_bf16 v[128:143], v[152:155], v[40:43], 0
    v_exp_f32 v112, v112
    v_exp_f32 v113, v113
    v_exp_f32 v114, v114
    v_exp_f32 v115, v115
    v_mfma_f32_32x32x16_bf16 v[64:79], v[160:163], v[144:147], 0
    v_exp_f32 v116, v116
    v_exp_f32 v117, v117
    v_exp_f32 v118, v118
    v_exp_f32 v119, v119
    v_cvt_pk_bf16_f32 v144, v112, v113
    v_cvt_pk_bf16_f32 v145, v114, v115
    v_mfma_f32_32x32x16_bf16 v[128:143], v[156:159], v[44:47], v[128:143]
    v_exp_f32 v120, v120
    v_exp_f32 v121, v121
    v_exp_f32 v122, v122
    v_exp_f32 v123, v123
    v_cvt_pk_bf16_f32 v146, v116, v117
    v_cvt_pk_bf16_f32 v147, v118, v119
    v_mfma_f32_32x32x16_bf16 v[64:79], v[164:167], v[148:151], v[64:79]
    v_exp_f32 v124, v124
    v_exp_f32 v125, v125
    v_exp_f32 v126, v126
    v_exp_f32 v127, v127
    v_cvt_pk_bf16_f32 v148, v120, v121
    v_cvt_pk_bf16_f32 v149, v122, v123
    v_cvt_pk_bf16_f32 v150, v124, v125
    v_cvt_pk_bf16_f32 v151, v126, v127
    buffer_load_dword v219, v219, s[28:31], 0 offen offset:0 sc1
    s_waitcnt vmcnt(11)
    v_mfma_f32_32x32x16_bf16 v[112:127], v[168:171], v[16:19], 0
    v_exp_f32 v128, v128
    v_exp_f32 v129, v129
    v_exp_f32 v130, v130
    v_exp_f32 v131, v131
    v_mfma_f32_32x32x16_bf16 v[80:95], v[160:163], v[144:147], 0
    v_exp_f32 v132, v132
    v_exp_f32 v133, v133
    v_exp_f32 v134, v134
    v_exp_f32 v135, v135
    v_cvt_pk_bf16_f32 v144, v128, v129
    v_cvt_pk_bf16_f32 v145, v130, v131
    v_mfma_f32_32x32x16_bf16 v[112:127], v[172:175], v[20:23], v[112:127]
    v_exp_f32 v136, v136
    v_exp_f32 v137, v137
    v_exp_f32 v138, v138
    v_exp_f32 v139, v139
    v_cvt_pk_bf16_f32 v146, v132, v133
    v_cvt_pk_bf16_f32 v147, v134, v135
    v_mfma_f32_32x32x16_bf16 v[80:95], v[164:167], v[148:151], v[80:95]
    v_exp_f32 v140, v140
    v_exp_f32 v141, v141
    v_exp_f32 v142, v142
    v_exp_f32 v143, v143
    v_cvt_pk_bf16_f32 v148, v136, v137
    v_cvt_pk_bf16_f32 v149, v138, v139
    v_cvt_pk_bf16_f32 v150, v140, v141
    v_cvt_pk_bf16_f32 v151, v142, v143
    v_mfma_f32_32x32x16_bf16 v[128:143], v[168:171], v[24:27], 0
    v_exp_f32 v112, v112
    v_exp_f32 v113, v113
    v_exp_f32 v114, v114
    v_exp_f32 v115, v115
    v_mfma_f32_32x32x16_bf16 v[96:111], v[160:163], v[144:147], 0
    v_exp_f32 v116, v116
    v_exp_f32 v117, v117
    v_exp_f32 v118, v118
    v_exp_f32 v119, v119
    v_cvt_pk_bf16_f32 v144, v112, v113
    v_cvt_pk_bf16_f32 v145, v114, v115
    v_mfma_f32_32x32x16_bf16 v[128:143], v[172:175], v[28:31], v[128:143]
    v_exp_f32 v120, v120
    v_exp_f32 v121, v121
    v_exp_f32 v122, v122
    v_exp_f32 v123, v123
    v_cvt_pk_bf16_f32 v146, v116, v117
    v_cvt_pk_bf16_f32 v147, v118, v119
    v_mfma_f32_32x32x16_bf16 v[96:111], v[164:167], v[148:151], v[96:111]
    v_exp_f32 v124, v124
    v_exp_f32 v125, v125
    v_exp_f32 v126, v126
    v_exp_f32 v127, v127
    v_cvt_pk_bf16_f32 v148, v120, v121
    v_cvt_pk_bf16_f32 v149, v122, v123
    v_cvt_pk_bf16_f32 v150, v124, v125
    v_cvt_pk_bf16_f32 v151, v126, v127
    buffer_load_dwordx4 v[152:155], v3, s[28:31], s66 offen offset:0 sc1
    buffer_load_dwordx4 v[156:159], v3, s[28:31], s66 offen offset:1024 sc1
    buffer_load_dwordx4 v[160:163], v217, s[28:31], 0 offen offset:0 sc1
    buffer_load_dwordx4 v[164:167], v217, s[28:31], 0 offen offset:896 sc1
    s_add_u32 s66, s66, 3584
    v_add_u32 v217, v218, v217
    v_mfma_f32_32x32x16_bf16 v[112:127], v[168:171], v[32:35], 0
    v_exp_f32 v128, v128
    v_exp_f32 v129, v129
    v_exp_f32 v130, v130
    v_exp_f32 v131, v131
    s_waitcnt vmcnt(13)
    v_mfma_f32_32x32x16_bf16 v[48:63], v[176:179], v[144:147], v[48:63]
    v_exp_f32 v132, v132
    v_exp_f32 v133, v133
    v_exp_f32 v134, v134
    v_exp_f32 v135, v135
    v_cvt_pk_bf16_f32 v144, v128, v129
    v_cvt_pk_bf16_f32 v145, v130, v131
    v_mfma_f32_32x32x16_bf16 v[112:127], v[172:175], v[36:39], v[112:127]
    v_exp_f32 v136, v136
    v_exp_f32 v137, v137
    v_exp_f32 v138, v138
    v_exp_f32 v139, v139
    v_cvt_pk_bf16_f32 v146, v132, v133
    v_cvt_pk_bf16_f32 v147, v134, v135
    v_mfma_f32_32x32x16_bf16 v[48:63], v[180:183], v[148:151], v[48:63]
    v_exp_f32 v140, v140
    v_exp_f32 v141, v141
    v_exp_f32 v142, v142
    v_exp_f32 v143, v143
    v_cvt_pk_bf16_f32 v148, v136, v137
    v_cvt_pk_bf16_f32 v149, v138, v139
    v_cvt_pk_bf16_f32 v150, v140, v141
    v_cvt_pk_bf16_f32 v151, v142, v143
    v_mfma_f32_32x32x16_bf16 v[128:143], v[168:171], v[40:43], 0
    v_exp_f32 v112, v112
    v_exp_f32 v113, v113
    v_exp_f32 v114, v114
    v_exp_f32 v115, v115
    v_mfma_f32_32x32x16_bf16 v[64:79], v[176:179], v[144:147], v[64:79]
    v_exp_f32 v116, v116
    v_exp_f32 v117, v117
    v_exp_f32 v118, v118
    v_exp_f32 v119, v119
    v_cvt_pk_bf16_f32 v144, v112, v113
    v_cvt_pk_bf16_f32 v145, v114, v115
    v_mfma_f32_32x32x16_bf16 v[128:143], v[172:175], v[44:47], v[128:143]
    v_exp_f32 v120, v120
    v_exp_f32 v121, v121
    v_exp_f32 v122, v122
    v_exp_f32 v123, v123
    v_cvt_pk_bf16_f32 v146, v116, v117
    v_cvt_pk_bf16_f32 v147, v118, v119
    v_mfma_f32_32x32x16_bf16 v[64:79], v[180:183], v[148:151], v[64:79]
    v_exp_f32 v124, v124
    v_exp_f32 v125, v125
    v_exp_f32 v126, v126
    v_exp_f32 v127, v127
    v_cvt_pk_bf16_f32 v148, v120, v121
    v_cvt_pk_bf16_f32 v149, v122, v123
    v_cvt_pk_bf16_f32 v150, v124, v125
    v_cvt_pk_bf16_f32 v151, v126, v127
    s_add_u32 m0, s100, 0
    s_movk_i32 s101, 0
    buffer_load_dwordx4 v234, s[92:95], s101 offen offset:0 lds
    buffer_load_dwordx4 v235, s[92:95], s101 offen offset:1024 lds
    buffer_load_dwordx4 v236, s[92:95], s101 offen offset:2048 lds
    buffer_load_dwordx4 v237, s[92:95], s101 offen offset:3072 lds
    s_waitcnt vmcnt(15)
    v_mfma_f32_32x32x16_bf16 v[112:127], v[184:187], v[16:19], 0
    v_exp_f32 v128, v128
    v_exp_f32 v129, v129
    v_exp_f32 v130, v130
    v_exp_f32 v131, v131
    v_mfma_f32_32x32x16_bf16 v[80:95], v[176:179], v[144:147], v[80:95]
    v_exp_f32 v132, v132
    v_exp_f32 v133, v133
    v_exp_f32 v134, v134
    v_exp_f32 v135, v135
    v_cvt_pk_bf16_f32 v144, v128, v129
    v_cvt_pk_bf16_f32 v145, v130, v131
    v_mfma_f32_32x32x16_bf16 v[112:127], v[188:191], v[20:23], v[112:127]
    v_exp_f32 v136, v136
    v_exp_f32 v137, v137
    v_exp_f32 v138, v138
    v_exp_f32 v139, v139
    v_cvt_pk_bf16_f32 v146, v132, v133
    v_cvt_pk_bf16_f32 v147, v134, v135
    v_mfma_f32_32x32x16_bf16 v[80:95], v[180:183], v[148:151], v[80:95]
    v_exp_f32 v140, v140
    v_exp_f32 v141, v141
    v_exp_f32 v142, v142
    v_exp_f32 v143, v143
    v_cvt_pk_bf16_f32 v148, v136, v137
    v_cvt_pk_bf16_f32 v149, v138, v139
    v_cvt_pk_bf16_f32 v150, v140, v141
    v_cvt_pk_bf16_f32 v151, v142, v143
    s_mul_i32 s80, s26, 14336
    s_add_u32 m0, s80, 0
    s_mov_b32 s81, 0
    buffer_load_dwordx4 v220, s[32:35], s81 offen offset:0 lds
    buffer_load_dwordx4 v221, s[32:35], s81 offen offset:1024 lds
    v_mfma_f32_32x32x16_bf16 v[128:143], v[184:187], v[24:27], 0
    v_exp_f32 v112, v112
    v_exp_f32 v113, v113
    v_exp_f32 v114, v114
    v_exp_f32 v115, v115
    v_mfma_f32_32x32x16_bf16 v[96:111], v[176:179], v[144:147], v[96:111]
    v_exp_f32 v116, v116
    v_exp_f32 v117, v117
    v_exp_f32 v118, v118
    v_exp_f32 v119, v119
    v_cvt_pk_bf16_f32 v144, v112, v113
    v_cvt_pk_bf16_f32 v145, v114, v115
    v_mfma_f32_32x32x16_bf16 v[128:143], v[188:191], v[28:31], v[128:143]
    v_exp_f32 v120, v120
    v_exp_f32 v121, v121
    v_exp_f32 v122, v122
    v_exp_f32 v123, v123
    v_cvt_pk_bf16_f32 v146, v116, v117
    v_cvt_pk_bf16_f32 v147, v118, v119
    v_mfma_f32_32x32x16_bf16 v[96:111], v[180:183], v[148:151], v[96:111]
    v_exp_f32 v124, v124
    v_exp_f32 v125, v125
    v_exp_f32 v126, v126
    v_exp_f32 v127, v127
    v_cvt_pk_bf16_f32 v148, v120, v121
    v_cvt_pk_bf16_f32 v149, v122, v123
    v_cvt_pk_bf16_f32 v150, v124, v125
    v_cvt_pk_bf16_f32 v151, v126, v127
    buffer_load_dwordx4 v[168:171], v3, s[28:31], s66 offen offset:0 sc1
    buffer_load_dwordx4 v[172:175], v3, s[28:31], s66 offen offset:1024 sc1
    buffer_load_dwordx4 v[176:179], v217, s[28:31], 0 offen offset:0 sc1
    buffer_load_dwordx4 v[180:183], v217, s[28:31], 0 offen offset:896 sc1
    s_add_u32 s66, s66, 3584
    v_add_u32 v217, v218, v217
    v_mfma_f32_32x32x16_bf16 v[112:127], v[184:187], v[32:35], 0
    v_exp_f32 v128, v128
    v_exp_f32 v129, v129
    v_exp_f32 v130, v130
    v_exp_f32 v131, v131
    s_waitcnt vmcnt(19)
    v_mfma_f32_32x32x16_bf16 v[48:63], v[192:195], v[144:147], v[48:63]
    v_exp_f32 v132, v132
    v_exp_f32 v133, v133
    v_exp_f32 v134, v134
    v_exp_f32 v135, v135
    v_cvt_pk_bf16_f32 v144, v128, v129
    v_cvt_pk_bf16_f32 v145, v130, v131
    v_mfma_f32_32x32x16_bf16 v[112:127], v[188:191], v[36:39], v[112:127]
    v_exp_f32 v136, v136
    v_exp_f32 v137, v137
    v_exp_f32 v138, v138
    v_exp_f32 v139, v139
    v_cvt_pk_bf16_f32 v146, v132, v133
    v_cvt_pk_bf16_f32 v147, v134, v135
    v_mfma_f32_32x32x16_bf16 v[48:63], v[196:199], v[148:151], v[48:63]
    v_exp_f32 v140, v140
    v_exp_f32 v141, v141
    v_exp_f32 v142, v142
    v_exp_f32 v143, v143
    v_cvt_pk_bf16_f32 v148, v136, v137
    v_cvt_pk_bf16_f32 v149, v138, v139
    v_cvt_pk_bf16_f32 v150, v140, v141
    v_cvt_pk_bf16_f32 v151, v142, v143
    v_mfma_f32_32x32x16_bf16 v[128:143], v[184:187], v[40:43], 0
    v_exp_f32 v112, v112
    v_exp_f32 v113, v113
    v_exp_f32 v114, v114
    v_exp_f32 v115, v115
    v_mfma_f32_32x32x16_bf16 v[64:79], v[192:195], v[144:147], v[64:79]
    v_exp_f32 v116, v116
    v_exp_f32 v117, v117
    v_exp_f32 v118, v118
    v_exp_f32 v119, v119
    v_cvt_pk_bf16_f32 v144, v112, v113
    v_cvt_pk_bf16_f32 v145, v114, v115
    v_mfma_f32_32x32x16_bf16 v[128:143], v[188:191], v[44:47], v[128:143]
    v_exp_f32 v120, v120
    v_exp_f32 v121, v121
    v_exp_f32 v122, v122
    v_exp_f32 v123, v123
    v_cvt_pk_bf16_f32 v146, v116, v117
    v_cvt_pk_bf16_f32 v147, v118, v119
    v_mfma_f32_32x32x16_bf16 v[64:79], v[196:199], v[148:151], v[64:79]
    v_exp_f32 v124, v124
    v_exp_f32 v125, v125
    v_exp_f32 v126, v126
    v_exp_f32 v127, v127
    v_cvt_pk_bf16_f32 v148, v120, v121
    v_cvt_pk_bf16_f32 v149, v122, v123
    v_cvt_pk_bf16_f32 v150, v124, v125
    v_cvt_pk_bf16_f32 v151, v126, v127
    s_add_u32 m0, s100, 4096
    s_movk_i32 s101, 128
    buffer_load_dwordx4 v234, s[92:95], s101 offen offset:0 lds
    buffer_load_dwordx4 v235, s[92:95], s101 offen offset:1024 lds
    buffer_load_dwordx4 v236, s[92:95], s101 offen offset:2048 lds
    buffer_load_dwordx4 v237, s[92:95], s101 offen offset:3072 lds
    s_waitcnt vmcnt(21)
    v_mfma_f32_32x32x16_bf16 v[112:127], v[200:203], v[16:19], 0
    v_exp_f32 v128, v128
    v_exp_f32 v129, v129
    v_exp_f32 v130, v130
    v_exp_f32 v131, v131
    v_mfma_f32_32x32x16_bf16 v[80:95], v[192:195], v[144:147], v[80:95]
    v_exp_f32 v132, v132
    v_exp_f32 v133, v133
    v_exp_f32 v134, v134
    v_exp_f32 v135, v135
    v_cvt_pk_bf16_f32 v144, v128, v129
    v_cvt_pk_bf16_f32 v145, v130, v131
    v_mfma_f32_32x32x16_bf16 v[112:127], v[204:207], v[20:23], v[112:127]
    v_exp_f32 v136, v136
    v_exp_f32 v137, v137
    v_exp_f32 v138, v138
    v_exp_f32 v139, v139
    v_cvt_pk_bf16_f32 v146, v132, v133
    v_cvt_pk_bf16_f32 v147, v134, v135
    v_mfma_f32_32x32x16_bf16 v[80:95], v[196:199], v[148:151], v[80:95]
    v_exp_f32 v140, v140
    v_exp_f32 v141, v141
    v_exp_f32 v142, v142
    v_exp_f32 v143, v143
    v_cvt_pk_bf16_f32 v148, v136, v137
    v_cvt_pk_bf16_f32 v149, v138, v139
    v_cvt_pk_bf16_f32 v150, v140, v141
    v_cvt_pk_bf16_f32 v151, v142, v143
    s_add_u32 m0, s80, 2048
    s_mov_b32 s81, 14336
    buffer_load_dwordx4 v220, s[32:35], s81 offen offset:0 lds
    buffer_load_dwordx4 v221, s[32:35], s81 offen offset:1024 lds
    v_mfma_f32_32x32x16_bf16 v[128:143], v[200:203], v[24:27], 0
    v_exp_f32 v112, v112
    v_exp_f32 v113, v113
    v_exp_f32 v114, v114
    v_exp_f32 v115, v115
    v_mfma_f32_32x32x16_bf16 v[96:111], v[192:195], v[144:147], v[96:111]
    v_exp_f32 v116, v116
    v_exp_f32 v117, v117
    v_exp_f32 v118, v118
    v_exp_f32 v119, v119
    v_cvt_pk_bf16_f32 v144, v112, v113
    v_cvt_pk_bf16_f32 v145, v114, v115
    v_mfma_f32_32x32x16_bf16 v[128:143], v[204:207], v[28:31], v[128:143]
    v_exp_f32 v120, v120
    v_exp_f32 v121, v121
    v_exp_f32 v122, v122
    v_exp_f32 v123, v123
    v_cvt_pk_bf16_f32 v146, v116, v117
    v_cvt_pk_bf16_f32 v147, v118, v119
    v_mfma_f32_32x32x16_bf16 v[96:111], v[196:199], v[148:151], v[96:111]
    v_exp_f32 v124, v124
    v_exp_f32 v125, v125
    v_exp_f32 v126, v126
    v_exp_f32 v127, v127
    v_cvt_pk_bf16_f32 v148, v120, v121
    v_cvt_pk_bf16_f32 v149, v122, v123
    v_cvt_pk_bf16_f32 v150, v124, v125
    v_cvt_pk_bf16_f32 v151, v126, v127
    buffer_load_dwordx4 v[184:187], v3, s[28:31], s66 offen offset:0 sc1
    buffer_load_dwordx4 v[188:191], v3, s[28:31], s66 offen offset:1024 sc1
    buffer_load_dwordx4 v[192:195], v217, s[28:31], 0 offen offset:0 sc1
    buffer_load_dwordx4 v[196:199], v217, s[28:31], 0 offen offset:896 sc1
    s_add_u32 s66, s66, 3584
    v_add_u32 v217, v218, v217
    v_mfma_f32_32x32x16_bf16 v[112:127], v[200:203], v[32:35], 0
    v_exp_f32 v128, v128
    v_exp_f32 v129, v129
    v_exp_f32 v130, v130
    v_exp_f32 v131, v131
    s_waitcnt vmcnt(25)
    v_mfma_f32_32x32x16_bf16 v[48:63], v[208:211], v[144:147], v[48:63]
    v_exp_f32 v132, v132
    v_exp_f32 v133, v133
    v_exp_f32 v134, v134
    v_exp_f32 v135, v135
    v_cvt_pk_bf16_f32 v144, v128, v129
    v_cvt_pk_bf16_f32 v145, v130, v131
    v_mfma_f32_32x32x16_bf16 v[112:127], v[204:207], v[36:39], v[112:127]
    v_exp_f32 v136, v136
    v_exp_f32 v137, v137
    v_exp_f32 v138, v138
    v_exp_f32 v139, v139
    v_cvt_pk_bf16_f32 v146, v132, v133
    v_cvt_pk_bf16_f32 v147, v134, v135
    v_mfma_f32_32x32x16_bf16 v[48:63], v[212:215], v[148:151], v[48:63]
    v_exp_f32 v140, v140
    v_exp_f32 v141, v141
    v_exp_f32 v142, v142
    v_exp_f32 v143, v143
    v_cvt_pk_bf16_f32 v148, v136, v137
    v_cvt_pk_bf16_f32 v149, v138, v139
    v_cvt_pk_bf16_f32 v150, v140, v141
    v_cvt_pk_bf16_f32 v151, v142, v143
    s_waitcnt vmcnt(16)
    ds_read_b128 a[0:3], v12 offset:0
    ds_read_b128 a[4:7], v13 offset:0
    ds_read_b128 a[8:11], v14 offset:0
    ds_read_b128 a[12:15], v15 offset:0
    v_mfma_f32_32x32x16_bf16 v[128:143], v[200:203], v[40:43], 0
    v_exp_f32 v112, v112
    v_exp_f32 v113, v113
    v_exp_f32 v114, v114
    v_exp_f32 v115, v115
    v_mfma_f32_32x32x16_bf16 v[64:79], v[208:211], v[144:147], v[64:79]
    v_exp_f32 v116, v116
    v_exp_f32 v117, v117
    v_exp_f32 v118, v118
    v_exp_f32 v119, v119
    v_cvt_pk_bf16_f32 v144, v112, v113
    v_cvt_pk_bf16_f32 v145, v114, v115
    v_mfma_f32_32x32x16_bf16 v[128:143], v[204:207], v[44:47], v[128:143]
    v_exp_f32 v120, v120
    v_exp_f32 v121, v121
    v_exp_f32 v122, v122
    v_exp_f32 v123, v123
    v_cvt_pk_bf16_f32 v146, v116, v117
    v_cvt_pk_bf16_f32 v147, v118, v119
    v_mfma_f32_32x32x16_bf16 v[64:79], v[212:215], v[148:151], v[64:79]
    v_exp_f32 v124, v124
    v_exp_f32 v125, v125
    v_exp_f32 v126, v126
    v_exp_f32 v127, v127
    v_cvt_pk_bf16_f32 v148, v120, v121
    v_cvt_pk_bf16_f32 v149, v122, v123
    v_cvt_pk_bf16_f32 v150, v124, v125
    v_cvt_pk_bf16_f32 v151, v126, v127
    s_add_u32 m0, s100, 8192
    s_movk_i32 s101, 256
    buffer_load_dwordx4 v234, s[92:95], s101 offen offset:0 lds
    buffer_load_dwordx4 v235, s[92:95], s101 offen offset:1024 lds
    buffer_load_dwordx4 v236, s[92:95], s101 offen offset:2048 lds
    buffer_load_dwordx4 v237, s[92:95], s101 offen offset:3072 lds
    v_mfma_f32_32x32x16_bf16 v[112:127], v[152:155], v[16:19], 0
    v_exp_f32 v128, v128
    v_exp_f32 v129, v129
    v_exp_f32 v130, v130
    v_exp_f32 v131, v131
    v_mfma_f32_32x32x16_bf16 v[80:95], v[208:211], v[144:147], v[80:95]
    v_exp_f32 v132, v132
    v_exp_f32 v133, v133
    v_exp_f32 v134, v134
    v_exp_f32 v135, v135
    v_cvt_pk_bf16_f32 v144, v128, v129
    v_cvt_pk_bf16_f32 v145, v130, v131
    v_mfma_f32_32x32x16_bf16 v[112:127], v[156:159], v[20:23], v[112:127]
    v_exp_f32 v136, v136
    v_exp_f32 v137, v137
    v_exp_f32 v138, v138
    v_exp_f32 v139, v139
    v_cvt_pk_bf16_f32 v146, v132, v133
    v_cvt_pk_bf16_f32 v147, v134, v135
    v_mfma_f32_32x32x16_bf16 v[80:95], v[212:215], v[148:151], v[80:95]
    v_exp_f32 v140, v140
    v_exp_f32 v141, v141
    v_exp_f32 v142, v142
    v_exp_f32 v143, v143
    v_cvt_pk_bf16_f32 v148, v136, v137
    v_cvt_pk_bf16_f32 v149, v138, v139
    v_cvt_pk_bf16_f32 v150, v140, v141
    v_cvt_pk_bf16_f32 v151, v142, v143
    s_add_u32 m0, s80, 4096
    s_mov_b32 s81, 28672
    buffer_load_dwordx4 v220, s[32:35], s81 offen offset:0 lds
    buffer_load_dwordx4 v221, s[32:35], s81 offen offset:1024 lds
    v_mfma_f32_32x32x16_bf16 v[128:143], v[152:155], v[24:27], 0
    v_exp_f32 v112, v112
    v_exp_f32 v113, v113
    v_exp_f32 v114, v114
    v_exp_f32 v115, v115
    v_mfma_f32_32x32x16_bf16 v[96:111], v[208:211], v[144:147], v[96:111]
    v_exp_f32 v116, v116
    v_exp_f32 v117, v117
    v_exp_f32 v118, v118
    v_exp_f32 v119, v119
    v_cvt_pk_bf16_f32 v144, v112, v113
    v_cvt_pk_bf16_f32 v145, v114, v115
    v_mfma_f32_32x32x16_bf16 v[128:143], v[156:159], v[28:31], v[128:143]
    v_exp_f32 v120, v120
    v_exp_f32 v121, v121
    v_exp_f32 v122, v122
    v_exp_f32 v123, v123
    v_cvt_pk_bf16_f32 v146, v116, v117
    v_cvt_pk_bf16_f32 v147, v118, v119
    v_mfma_f32_32x32x16_bf16 v[96:111], v[212:215], v[148:151], v[96:111]
    v_exp_f32 v124, v124
    v_exp_f32 v125, v125
    v_exp_f32 v126, v126
    v_exp_f32 v127, v127
    v_cvt_pk_bf16_f32 v148, v120, v121
    v_cvt_pk_bf16_f32 v149, v122, v123
    v_cvt_pk_bf16_f32 v150, v124, v125
    v_cvt_pk_bf16_f32 v151, v126, v127
    buffer_load_dwordx4 v[200:203], v3, s[28:31], s66 offen offset:0 sc1
    buffer_load_dwordx4 v[204:207], v3, s[28:31], s66 offen offset:1024 sc1
    buffer_load_dwordx4 v[208:211], v217, s[28:31], 0 offen offset:0 sc1
    buffer_load_dwordx4 v[212:215], v217, s[28:31], 0 offen offset:896 sc1
    s_add_u32 s66, s66, 3584
    v_add_u32 v217, v218, v217
    v_mfma_f32_32x32x16_bf16 v[112:127], v[152:155], v[32:35], 0
    v_exp_f32 v128, v128
    v_exp_f32 v129, v129
    v_exp_f32 v130, v130
    v_exp_f32 v131, v131
    v_mfma_f32_32x32x16_bf16 v[48:63], v[160:163], v[144:147], v[48:63]
    v_exp_f32 v132, v132
    v_exp_f32 v133, v133
    v_exp_f32 v134, v134
    v_exp_f32 v135, v135
    s_branch L_pg4
    .p2align 12
L_stub4:
    s_setpc_b64 s[70:71]
L_pg4:
    v_cvt_pk_bf16_f32 v144, v128, v129
    v_cvt_pk_bf16_f32 v145, v130, v131
    v_mfma_f32_32x32x16_bf16 v[112:127], v[156:159], v[36:39], v[112:127]
    v_exp_f32 v136, v136
    v_exp_f32 v137, v137
    v_exp_f32 v138, v138
    v_exp_f32 v139, v139
    v_cvt_pk_bf16_f32 v146, v132, v133
    v_cvt_pk_bf16_f32 v147, v134, v135
    v_mfma_f32_32x32x16_bf16 v[48:63], v[164:167], v[148:151], v[48:63]
    v_exp_f32 v140, v140
    v_exp_f32 v141, v141
    v_exp_f32 v142, v142
    v_exp_f32 v143, v143
    v_cvt_pk_bf16_f32 v148, v136, v137
    v_cvt_pk_bf16_f32 v149, v138, v139
    v_cvt_pk_bf16_f32 v150, v140, v141
    v_cvt_pk_bf16_f32 v151, v142, v143
    s_waitcnt vmcnt(16)
    ds_read_b128 a[16:19], v12 offset:4096
    ds_read_b128 a[20:23], v13 offset:4096
    ds_read_b128 a[24:27], v14 offset:4096
    ds_read_b128 a[28:31], v15 offset:4096
    v_mfma_f32_32x32x16_bf16 v[128:143], v[152:155], v[40:43], 0
    v_exp_f32 v112, v112
    v_exp_f32 v113, v113
    v_exp_f32 v114, v114
    v_exp_f32 v115, v115
    v_mfma_f32_32x32x16_bf16 v[64:79], v[160:163], v[144:147], v[64:79]
    v_exp_f32 v116, v116
    v_exp_f32 v117, v117
    v_exp_f32 v118, v118
    v_exp_f32 v119, v119
    v_cvt_pk_bf16_f32 v144, v112, v113
    v_cvt_pk_bf16_f32 v145, v114, v115
    v_mfma_f32_32x32x16_bf16 v[128:143], v[156:159], v[44:47], v[128:143]
    v_exp_f32 v120, v120
    v_exp_f32 v121, v121
    v_exp_f32 v122, v122
    v_exp_f32 v123, v123
    v_cvt_pk_bf16_f32 v146, v116, v117
    v_cvt_pk_bf16_f32 v147, v118, v119
    v_mfma_f32_32x32x16_bf16 v[64:79], v[164:167], v[148:151], v[64:79]
    v_exp_f32 v124, v124
    v_exp_f32 v125, v125
    v_exp_f32 v126, v126
    v_exp_f32 v127, v127
    v_cvt_pk_bf16_f32 v148, v120, v121
    v_cvt_pk_bf16_f32 v149, v122, v123
    v_cvt_pk_bf16_f32 v150, v124, v125
    v_cvt_pk_bf16_f32 v151, v126, v127
    s_waitcnt lgkmcnt(0)
    s_add_u32 m0, s100, 0
    s_movk_i32 s101, 384
    buffer_load_dwordx4 v234, s[92:95], s101 offen offset:0 lds
    buffer_load_dwordx4 v235, s[92:95], s101 offen offset:1024 lds
    buffer_load_dwordx4 v236, s[92:95], s101 offen offset:2048 lds
    buffer_load_dwordx4 v237, s[92:95], s101 offen offset:3072 lds
    v_mfma_f32_32x32x16_bf16 v[112:127], v[168:171], v[16:19], 0
    v_exp_f32 v128, v128
    v_exp_f32 v129, v129
    v_exp_f32 v130, v130
    v_exp_f32 v131, v131
    v_mfma_f32_32x32x16_bf16 v[80:95], v[160:163], v[144:147], v[80:95]
    v_exp_f32 v132, v132
    v_exp_f32 v133, v133
    v_exp_f32 v134, v134
    v_exp_f32 v135, v135
    v_cvt_pk_bf16_f32 v144, v128, v129
    v_cvt_pk_bf16_f32 v145, v130, v131
    v_mfma_f32_32x32x16_bf16 v[112:127], v[172:175], v[20:23], v[112:127]
    v_exp_f32 v136, v136
    v_exp_f32 v137, v137
    v_exp_f32 v138, v138
    v_exp_f32 v139, v139
    v_cvt_pk_bf16_f32 v146, v132, v133
    v_cvt_pk_bf16_f32 v147, v134, v135
    v_mfma_f32_32x32x16_bf16 v[80:95], v[164:167], v[148:151], v[80:95]
    v_exp_f32 v140, v140
    v_exp_f32 v141, v141
    v_exp_f32 v142, v142
    v_exp_f32 v143, v143
    v_cvt_pk_bf16_f32 v148, v136, v137
    v_cvt_pk_bf16_f32 v149, v138, v139
    v_cvt_pk_bf16_f32 v150, v140, v141
    v_cvt_pk_bf16_f32 v151, v142, v143
    s_add_u32 m0, s80, 6144
    s_mov_b32 s81, 43008
    buffer_load_dwordx4 v220, s[32:35], s81 offen offset:0 lds
    buffer_load_dwordx4 v221, s[32:35], s81 offen offset:1024 lds
    v_mfma_f32_32x32x16_bf16 v[128:143], v[168:171], v[24:27], 0
    v_exp_f32 v112, v112
    v_exp_f32 v113, v113
    v_exp_f32 v114, v114
    v_exp_f32 v115, v115
    v_mfma_f32_32x32x16_bf16 v[96:111], v[160:163], v[144:147], v[96:111]
    v_exp_f32 v116, v116
    v_exp_f32 v117, v117
    v_exp_f32 v118, v118
    v_exp_f32 v119, v119
    v_cvt_pk_bf16_f32 v144, v112, v113
    v_cvt_pk_bf16_f32 v145, v114, v115
    v_mfma_f32_32x32x16_bf16 v[128:143], v[172:175], v[28:31], v[128:143]
    v_exp_f32 v120, v120
    v_exp_f32 v121, v121
    v_exp_f32 v122, v122
    v_exp_f32 v123, v123
    v_cvt_pk_bf16_f32 v146, v116, v117
    v_cvt_pk_bf16_f32 v147, v118, v119
    v_mfma_f32_32x32x16_bf16 v[96:111], v[164:167], v[148:151], v[96:111]
    v_exp_f32 v124, v124
    v_exp_f32 v125, v125
    v_exp_f32 v126, v126
    v_exp_f32 v127, v127
    v_cvt_pk_bf16_f32 v148, v120, v121
    v_cvt_pk_bf16_f32 v149, v122, v123
    v_cvt_pk_bf16_f32 v150, v124, v125
    v_cvt_pk_bf16_f32 v151, v126, v127
    buffer_load_dwordx4 v[152:155], v3, s[28:31], s66 offen offset:0 sc1
    buffer_load_dwordx4 v[156:159], v3, s[28:31], s66 offen offset:1024 sc1
    buffer_load_dwordx4 v[160:163], v217, s[28:31], 0 offen offset:0 sc1
    buffer_load_dwordx4 v[164:167], v217, s[28:31], 0 offen offset:896 sc1
    s_add_u32 s66, s66, 3584
    v_add_u32 v217, v218, v217
    v_mfma_f32_32x32x16_bf16 v[112:127], v[168:171], v[32:35], 0
    v_exp_f32 v128, v128
    v_exp_f32 v129, v129
    v_exp_f32 v130, v130
    v_exp_f32 v131, v131
    v_mfma_f32_32x32x16_bf16 v[48:63], v[176:179], v[144:147], v[48:63]
    v_exp_f32 v132, v132
    v_exp_f32 v133, v133
    v_exp_f32 v134, v134
    v_exp_f32 v135, v135
    v_cvt_pk_bf16_f32 v144, v128, v129
    v_cvt_pk_bf16_f32 v145, v130, v131
    v_mfma_f32_32x32x16_bf16 v[112:127], v[172:175], v[36:39], v[112:127]
    v_exp_f32 v136, v136
    v_exp_f32 v137, v137
    v_exp_f32 v138, v138
    v_exp_f32 v139, v139
    v_cvt_pk_bf16_f32 v146, v132, v133
    v_cvt_pk_bf16_f32 v147, v134, v135
    v_mfma_f32_32x32x16_bf16 v[48:63], v[180:183], v[148:151], v[48:63]
    v_exp_f32 v140, v140
    v_exp_f32 v141, v141
    v_exp_f32 v142, v142
    v_exp_f32 v143, v143
    v_cvt_pk_bf16_f32 v148, v136, v137
    v_cvt_pk_bf16_f32 v149, v138, v139
    v_cvt_pk_bf16_f32 v150, v140, v141
    v_cvt_pk_bf16_f32 v151, v142, v143
    s_waitcnt vmcnt(16)
    ds_read_b128 a[32:35], v12 offset:8192
    ds_read_b128 a[36:39], v13 offset:8192
    ds_read_b128 a[40:43], v14 offset:8192
    ds_read_b128 a[44:47], v15 offset:8192
    v_mfma_f32_32x32x16_bf16 v[128:143], v[168:171], v[40:43], 0
    v_exp_f32 v112, v112
    v_exp_f32 v113, v113
    v_exp_f32 v114, v114
    v_exp_f32 v115, v115
    v_mfma_f32_32x32x16_bf16 v[64:79], v[176:179], v[144:147], v[64:79]
    v_exp_f32 v116, v116
    v_exp_f32 v117, v117
    v_exp_f32 v118, v118
    v_exp_f32 v119, v119
    v_cvt_pk_bf16_f32 v144, v112, v113
    v_cvt_pk_bf16_f32 v145, v114, v115
    v_mfma_f32_32x32x16_bf16 v[128:143], v[172:175], v[44:47], v[128:143]
    v_exp_f32 v120, v120
    v_exp_f32 v121, v121
    v_exp_f32 v122, v122
    v_exp_f32 v123, v123
    v_cvt_pk_bf16_f32 v146, v116, v117
    v_cvt_pk_bf16_f32 v147, v118, v119
    v_mfma_f32_32x32x16_bf16 v[64:79], v[180:183], v[148:151], v[64:79]
    v_exp_f32 v124, v124
    v_exp_f32 v125, v125
    v_exp_f32 v126, v126
    v_exp_f32 v127, v127
    v_cvt_pk_bf16_f32 v148, v120, v121
    v_cvt_pk_bf16_f32 v149, v122, v123
    v_cvt_pk_bf16_f32 v150, v124, v125
    v_cvt_pk_bf16_f32 v151, v126, v127
    s_waitcnt lgkmcnt(0)
    s_add_u32 m0, s100, 4096
    s_movk_i32 s101, 512
    buffer_load_dwordx4 v234, s[92:95], s101 offen offset:0 lds
    buffer_load_dwordx4 v235, s[92:95], s101 offen offset:1024 lds
    buffer_load_dwordx4 v236, s[92:95], s101 offen offset:2048 lds
    buffer_load_dwordx4 v237, s[92:95], s101 offen offset:3072 lds
    v_mfma_f32_32x32x16_bf16 v[112:127], v[184:187], v[16:19], 0
    v_exp_f32 v128, v128
    v_exp_f32 v129, v129
    v_exp_f32 v130, v130
    v_exp_f32 v131, v131
    v_mfma_f32_32x32x16_bf16 v[80:95], v[176:179], v[144:147], v[80:95]
    v_exp_f32 v132, v132
    v_exp_f32 v133, v133
    v_exp_f32 v134, v134
    v_exp_f32 v135, v135
    v_cvt_pk_bf16_f32 v144, v128, v129
    v_cvt_pk_bf16_f32 v145, v130, v131
    v_mfma_f32_32x32x16_bf16 v[112:127], v[188:191], v[20:23], v[112:127]
    v_exp_f32 v136, v136
    v_exp_f32 v137, v137
    v_exp_f32 v138, v138
    v_exp_f32 v139, v139
    v_cvt_pk_bf16_f32 v146, v132, v133
    v_cvt_pk_bf16_f32 v147, v134, v135
    v_mfma_f32_32x32x16_bf16 v[80:95], v[180:183], v[148:151], v[80:95]
    v_exp_f32 v140, v140
    v_exp_f32 v141, v141
    v_exp_f32 v142, v142
    v_exp_f32 v143, v143
    v_cvt_pk_bf16_f32 v148, v136, v137
    v_cvt_pk_bf16_f32 v149, v138, v139
    v_cvt_pk_bf16_f32 v150, v140, v141
    v_cvt_pk_bf16_f32 v151, v142, v143
    s_add_u32 m0, s80, 8192
    s_mov_b32 s81, 57344
    buffer_load_dwordx4 v220, s[32:35], s81 offen offset:0 lds
    buffer_load_dwordx4 v221, s[32:35], s81 offen offset:1024 lds
    v_mfma_f32_32x32x16_bf16 v[128:143], v[184:187], v[24:27], 0
    v_exp_f32 v112, v112
    v_exp_f32 v113, v113
    v_exp_f32 v114, v114
    v_exp_f32 v115, v115
    v_mfma_f32_32x32x16_bf16 v[96:111], v[176:179], v[144:147], v[96:111]
    v_exp_f32 v116, v116
    v_exp_f32 v117, v117
    v_exp_f32 v118, v118
    v_exp_f32 v119, v119
    v_cvt_pk_bf16_f32 v144, v112, v113
    v_cvt_pk_bf16_f32 v145, v114, v115
    v_mfma_f32_32x32x16_bf16 v[128:143], v[188:191], v[28:31], v[128:143]
    v_exp_f32 v120, v120
    v_exp_f32 v121, v121
    v_exp_f32 v122, v122
    v_exp_f32 v123, v123
    v_cvt_pk_bf16_f32 v146, v116, v117
    v_cvt_pk_bf16_f32 v147, v118, v119
    v_mfma_f32_32x32x16_bf16 v[96:111], v[180:183], v[148:151], v[96:111]
    v_exp_f32 v124, v124
    v_exp_f32 v125, v125
    v_exp_f32 v126, v126
    v_exp_f32 v127, v127
    v_cvt_pk_bf16_f32 v148, v120, v121
    v_cvt_pk_bf16_f32 v149, v122, v123
    v_cvt_pk_bf16_f32 v150, v124, v125
    v_cvt_pk_bf16_f32 v151, v126, v127
    buffer_load_dwordx4 v[168:171], v3, s[28:31], s66 offen offset:0 sc1
    buffer_load_dwordx4 v[172:175], v3, s[28:31], s66 offen offset:1024 sc1
    buffer_load_dwordx4 v[176:179], v217, s[28:31], 0 offen offset:0 sc1
    buffer_load_dwordx4 v[180:183], v217, s[28:31], 0 offen offset:896 sc1
    s_add_u32 s66, s66, 3584
    v_add_u32 v217, v218, v217
    v_mfma_f32_32x32x16_bf16 v[112:127], v[184:187], v[32:35], 0
    v_exp_f32 v128, v128
    v_exp_f32 v129, v129
    v_exp_f32 v130, v130
    v_exp_f32 v131, v131
    v_mfma_f32_32x32x16_bf16 v[48:63], v[192:195], v[144:147], v[48:63]
    v_exp_f32 v132, v132
    v_exp_f32 v133, v133
    v_exp_f32 v134, v134
    v_exp_f32 v135, v135
    v_cvt_pk_bf16_f32 v144, v128, v129
    v_cvt_pk_bf16_f32 v145, v130, v131
    v_mfma_f32_32x32x16_bf16 v[112:127], v[188:191], v[36:39], v[112:127]
    v_exp_f32 v136, v136
    v_exp_f32 v137, v137
    v_exp_f32 v138, v138
    v_exp_f32 v139, v139
    v_cvt_pk_bf16_f32 v146, v132, v133
    v_cvt_pk_bf16_f32 v147, v134, v135
    v_mfma_f32_32x32x16_bf16 v[48:63], v[196:199], v[148:151], v[48:63]
    v_exp_f32 v140, v140
    v_exp_f32 v141, v141
    v_exp_f32 v142, v142
    v_exp_f32 v143, v143
    v_cvt_pk_bf16_f32 v148, v136, v137
    v_cvt_pk_bf16_f32 v149, v138, v139
    v_cvt_pk_bf16_f32 v150, v140, v141
    v_cvt_pk_bf16_f32 v151, v142, v143
    s_waitcnt vmcnt(16)
    ds_read_b128 a[48:51], v12 offset:0
    ds_read_b128 a[52:55], v13 offset:0
    ds_read_b128 a[56:59], v14 offset:0
    ds_read_b128 a[60:63], v15 offset:0
    v_mfma_f32_32x32x16_bf16 v[128:143], v[184:187], v[40:43], 0
    v_exp_f32 v112, v112
    v_exp_f32 v113, v113
    v_exp_f32 v114, v114
    v_exp_f32 v115, v115
    v_mfma_f32_32x32x16_bf16 v[64:79], v[192:195], v[144:147], v[64:79]
    v_exp_f32 v116, v116
    v_exp_f32 v117, v117
    v_exp_f32 v118, v118
    v_exp_f32 v119, v119
    v_cvt_pk_bf16_f32 v144, v112, v113
    v_cvt_pk_bf16_f32 v145, v114, v115
    v_mfma_f32_32x32x16_bf16 v[128:143], v[188:191], v[44:47], v[128:143]
    v_exp_f32 v120, v120
    v_exp_f32 v121, v121
    v_exp_f32 v122, v122
    v_exp_f32 v123, v123
    v_cvt_pk_bf16_f32 v146, v116, v117
    v_cvt_pk_bf16_f32 v147, v118, v119
    v_mfma_f32_32x32x16_bf16 v[64:79], v[196:199], v[148:151], v[64:79]
    v_exp_f32 v124, v124
    v_exp_f32 v125, v125
    v_exp_f32 v126, v126
    v_exp_f32 v127, v127
    v_cvt_pk_bf16_f32 v148, v120, v121
    v_cvt_pk_bf16_f32 v149, v122, v123
    v_cvt_pk_bf16_f32 v150, v124, v125
    v_cvt_pk_bf16_f32 v151, v126, v127
    s_waitcnt lgkmcnt(0)
    s_add_u32 m0, s100, 8192
    s_movk_i32 s101, 640
    buffer_load_dwordx4 v234, s[92:95], s101 offen offset:0 lds
    buffer_load_dwordx4 v235, s[92:95], s101 offen offset:1024 lds
    buffer_load_dwordx4 v236, s[92:95], s101 offen offset:2048 lds
    buffer_load_dwordx4 v237, s[92:95], s101 offen offset:3072 lds
    v_mfma_f32_32x32x16_bf16 v[112:127], v[200:203], v[16:19], 0
    v_exp_f32 v128, v128
    v_exp_f32 v129, v129
    v_exp_f32 v130, v130
    v_exp_f32 v131, v131
    v_mfma_f32_32x32x16_bf16 v[80:95], v[192:195], v[144:147], v[80:95]
    v_exp_f32 v132, v132
    v_exp_f32 v133, v133
    v_exp_f32 v134, v134
    v_exp_f32 v135, v135
    v_cvt_pk_bf16_f32 v144, v128, v129
    v_cvt_pk_bf16_f32 v145, v130, v131
    v_mfma_f32_32x32x16_bf16 v[112:127], v[204:207], v[20:23], v[112:127]
    v_exp_f32 v136, v136
    v_exp_f32 v137, v137
    v_exp_f32 v138, v138
    v_exp_f32 v139, v139
    v_cvt_pk_bf16_f32 v146, v132, v133
    v_cvt_pk_bf16_f32 v147, v134, v135
    v_mfma_f32_32x32x16_bf16 v[80:95], v[196:199], v[148:151], v[80:95]
    v_exp_f32 v140, v140
    v_exp_f32 v141, v141
    v_exp_f32 v142, v142
    v_exp_f32 v143, v143
    v_cvt_pk_bf16_f32 v148, v136, v137
    v_cvt_pk_bf16_f32 v149, v138, v139
    v_cvt_pk_bf16_f32 v150, v140, v141
    v_cvt_pk_bf16_f32 v151, v142, v143
    s_add_u32 m0, s80, 10240
    s_mov_b32 s81, 71680
    buffer_load_dwordx4 v220, s[32:35], s81 offen offset:0 lds
    buffer_load_dwordx4 v221, s[32:35], s81 offen offset:1024 lds
    v_mfma_f32_32x32x16_bf16 v[128:143], v[200:203], v[24:27], 0
    v_exp_f32 v112, v112
    v_exp_f32 v113, v113
    v_exp_f32 v114, v114
    v_exp_f32 v115, v115
    v_mfma_f32_32x32x16_bf16 v[96:111], v[192:195], v[144:147], v[96:111]
    v_exp_f32 v116, v116
    v_exp_f32 v117, v117
    v_exp_f32 v118, v118
    v_exp_f32 v119, v119
    v_cvt_pk_bf16_f32 v144, v112, v113
    v_cvt_pk_bf16_f32 v145, v114, v115
    v_mfma_f32_32x32x16_bf16 v[128:143], v[204:207], v[28:31], v[128:143]
    v_exp_f32 v120, v120
    v_exp_f32 v121, v121
    v_exp_f32 v122, v122
    v_exp_f32 v123, v123
    v_cvt_pk_bf16_f32 v146, v116, v117
    v_cvt_pk_bf16_f32 v147, v118, v119
    v_mfma_f32_32x32x16_bf16 v[96:111], v[196:199], v[148:151], v[96:111]
    v_exp_f32 v124, v124
    v_exp_f32 v125, v125
    v_exp_f32 v126, v126
    v_exp_f32 v127, v127
    v_cvt_pk_bf16_f32 v148, v120, v121
    v_cvt_pk_bf16_f32 v149, v122, v123
    v_cvt_pk_bf16_f32 v150, v124, v125
    v_cvt_pk_bf16_f32 v151, v126, v127
    buffer_load_dwordx4 v[184:187], v3, s[28:31], s66 offen offset:0 sc1
    buffer_load_dwordx4 v[188:191], v3, s[28:31], s66 offen offset:1024 sc1
    buffer_load_dwordx4 v[192:195], v217, s[28:31], 0 offen offset:0 sc1
    buffer_load_dwordx4 v[196:199], v217, s[28:31], 0 offen offset:896 sc1
    s_add_u32 s66, s66, 3584
    v_add_u32 v217, v218, v217
    v_mfma_f32_32x32x16_bf16 v[112:127], v[200:203], v[32:35], 0
    v_exp_f32 v128, v128
    v_exp_f32 v129, v129
    v_exp_f32 v130, v130
    v_exp_f32 v131, v131
    v_mfma_f32_32x32x16_bf16 v[48:63], v[208:211], v[144:147], v[48:63]
    v_exp_f32 v132, v132
    v_exp_f32 v133, v133
    v_exp_f32 v134, v134
    v_exp_f32 v135, v135
    v_cvt_pk_bf16_f32 v144, v128, v129
    v_cvt_pk_bf16_f32 v145, v130, v131
    v_mfma_f32_32x32x16_bf16 v[112:127], v[204:207], v[36:39], v[112:127]
    v_exp_f32 v136, v136
    v_exp_f32 v137, v137
    v_exp_f32 v138, v138
    v_exp_f32 v139, v139
    v_cvt_pk_bf16_f32 v146, v132, v133
    v_cvt_pk_bf16_f32 v147, v134, v135
    v_mfma_f32_32x32x16_bf16 v[48:63], v[212:215], v[148:151], v[48:63]
    v_exp_f32 v140, v140
    v_exp_f32 v141, v141
    v_exp_f32 v142, v142
    v_exp_f32 v143, v143
    v_cvt_pk_bf16_f32 v148, v136, v137
    v_cvt_pk_bf16_f32 v149, v138, v139
    v_cvt_pk_bf16_f32 v150, v140, v141
    v_cvt_pk_bf16_f32 v151, v142, v143
    s_waitcnt vmcnt(16)
    ds_read_b128 a[64:67], v12 offset:4096
    ds_read_b128 a[68:71], v13 offset:4096
    ds_read_b128 a[72:75], v14 offset:4096
    ds_read_b128 a[76:79], v15 offset:4096
    v_mfma_f32_32x32x16_bf16 v[128:143], v[200:203], v[40:43], 0
    v_exp_f32 v112, v112
    v_exp_f32 v113, v113
    v_exp_f32 v114, v114
    v_exp_f32 v115, v115
    v_mfma_f32_32x32x16_bf16 v[64:79], v[208:211], v[144:147], v[64:79]
    v_exp_f32 v116, v116
    v_exp_f32 v117, v117
    v_exp_f32 v118, v118
    v_exp_f32 v119, v119
    v_cvt_pk_bf16_f32 v144, v112, v113
    v_cvt_pk_bf16_f32 v145, v114, v115
    v_mfma_f32_32x32x16_bf16 v[128:143], v[204:207], v[44:47], v[128:143]
    v_exp_f32 v120, v120
    v_exp_f32 v121, v121
    v_exp_f32 v122, v122
    v_exp_f32 v123, v123
    v_cvt_pk_bf16_f32 v146, v116, v117
    v_cvt_pk_bf16_f32 v147, v118, v119
    v_mfma_f32_32x32x16_bf16 v[64:79], v[212:215], v[148:151], v[64:79]
    v_exp_f32 v124, v124
    v_exp_f32 v125, v125
    v_exp_f32 v126, v126
    v_exp_f32 v127, v127
    v_cvt_pk_bf16_f32 v148, v120, v121
    v_cvt_pk_bf16_f32 v149, v122, v123
    v_cvt_pk_bf16_f32 v150, v124, v125
    v_cvt_pk_bf16_f32 v151, v126, v127
    s_waitcnt lgkmcnt(0)
    s_add_u32 m0, s100, 0
    s_movk_i32 s101, 768
    buffer_load_dwordx4 v234, s[92:95], s101 offen offset:0 lds
    buffer_load_dwordx4 v235, s[92:95], s101 offen offset:1024 lds
    buffer_load_dwordx4 v236, s[92:95], s101 offen offset:2048 lds
    buffer_load_dwordx4 v237, s[92:95], s101 offen offset:3072 lds
    v_mfma_f32_32x32x16_bf16 v[112:127], v[152:155], v[16:19], 0
    v_exp_f32 v128, v128
    v_exp_f32 v129, v129
    v_exp_f32 v130, v130
    v_exp_f32 v131, v131
    v_mfma_f32_32x32x16_bf16 v[80:95], v[208:211], v[144:147], v[80:95]
    v_exp_f32 v132, v132
    v_exp_f32 v133, v133
    v_exp_f32 v134, v134
    v_exp_f32 v135, v135
    v_cvt_pk_bf16_f32 v144, v128, v129
    v_cvt_pk_bf16_f32 v145, v130, v131
    v_mfma_f32_32x32x16_bf16 v[112:127], v[156:159], v[20:23], v[112:127]
    v_exp_f32 v136, v136
    v_exp_f32 v137, v137
    v_exp_f32 v138, v138
    v_exp_f32 v139, v139
    v_cvt_pk_bf16_f32 v146, v132, v133
    v_cvt_pk_bf16_f32 v147, v134, v135
    v_mfma_f32_32x32x16_bf16 v[80:95], v[212:215], v[148:151], v[80:95]
    v_exp_f32 v140, v140
    v_exp_f32 v141, v141
    v_exp_f32 v142, v142
    v_exp_f32 v143, v143
    v_cvt_pk_bf16_f32 v148, v136, v137
    v_cvt_pk_bf16_f32 v149, v138, v139
    v_cvt_pk_bf16_f32 v150, v140, v141
    v_cvt_pk_bf16_f32 v151, v142, v143
    s_add_u32 m0, s80, 12288
    s_mov_b32 s81, 86016
    buffer_load_dwordx4 v220, s[32:35], s81 offen offset:0 lds
    buffer_load_dwordx4 v221, s[32:35], s81 offen offset:1024 lds
    v_mfma_f32_32x32x16_bf16 v[128:143], v[152:155], v[24:27], 0
    v_exp_f32 v112, v112
    v_exp_f32 v113, v113
    v_exp_f32 v114, v114
    v_exp_f32 v115, v115
    v_mfma_f32_32x32x16_bf16 v[96:111], v[208:211], v[144:147], v[96:111]
    v_exp_f32 v116, v116
    v_exp_f32 v117, v117
    v_exp_f32 v118, v118
    v_exp_f32 v119, v119
    v_cvt_pk_bf16_f32 v144, v112, v113
    v_cvt_pk_bf16_f32 v145, v114, v115
    v_mfma_f32_32x32x16_bf16 v[128:143], v[156:159], v[28:31], v[128:143]
    v_exp_f32 v120, v120
    v_exp_f32 v121, v121
    v_exp_f32 v122, v122
    v_exp_f32 v123, v123
    v_cvt_pk_bf16_f32 v146, v116, v117
    v_cvt_pk_bf16_f32 v147, v118, v119
    v_mfma_f32_32x32x16_bf16 v[96:111], v[212:215], v[148:151], v[96:111]
    v_exp_f32 v124, v124
    v_exp_f32 v125, v125
    v_exp_f32 v126, v126
    v_exp_f32 v127, v127
    v_cvt_pk_bf16_f32 v148, v120, v121
    v_cvt_pk_bf16_f32 v149, v122, v123
    v_cvt_pk_bf16_f32 v150, v124, v125
    v_cvt_pk_bf16_f32 v151, v126, v127
    buffer_load_dwordx4 v[200:203], v3, s[28:31], s66 offen offset:0 sc1
    buffer_load_dwordx4 v[204:207], v3, s[28:31], s66 offen offset:1024 sc1
    buffer_load_dwordx4 v[208:211], v217, s[28:31], 0 offen offset:0 sc1
    buffer_load_dwordx4 v[212:215], v217, s[28:31], 0 offen offset:896 sc1
    s_add_u32 s66, s66, 3584
    v_add_u32 v217, v218, v217
    v_mfma_f32_32x32x16_bf16 v[112:127], v[152:155], v[32:35], 0
    v_exp_f32 v128, v128
    v_exp_f32 v129, v129
    v_exp_f32 v130, v130
    v_exp_f32 v131, v131
    v_mfma_f32_32x32x16_bf16 v[48:63], v[160:163], v[144:147], v[48:63]
    v_exp_f32 v132, v132
    v_exp_f32 v133, v133
    v_exp_f32 v134, v134
    v_exp_f32 v135, v135
    v_cvt_pk_bf16_f32 v144, v128, v129
    v_cvt_pk_bf16_f32 v145, v130, v131
    v_mfma_f32_32x32x16_bf16 v[112:127], v[156:159], v[36:39], v[112:127]
    v_exp_f32 v136, v136
    v_exp_f32 v137, v137
    v_exp_f32 v138, v138
    v_exp_f32 v139, v139
    v_cvt_pk_bf16_f32 v146, v132, v133
    v_cvt_pk_bf16_f32 v147, v134, v135
    v_mfma_f32_32x32x16_bf16 v[48:63], v[164:167], v[148:151], v[48:63]
    v_exp_f32 v140, v140
    v_exp_f32 v141, v141
    v_exp_f32 v142, v142
    v_exp_f32 v143, v143
    v_cvt_pk_bf16_f32 v148, v136, v137
    v_cvt_pk_bf16_f32 v149, v138, v139
    v_cvt_pk_bf16_f32 v150, v140, v141
    v_cvt_pk_bf16_f32 v151, v142, v143
    s_waitcnt vmcnt(16)
    ds_read_b128 a[80:83], v12 offset:8192
    ds_read_b128 a[84:87], v13 offset:8192
    ds_read_b128 a[88:91], v14 offset:8192
    ds_read_b128 a[92:95], v15 offset:8192
    v_mfma_f32_32x32x16_bf16 v[128:143], v[152:155], v[40:43], 0
    v_exp_f32 v112, v112
    v_exp_f32 v113, v113
    v_exp_f32 v114, v114
    v_exp_f32 v115, v115
    v_mfma_f32_32x32x16_bf16 v[64:79], v[160:163], v[144:147], v[64:79]
    v_exp_f32 v116, v116
    v_exp_f32 v117, v117
    v_exp_f32 v118, v118
    v_exp_f32 v119, v119
    v_cvt_pk_bf16_f32 v144, v112, v113
    v_cvt_pk_bf16_f32 v145, v114, v115
    v_mfma_f32_32x32x16_bf16 v[128:143], v[156:159], v[44:47], v[128:143]
    v_exp_f32 v120, v120
    v_exp_f32 v121, v121
    v_exp_f32 v122, v122
    v_exp_f32 v123, v123
    v_cvt_pk_bf16_f32 v146, v116, v117
    v_cvt_pk_bf16_f32 v147, v118, v119
    v_mfma_f32_32x32x16_bf16 v[64:79], v[164:167], v[148:151], v[64:79]
    v_exp_f32 v124, v124
    v_exp_f32 v125, v125
    v_exp_f32 v126, v126
    v_exp_f32 v127, v127
    v_cvt_pk_bf16_f32 v148, v120, v121
    v_cvt_pk_bf16_f32 v149, v122, v123
    v_cvt_pk_bf16_f32 v150, v124, v125
    v_cvt_pk_bf16_f32 v151, v126, v127
    s_waitcnt lgkmcnt(0)
    s_add_u32 m0, s100, 4096
    s_movk_i32 s101, 896
    buffer_load_dwordx4 v234, s[92:95], s101 offen offset:0 lds
    buffer_load_dwordx4 v235, s[92:95], s101 offen offset:1024 lds
    buffer_load_dwordx4 v236, s[92:95], s101 offen offset:2048 lds
    buffer_load_dwordx4 v237, s[92:95], s101 offen offset:3072 lds
    v_mfma_f32_32x32x16_bf16 v[112:127], v[168:171], v[16:19], 0
    v_exp_f32 v128, v128
    v_exp_f32 v129, v129
    v_exp_f32 v130, v130
    v_exp_f32 v131, v131
    v_mfma_f32_32x32x16_bf16 v[80:95], v[160:163], v[144:147], v[80:95]
    v_exp_f32 v132, v132
    v_exp_f32 v133, v133
    v_exp_f32 v134, v134
    v_exp_f32 v135, v135
    v_cvt_pk_bf16_f32 v144, v128, v129
    v_cvt_pk_bf16_f32 v145, v130, v131
    v_mfma_f32_32x32x16_bf16 v[112:127], v[172:175], v[20:23], v[112:127]
    v_exp_f32 v136, v136
    v_exp_f32 v137, v137
    v_exp_f32 v138, v138
    v_exp_f32 v139, v139
    v_cvt_pk_bf16_f32 v146, v132, v133
    v_cvt_pk_bf16_f32 v147, v134, v135
    v_mfma_f32_32x32x16_bf16 v[80:95], v[164:167], v[148:151], v[80:95]
    v_exp_f32 v140, v140
    v_exp_f32 v141, v141
    v_exp_f32 v142, v142
    v_exp_f32 v143, v143
    v_cvt_pk_bf16_f32 v148, v136, v137
    v_cvt_pk_bf16_f32 v149, v138, v139
    v_cvt_pk_bf16_f32 v150, v140, v141
    v_cvt_pk_bf16_f32 v151, v142, v143
    s_mul_i32 s80, s26, 14336
    s_add_u32 m0, s80, 57344
    s_mov_b32 s81, 0
    buffer_load_dwordx4 v222, s[36:39], s81 offen offset:0 lds
    buffer_load_dwordx4 v223, s[36:39], s81 offen offset:1024 lds
    v_mfma_f32_32x32x16_bf16 v[128:143], v[168:171], v[24:27], 0
    v_exp_f32 v112, v112
    v_exp_f32 v113, v113
    v_exp_f32 v114, v114
    v_exp_f32 v115, v115
    v_mfma_f32_32x32x16_bf16 v[96:111], v[160:163], v[144:147], v[96:111]
    v_exp_f32 v116, v116
    v_exp_f32 v117, v117
    v_exp_f32 v118, v118
    v_exp_f32 v119, v119
    v_cvt_pk_bf16_f32 v144, v112, v113
    v_cvt_pk_bf16_f32 v145, v114, v115
    v_mfma_f32_32x32x16_bf16 v[128:143], v[172:175], v[28:31], v[128:143]
    v_exp_f32 v120, v120
    v_exp_f32 v121, v121
    v_exp_f32 v122, v122
    v_exp_f32 v123, v123
    v_cvt_pk_bf16_f32 v146, v116, v117
    v_cvt_pk_bf16_f32 v147, v118, v119
    v_mfma_f32_32x32x16_bf16 v[96:111], v[164:167], v[148:151], v[96:111]
    v_exp_f32 v124, v124
    v_exp_f32 v125, v125
    v_exp_f32 v126, v126
    v_exp_f32 v127, v127
    v_cvt_pk_bf16_f32 v148, v120, v121
    v_cvt_pk_bf16_f32 v149, v122, v123
    v_cvt_pk_bf16_f32 v150, v124, v125
    v_cvt_pk_bf16_f32 v151, v126, v127
    buffer_load_dwordx4 v[152:155], v3, s[28:31], s66 offen offset:0 sc1
    buffer_load_dwordx4 v[156:159], v3, s[28:31], s66 offen offset:1024 sc1
    buffer_load_dwordx4 v[160:163], v217, s[28:31], 0 offen offset:0 sc1
    buffer_load_dwordx4 v[164:167], v217, s[28:31], 0 offen offset:896 sc1
    s_add_u32 s66, s66, 3584
    v_add_u32 v217, v218, v217
    v_mfma_f32_32x32x16_bf16 v[112:127], v[168:171], v[32:35], 0
    v_exp_f32 v128, v128
    v_exp_f32 v129, v129
    v_exp_f32 v130, v130
    v_exp_f32 v131, v131
    v_mfma_f32_32x32x16_bf16 v[48:63], v[176:179], v[144:147], v[48:63]
    v_exp_f32 v132, v132
    v_exp_f32 v133, v133
    v_exp_f32 v134, v134
    v_exp_f32 v135, v135
    v_cvt_pk_bf16_f32 v144, v128, v129
    v_cvt_pk_bf16_f32 v145, v130, v131
    v_mfma_f32_32x32x16_bf16 v[112:127], v[172:175], v[36:39], v[112:127]
    v_exp_f32 v136, v136
    v_exp_f32 v137, v137
    v_exp_f32 v138, v138
    v_exp_f32 v139, v139
    v_cvt_pk_bf16_f32 v146, v132, v133
    v_cvt_pk_bf16_f32 v147, v134, v135
    v_mfma_f32_32x32x16_bf16 v[48:63], v[180:183], v[148:151], v[48:63]
    v_exp_f32 v140, v140
    v_exp_f32 v141, v141
    v_exp_f32 v142, v142
    v_exp_f32 v143, v143
    v_cvt_pk_bf16_f32 v148, v136, v137
    s_branch L_pg5
    .p2align 12
L_stub5:
    s_setpc_b64 s[70:71]
L_pg5:
    v_cvt_pk_bf16_f32 v149, v138, v139
    v_cvt_pk_bf16_f32 v150, v140, v141
    v_cvt_pk_bf16_f32 v151, v142, v143
    s_waitcnt vmcnt(16)
    ds_read_b128 a[96:99], v12 offset:0
    ds_read_b128 a[100:103], v13 offset:0
    ds_read_b128 a[104:107], v14 offset:0
    ds_read_b128 a[108:111], v15 offset:0
    v_mfma_f32_32x32x16_bf16 v[128:143], v[168:171], v[40:43], 0
    v_exp_f32 v112, v112
    v_exp_f32 v113, v113
    v_exp_f32 v114, v114
    v_exp_f32 v115, v115
    v_mfma_f32_32x32x16_bf16 v[64:79], v[176:179], v[144:147], v[64:79]
    v_exp_f32 v116, v116
    v_exp_f32 v117, v117
    v_exp_f32 v118, v118
    v_exp_f32 v119, v119
    v_cvt_pk_bf16_f32 v144, v112, v113
    v_cvt_pk_bf16_f32 v145, v114, v115
    v_mfma_f32_32x32x16_bf16 v[128:143], v[172:175], v[44:47], v[128:143]
    v_exp_f32 v120, v120
    v_exp_f32 v121, v121
    v_exp_f32 v122, v122
    v_exp_f32 v123, v123
    v_cvt_pk_bf16_f32 v146, v116, v117
    v_cvt_pk_bf16_f32 v147, v118, v119
    v_mfma_f32_32x32x16_bf16 v[64:79], v[180:183], v[148:151], v[64:79]
    v_exp_f32 v124, v124
    v_exp_f32 v125, v125
    v_exp_f32 v126, v126
    v_exp_f32 v127, v127
    v_cvt_pk_bf16_f32 v148, v120, v121
    v_cvt_pk_bf16_f32 v149, v122, v123
    v_cvt_pk_bf16_f32 v150, v124, v125
    v_cvt_pk_bf16_f32 v151, v126, v127
    s_waitcnt lgkmcnt(0)
    s_add_u32 m0, s100, 8192
    s_movk_i32 s101, 1024
    buffer_load_dwordx4 v234, s[92:95], s101 offen offset:0 lds
    buffer_load_dwordx4 v235, s[92:95], s101 offen offset:1024 lds
    buffer_load_dwordx4 v236, s[92:95], s101 offen offset:2048 lds
    buffer_load_dwordx4 v237, s[92:95], s101 offen offset:3072 lds
    v_mfma_f32_32x32x16_bf16 v[112:127], v[184:187], v[16:19], 0
    v_exp_f32 v128, v128
    v_exp_f32 v129, v129
    v_exp_f32 v130, v130
    v_exp_f32 v131, v131
    v_mfma_f32_32x32x16_bf16 v[80:95], v[176:179], v[144:147], v[80:95]
    v_exp_f32 v132, v132
    v_exp_f32 v133, v133
    v_exp_f32 v134, v134
    v_exp_f32 v135, v135
    v_cvt_pk_bf16_f32 v144, v128, v129
    v_cvt_pk_bf16_f32 v145, v130, v131
    v_mfma_f32_32x32x16_bf16 v[112:127], v[188:191], v[20:23], v[112:127]
    v_exp_f32 v136, v136
    v_exp_f32 v137, v137
    v_exp_f32 v138, v138
    v_exp_f32 v139, v139
    v_cvt_pk_bf16_f32 v146, v132, v133
    v_cvt_pk_bf16_f32 v147, v134, v135
    v_mfma_f32_32x32x16_bf16 v[80:95], v[180:183], v[148:151], v[80:95]
    v_exp_f32 v140, v140
    v_exp_f32 v141, v141
    v_exp_f32 v142, v142
    v_exp_f32 v143, v143
    v_cvt_pk_bf16_f32 v148, v136, v137
    v_cvt_pk_bf16_f32 v149, v138, v139
    v_cvt_pk_bf16_f32 v150, v140, v141
    v_cvt_pk_bf16_f32 v151, v142, v143
    s_add_u32 m0, s80, 59392
    s_mov_b32 s81, 57344
    buffer_load_dwordx4 v222, s[36:39], s81 offen offset:0 lds
    buffer_load_dwordx4 v223, s[36:39], s81 offen offset:1024 lds
    v_mfma_f32_32x32x16_bf16 v[128:143], v[184:187], v[24:27], 0
    v_exp_f32 v112, v112
    v_exp_f32 v113, v113
    v_exp_f32 v114, v114
    v_exp_f32 v115, v115
    v_mfma_f32_32x32x16_bf16 v[96:111], v[176:179], v[144:147], v[96:111]
    v_exp_f32 v116, v116
    v_exp_f32 v117, v117
    v_exp_f32 v118, v118
    v_exp_f32 v119, v119
    v_cvt_pk_bf16_f32 v144, v112, v113
    v_cvt_pk_bf16_f32 v145, v114, v115
    v_mfma_f32_32x32x16_bf16 v[128:143], v[188:191], v[28:31], v[128:143]
    v_exp_f32 v120, v120
    v_exp_f32 v121, v121
    v_exp_f32 v122, v122
    v_exp_f32 v123, v123
    v_cvt_pk_bf16_f32 v146, v116, v117
    v_cvt_pk_bf16_f32 v147, v118, v119
    v_mfma_f32_32x32x16_bf16 v[96:111], v[180:183], v[148:151], v[96:111]
    v_exp_f32 v124, v124
    v_exp_f32 v125, v125
    v_exp_f32 v126, v126
    v_exp_f32 v127, v127
    v_cvt_pk_bf16_f32 v148, v120, v121
    v_cvt_pk_bf16_f32 v149, v122, v123
    v_cvt_pk_bf16_f32 v150, v124, v125
    v_cvt_pk_bf16_f32 v151, v126, v127
    buffer_load_dwordx4 v[168:171], v3, s[28:31], s66 offen offset:0 sc1
    buffer_load_dwordx4 v[172:175], v3, s[28:31], s66 offen offset:1024 sc1
    buffer_load_dwordx4 v[176:179], v217, s[28:31], 0 offen offset:0 sc1
    buffer_load_dwordx4 v[180:183], v217, s[28:31], 0 offen offset:896 sc1
    s_add_u32 s66, s66, 3584
    v_add_u32 v217, v218, v217
    v_mfma_f32_32x32x16_bf16 v[112:127], v[184:187], v[32:35], 0
    v_exp_f32 v128, v128
    v_exp_f32 v129, v129
    v_exp_f32 v130, v130
    v_exp_f32 v131, v131
    v_mfma_f32_32x32x16_bf16 v[48:63], v[192:195], v[144:147], v[48:63]
    v_exp_f32 v132, v132
    v_exp_f32 v133, v133
    v_exp_f32 v134, v134
    v_exp_f32 v135, v135
    v_cvt_pk_bf16_f32 v144, v128, v129
    v_cvt_pk_bf16_f32 v145, v130, v131
    v_mfma_f32_32x32x16_bf16 v[112:127], v[188:191], v[36:39], v[112:127]
    v_exp_f32 v136, v136
    v_exp_f32 v137, v137
    v_exp_f32 v138, v138
    v_exp_f32 v139, v139
    v_cvt_pk_bf16_f32 v146, v132, v133
    v_cvt_pk_bf16_f32 v147, v134, v135
    v_mfma_f32_32x32x16_bf16 v[48:63], v[196:199], v[148:151], v[48:63]
    v_exp_f32 v140, v140
    v_exp_f32 v141, v141
    v_exp_f32 v142, v142
    v_exp_f32 v143, v143
    v_cvt_pk_bf16_f32 v148, v136, v137
    v_cvt_pk_bf16_f32 v149, v138, v139
    v_cvt_pk_bf16_f32 v150, v140, v141
    v_cvt_pk_bf16_f32 v151, v142, v143
    s_waitcnt vmcnt(16)
    ds_read_b128 a[112:115], v12 offset:4096
    ds_read_b128 a[116:119], v13 offset:4096
    ds_read_b128 a[120:123], v14 offset:4096
    ds_read_b128 a[124:127], v15 offset:4096
    v_mfma_f32_32x32x16_bf16 v[128:143], v[184:187], v[40:43], 0
    v_exp_f32 v112, v112
    v_exp_f32 v113, v113
    v_exp_f32 v114, v114
    v_exp_f32 v115, v115
    v_mfma_f32_32x32x16_bf16 v[64:79], v[192:195], v[144:147], v[64:79]
    v_exp_f32 v116, v116
    v_exp_f32 v117, v117
    v_exp_f32 v118, v118
    v_exp_f32 v119, v119
    v_cvt_pk_bf16_f32 v144, v112, v113
    v_cvt_pk_bf16_f32 v145, v114, v115
    v_mfma_f32_32x32x16_bf16 v[128:143], v[188:191], v[44:47], v[128:143]
    v_exp_f32 v120, v120
    v_exp_f32 v121, v121
    v_exp_f32 v122, v122
    v_exp_f32 v123, v123
    v_cvt_pk_bf16_f32 v146, v116, v117
    v_cvt_pk_bf16_f32 v147, v118, v119
    v_mfma_f32_32x32x16_bf16 v[64:79], v[196:199], v[148:151], v[64:79]
    v_exp_f32 v124, v124
    v_exp_f32 v125, v125
    v_exp_f32 v126, v126
    v_exp_f32 v127, v127
    v_cvt_pk_bf16_f32 v148, v120, v121
    v_cvt_pk_bf16_f32 v149, v122, v123
    v_cvt_pk_bf16_f32 v150, v124, v125
    v_cvt_pk_bf16_f32 v151, v126, v127
    s_waitcnt lgkmcnt(0)
    s_add_u32 m0, s100, 0
    s_movk_i32 s101, 1152
    buffer_load_dwordx4 v234, s[92:95], s101 offen offset:0 lds
    buffer_load_dwordx4 v235, s[92:95], s101 offen offset:1024 lds
    buffer_load_dwordx4 v236, s[92:95], s101 offen offset:2048 lds
    buffer_load_dwordx4 v237, s[92:95], s101 offen offset:3072 lds
    v_mfma_f32_32x32x16_bf16 v[112:127], v[200:203], v[16:19], 0
    v_exp_f32 v128, v128
    v_exp_f32 v129, v129
    v_exp_f32 v130, v130
    v_exp_f32 v131, v131
    v_mfma_f32_32x32x16_bf16 v[80:95], v[192:195], v[144:147], v[80:95]
    v_exp_f32 v132, v132
    v_exp_f32 v133, v133
    v_exp_f32 v134, v134
    v_exp_f32 v135, v135
    v_cvt_pk_bf16_f32 v144, v128, v129
    v_cvt_pk_bf16_f32 v145, v130, v131
    v_mfma_f32_32x32x16_bf16 v[112:127], v[204:207], v[20:23], v[112:127]
    v_exp_f32 v136, v136
    v_exp_f32 v137, v137
    v_exp_f32 v138, v138
    v_exp_f32 v139, v139
    v_cvt_pk_bf16_f32 v146, v132, v133
    v_cvt_pk_bf16_f32 v147, v134, v135
    v_mfma_f32_32x32x16_bf16 v[80:95], v[196:199], v[148:151], v[80:95]
    v_exp_f32 v140, v140
    v_exp_f32 v141, v141
    v_exp_f32 v142, v142
    v_exp_f32 v143, v143
    v_cvt_pk_bf16_f32 v148, v136, v137
    v_cvt_pk_bf16_f32 v149, v138, v139
    v_cvt_pk_bf16_f32 v150, v140, v141
    v_cvt_pk_bf16_f32 v151, v142, v143
    s_add_u32 m0, s80, 61440
    s_mov_b32 s81, 114688
    buffer_load_dwordx4 v222, s[36:39], s81 offen offset:0 lds
    buffer_load_dwordx4 v223, s[36:39], s81 offen offset:1024 lds
    v_mfma_f32_32x32x16_bf16 v[128:143], v[200:203], v[24:27], 0
    v_exp_f32 v112, v112
    v_exp_f32 v113, v113
    v_exp_f32 v114, v114
    v_exp_f32 v115, v115
    v_mfma_f32_32x32x16_bf16 v[96:111], v[192:195], v[144:147], v[96:111]
    v_exp_f32 v116, v116
    v_exp_f32 v117, v117
    v_exp_f32 v118, v118
    v_exp_f32 v119, v119
    v_cvt_pk_bf16_f32 v144, v112, v113
    v_cvt_pk_bf16_f32 v145, v114, v115
    v_mfma_f32_32x32x16_bf16 v[128:143], v[204:207], v[28:31], v[128:143]
    v_exp_f32 v120, v120
    v_exp_f32 v121, v121
    v_exp_f32 v122, v122
    v_exp_f32 v123, v123
    v_cvt_pk_bf16_f32 v146, v116, v117
    v_cvt_pk_bf16_f32 v147, v118, v119
    v_mfma_f32_32x32x16_bf16 v[96:111], v[196:199], v[148:151], v[96:111]
    v_exp_f32 v124, v124
    v_exp_f32 v125, v125
    v_exp_f32 v126, v126
    v_exp_f32 v127, v127
    v_cvt_pk_bf16_f32 v148, v120, v121
    v_cvt_pk_bf16_f32 v149, v122, v123
    v_cvt_pk_bf16_f32 v150, v124, v125
    v_cvt_pk_bf16_f32 v151, v126, v127
    buffer_load_dwordx4 v[184:187], v3, s[28:31], s66 offen offset:0 sc1
    buffer_load_dwordx4 v[188:191], v3, s[28:31], s66 offen offset:1024 sc1
    buffer_load_dwordx4 v[192:195], v217, s[28:31], 0 offen offset:0 sc1
    buffer_load_dwordx4 v[196:199], v217, s[28:31], 0 offen offset:896 sc1
    s_add_u32 s66, s66, 3584
    v_add_u32 v217, v218, v217
    v_mfma_f32_32x32x16_bf16 v[112:127], v[200:203], v[32:35], 0
    v_exp_f32 v128, v128
    v_exp_f32 v129, v129
    v_exp_f32 v130, v130
    v_exp_f32 v131, v131
    v_mfma_f32_32x32x16_bf16 v[48:63], v[208:211], v[144:147], v[48:63]
    v_exp_f32 v132, v132
    v_exp_f32 v133, v133
    v_exp_f32 v134, v134
    v_exp_f32 v135, v135
    v_cvt_pk_bf16_f32 v144, v128, v129
    v_cvt_pk_bf16_f32 v145, v130, v131
    v_mfma_f32_32x32x16_bf16 v[112:127], v[204:207], v[36:39], v[112:127]
    v_exp_f32 v136, v136
    v_exp_f32 v137, v137
    v_exp_f32 v138, v138
    v_exp_f32 v139, v139
    v_cvt_pk_bf16_f32 v146, v132, v133
    v_cvt_pk_bf16_f32 v147, v134, v135
    v_mfma_f32_32x32x16_bf16 v[48:63], v[212:215], v[148:151], v[48:63]
    v_exp_f32 v140, v140
    v_exp_f32 v141, v141
    v_exp_f32 v142, v142
    v_exp_f32 v143, v143
    v_cvt_pk_bf16_f32 v148, v136, v137
    v_cvt_pk_bf16_f32 v149, v138, v139
    v_cvt_pk_bf16_f32 v150, v140, v141
    v_cvt_pk_bf16_f32 v151, v142, v143
    s_waitcnt vmcnt(16)
    ds_read_b128 a[128:131], v12 offset:8192
    ds_read_b128 a[132:135], v13 offset:8192
    ds_read_b128 a[136:139], v14 offset:8192
    ds_read_b128 a[140:143], v15 offset:8192
    v_mfma_f32_32x32x16_bf16 v[128:143], v[200:203], v[40:43], 0
    v_exp_f32 v112, v112
    v_exp_f32 v113, v113
    v_exp_f32 v114, v114
    v_exp_f32 v115, v115
    v_mfma_f32_32x32x16_bf16 v[64:79], v[208:211], v[144:147], v[64:79]
    v_exp_f32 v116, v116
    v_exp_f32 v117, v117
    v_exp_f32 v118, v118
    v_exp_f32 v119, v119
    v_cvt_pk_bf16_f32 v144, v112, v113
    v_cvt_pk_bf16_f32 v145, v114, v115
    v_mfma_f32_32x32x16_bf16 v[128:143], v[204:207], v[44:47], v[128:143]
    v_exp_f32 v120, v120
    v_exp_f32 v121, v121
    v_exp_f32 v122, v122
    v_exp_f32 v123, v123
    v_cvt_pk_bf16_f32 v146, v116, v117
    v_cvt_pk_bf16_f32 v147, v118, v119
    v_mfma_f32_32x32x16_bf16 v[64:79], v[212:215], v[148:151], v[64:79]
    v_exp_f32 v124, v124
    v_exp_f32 v125, v125
    v_exp_f32 v126, v126
    v_exp_f32 v127, v127
    v_cvt_pk_bf16_f32 v148, v120, v121
    v_cvt_pk_bf16_f32 v149, v122, v123
    v_cvt_pk_bf16_f32 v150, v124, v125
    v_cvt_pk_bf16_f32 v151, v126, v127
    s_waitcnt lgkmcnt(0)
    s_add_u32 m0, s100, 4096
    s_movk_i32 s101, 1280
    buffer_load_dwordx4 v234, s[92:95], s101 offen offset:0 lds
    buffer_load_dwordx4 v235, s[92:95], s101 offen offset:1024 lds
    buffer_load_dwordx4 v236, s[92:95], s101 offen offset:2048 lds
    buffer_load_dwordx4 v237, s[92:95], s101 offen offset:3072 lds
    v_mfma_f32_32x32x16_bf16 v[112:127], v[152:155], v[16:19], 0
    v_exp_f32 v128, v128
    v_exp_f32 v129, v129
    v_exp_f32 v130, v130
    v_exp_f32 v131, v131
    v_mfma_f32_32x32x16_bf16 v[80:95], v[208:211], v[144:147], v[80:95]
    v_exp_f32 v132, v132
    v_exp_f32 v133, v133
    v_exp_f32 v134, v134
    v_exp_f32 v135, v135
    v_cvt_pk_bf16_f32 v144, v128, v129
    v_cvt_pk_bf16_f32 v145, v130, v131
    v_mfma_f32_32x32x16_bf16 v[112:127], v[156:159], v[20:23], v[112:127]
    v_exp_f32 v136, v136
    v_exp_f32 v137, v137
    v_exp_f32 v138, v138
    v_exp_f32 v139, v139
    v_cvt_pk_bf16_f32 v146, v132, v133
    v_cvt_pk_bf16_f32 v147, v134, v135
    v_mfma_f32_32x32x16_bf16 v[80:95], v[212:215], v[148:151], v[80:95]
    v_exp_f32 v140, v140
    v_exp_f32 v141, v141
    v_exp_f32 v142, v142
    v_exp_f32 v143, v143
    v_cvt_pk_bf16_f32 v148, v136, v137
    v_cvt_pk_bf16_f32 v149, v138, v139
    v_cvt_pk_bf16_f32 v150, v140, v141
    v_cvt_pk_bf16_f32 v151, v142, v143
    s_add_u32 m0, s80, 63488
    s_mov_b32 s81, 172032
    buffer_load_dwordx4 v222, s[36:39], s81 offen offset:0 lds
    buffer_load_dwordx4 v223, s[36:39], s81 offen offset:1024 lds
    v_mfma_f32_32x32x16_bf16 v[128:143], v[152:155], v[24:27], 0
    v_exp_f32 v112, v112
    v_exp_f32 v113, v113
    v_exp_f32 v114, v114
    v_exp_f32 v115, v115
    v_mfma_f32_32x32x16_bf16 v[96:111], v[208:211], v[144:147], v[96:111]
    v_exp_f32 v116, v116
    v_exp_f32 v117, v117
    v_exp_f32 v118, v118
    v_exp_f32 v119, v119
    v_cvt_pk_bf16_f32 v144, v112, v113
    v_cvt_pk_bf16_f32 v145, v114, v115
    v_mfma_f32_32x32x16_bf16 v[128:143], v[156:159], v[28:31], v[128:143]
    v_exp_f32 v120, v120
    v_exp_f32 v121, v121
    v_exp_f32 v122, v122
    v_exp_f32 v123, v123
    v_cvt_pk_bf16_f32 v146, v116, v117
    v_cvt_pk_bf16_f32 v147, v118, v119
    v_mfma_f32_32x32x16_bf16 v[96:111], v[212:215], v[148:151], v[96:111]
    v_exp_f32 v124, v124
    v_exp_f32 v125, v125
    v_exp_f32 v126, v126
    v_exp_f32 v127, v127
    v_cvt_pk_bf16_f32 v148, v120, v121
    v_cvt_pk_bf16_f32 v149, v122, v123
    v_cvt_pk_bf16_f32 v150, v124, v125
    v_cvt_pk_bf16_f32 v151, v126, v127
    buffer_load_dwordx4 v[200:203], v3, s[28:31], s66 offen offset:0 sc1
    buffer_load_dwordx4 v[204:207], v3, s[28:31], s66 offen offset:1024 sc1
    buffer_load_dwordx4 v[208:211], v217, s[28:31], 0 offen offset:0 sc1
    buffer_load_dwordx4 v[212:215], v217, s[28:31], 0 offen offset:896 sc1
    v_mfma_f32_32x32x16_bf16 v[112:127], v[152:155], v[32:35], 0
    v_exp_f32 v128, v128
    v_exp_f32 v129, v129
    v_exp_f32 v130, v130
    v_exp_f32 v131, v131
    v_mfma_f32_32x32x16_bf16 v[48:63], v[160:163], v[144:147], v[48:63]
    v_exp_f32 v132, v132
    v_exp_f32 v133, v133
    v_exp_f32 v134, v134
    v_exp_f32 v135, v135
    v_cvt_pk_bf16_f32 v144, v128, v129
    v_cvt_pk_bf16_f32 v145, v130, v131
    v_mfma_f32_32x32x16_bf16 v[112:127], v[156:159], v[36:39], v[112:127]
    v_exp_f32 v136, v136
    v_exp_f32 v137, v137
    v_exp_f32 v138, v138
    v_exp_f32 v139, v139
    v_cvt_pk_bf16_f32 v146, v132, v133
    v_cvt_pk_bf16_f32 v147, v134, v135
    v_mfma_f32_32x32x16_bf16 v[48:63], v[164:167], v[148:151], v[48:63]
    v_exp_f32 v140, v140
    v_exp_f32 v141, v141
    v_exp_f32 v142, v142
    v_exp_f32 v143, v143
    v_cvt_pk_bf16_f32 v148, v136, v137
    v_cvt_pk_bf16_f32 v149, v138, v139
    v_cvt_pk_bf16_f32 v150, v140, v141
    v_cvt_pk_bf16_f32 v151, v142, v143
    s_waitcnt vmcnt(16)
    ds_read_b128 a[144:147], v12 offset:0
    ds_read_b128 a[148:151], v13 offset:0
    ds_read_b128 a[152:155], v14 offset:0
    ds_read_b128 a[156:159], v15 offset:0
    v_mfma_f32_32x32x16_bf16 v[128:143], v[152:155], v[40:43], 0
    v_exp_f32 v112, v112
    v_exp_f32 v113, v113
    v_exp_f32 v114, v114
    v_exp_f32 v115, v115
    v_mfma_f32_32x32x16_bf16 v[64:79], v[160:163], v[144:147], v[64:79]
    v_exp_f32 v116, v116
    v_exp_f32 v117, v117
    v_exp_f32 v118, v118
    v_exp_f32 v119, v119
    v_cvt_pk_bf16_f32 v144, v112, v113
    v_cvt_pk_bf16_f32 v145, v114, v115
    v_mfma_f32_32x32x16_bf16 v[128:143], v[156:159], v[44:47], v[128:143]
    v_exp_f32 v120, v120
    v_exp_f32 v121, v121
    v_exp_f32 v122, v122
    v_exp_f32 v123, v123
    v_cvt_pk_bf16_f32 v146, v116, v117
    v_cvt_pk_bf16_f32 v147, v118, v119
    v_mfma_f32_32x32x16_bf16 v[64:79], v[164:167], v[148:151], v[64:79]
    v_exp_f32 v124, v124
    v_exp_f32 v125, v125
    v_exp_f32 v126, v126
    v_exp_f32 v127, v127
    v_cvt_pk_bf16_f32 v148, v120, v121
    v_cvt_pk_bf16_f32 v149, v122, v123
    v_cvt_pk_bf16_f32 v150, v124, v125
    v_cvt_pk_bf16_f32 v151, v126, v127
    s_waitcnt lgkmcnt(0)
    s_add_u32 m0, s100, 8192
    s_movk_i32 s101, 1408
    buffer_load_dwordx4 v234, s[92:95], s101 offen offset:0 lds
    buffer_load_dwordx4 v235, s[92:95], s101 offen offset:1024 lds
    buffer_load_dwordx4 v236, s[92:95], s101 offen offset:2048 lds
    buffer_load_dwordx4 v237, s[92:95], s101 offen offset:3072 lds
    v_mfma_f32_32x32x16_bf16 v[112:127], v[168:171], v[16:19], 0
    v_exp_f32 v128, v128
    v_exp_f32 v129, v129
    v_exp_f32 v130, v130
    v_exp_f32 v131, v131
    v_mfma_f32_32x32x16_bf16 v[80:95], v[160:163], v[144:147], v[80:95]
    v_exp_f32 v132, v132
    v_exp_f32 v133, v133
    v_exp_f32 v134, v134
    v_exp_f32 v135, v135
    v_cvt_pk_bf16_f32 v144, v128, v129
    v_cvt_pk_bf16_f32 v145, v130, v131
    v_mfma_f32_32x32x16_bf16 v[112:127], v[172:175], v[20:23], v[112:127]
    v_exp_f32 v136, v136
    v_exp_f32 v137, v137
    v_exp_f32 v138, v138
    v_exp_f32 v139, v139
    v_cvt_pk_bf16_f32 v146, v132, v133
    v_cvt_pk_bf16_f32 v147, v134, v135
    v_mfma_f32_32x32x16_bf16 v[80:95], v[164:167], v[148:151], v[80:95]
    v_exp_f32 v140, v140
    v_exp_f32 v141, v141
    v_exp_f32 v142, v142
    v_exp_f32 v143, v143
    v_cvt_pk_bf16_f32 v148, v136, v137
    v_cvt_pk_bf16_f32 v149, v138, v139
    v_cvt_pk_bf16_f32 v150, v140, v141
    v_cvt_pk_bf16_f32 v151, v142, v143
    s_add_u32 m0, s80, 65536
    s_mov_b32 s81, 229376
    buffer_load_dwordx4 v222, s[36:39], s81 offen offset:0 lds
    buffer_load_dwordx4 v223, s[36:39], s81 offen offset:1024 lds
    v_mfma_f32_32x32x16_bf16 v[128:143], v[168:171], v[24:27], 0
    v_exp_f32 v112, v112
    v_exp_f32 v113, v113
    v_exp_f32 v114, v114
    v_exp_f32 v115, v115
    v_mfma_f32_32x32x16_bf16 v[96:111], v[160:163], v[144:147], v[96:111]
    v_exp_f32 v116, v116
    v_exp_f32 v117, v117
    v_exp_f32 v118, v118
    v_exp_f32 v119, v119
    v_cvt_pk_bf16_f32 v144, v112, v113
    v_cvt_pk_bf16_f32 v145, v114, v115
    v_mfma_f32_32x32x16_bf16 v[128:143], v[172:175], v[28:31], v[128:143]
    v_exp_f32 v120, v120
    v_exp_f32 v121, v121
    v_exp_f32 v122, v122
    v_exp_f32 v123, v123
    v_cvt_pk_bf16_f32 v146, v116, v117
    v_cvt_pk_bf16_f32 v147, v118, v119
    v_mfma_f32_32x32x16_bf16 v[96:111], v[164:167], v[148:151], v[96:111]
    v_exp_f32 v124, v124
    v_exp_f32 v125, v125
    v_exp_f32 v126, v126
    v_exp_f32 v127, v127
    v_cvt_pk_bf16_f32 v148, v120, v121
    v_cvt_pk_bf16_f32 v149, v122, v123
    v_cvt_pk_bf16_f32 v150, v124, v125
    v_cvt_pk_bf16_f32 v151, v126, v127
    v_mfma_f32_32x32x16_bf16 v[112:127], v[168:171], v[32:35], 0
    v_exp_f32 v128, v128
    v_exp_f32 v129, v129
    v_exp_f32 v130, v130
    v_exp_f32 v131, v131
    v_mfma_f32_32x32x16_bf16 v[48:63], v[176:179], v[144:147], v[48:63]
    v_exp_f32 v132, v132
    v_exp_f32 v133, v133
    v_exp_f32 v134, v134
    v_exp_f32 v135, v135
    v_cvt_pk_bf16_f32 v144, v128, v129
    v_cvt_pk_bf16_f32 v145, v130, v131
    v_mfma_f32_32x32x16_bf16 v[112:127], v[172:175], v[36:39], v[112:127]
    v_exp_f32 v136, v136
    v_exp_f32 v137, v137
    v_exp_f32 v138, v138
    v_exp_f32 v139, v139
    v_cvt_pk_bf16_f32 v146, v132, v133
    v_cvt_pk_bf16_f32 v147, v134, v135
    v_mfma_f32_32x32x16_bf16 v[48:63], v[180:183], v[148:151], v[48:63]
    v_exp_f32 v140, v140
    v_exp_f32 v141, v141
    v_exp_f32 v142, v142
    v_exp_f32 v143, v143
    v_cvt_pk_bf16_f32 v148, v136, v137
    v_cvt_pk_bf16_f32 v149, v138, v139
    v_cvt_pk_bf16_f32 v150, v140, v141
    v_cvt_pk_bf16_f32 v151, v142, v143
    s_waitcnt vmcnt(12)
    ds_read_b128 a[160:163], v12 offset:4096
    ds_read_b128 a[164:167], v13 offset:4096
    ds_read_b128 a[168:171], v14 offset:4096
    ds_read_b128 a[172:175], v15 offset:4096
    v_mfma_f32_32x32x16_bf16 v[128:143], v[168:171], v[40:43], 0
    v_exp_f32 v112, v112
    v_exp_f32 v113, v113
    v_exp_f32 v114, v114
    v_exp_f32 v115, v115
    v_mfma_f32_32x32x16_bf16 v[64:79], v[176:179], v[144:147], v[64:79]
    v_exp_f32 v116, v116
    v_exp_f32 v117, v117
    v_exp_f32 v118, v118
    v_exp_f32 v119, v119
    v_cvt_pk_bf16_f32 v144, v112, v113
    v_cvt_pk_bf16_f32 v145, v114, v115
    v_mfma_f32_32x32x16_bf16 v[128:143], v[172:175], v[44:47], v[128:143]
    v_exp_f32 v120, v120
    v_exp_f32 v121, v121
    v_exp_f32 v122, v122
    v_exp_f32 v123, v123
    v_cvt_pk_bf16_f32 v146, v116, v117
    v_cvt_pk_bf16_f32 v147, v118, v119
    v_mfma_f32_32x32x16_bf16 v[64:79], v[180:183], v[148:151], v[64:79]
    v_exp_f32 v124, v124
    v_exp_f32 v125, v125
    v_exp_f32 v126, v126
    v_exp_f32 v127, v127
    v_cvt_pk_bf16_f32 v148, v120, v121
    v_cvt_pk_bf16_f32 v149, v122, v123
    v_cvt_pk_bf16_f32 v150, v124, v125
    v_cvt_pk_bf16_f32 v151, v126, v127
    v_mfma_f32_32x32x16_bf16 v[112:127], v[184:187], v[16:19], 0
    v_exp_f32 v128, v128
    v_exp_f32 v129, v129
    v_exp_f32 v130, v130
    v_exp_f32 v131, v131
    v_mfma_f32_32x32x16_bf16 v[80:95], v[176:179], v[144:147], v[80:95]
    v_exp_f32 v132, v132
    v_exp_f32 v133, v133
    v_exp_f32 v134, v134
    v_exp_f32 v135, v135
    v_cvt_pk_bf16_f32 v144, v128, v129
    v_cvt_pk_bf16_f32 v145, v130, v131
    v_mfma_f32_32x32x16_bf16 v[112:127], v[188:191], v[20:23], v[112:127]
    v_exp_f32 v136, v136
    v_exp_f32 v137, v137
    v_exp_f32 v138, v138
    v_exp_f32 v139, v139
    v_cvt_pk_bf16_f32 v146, v132, v133
    v_cvt_pk_bf16_f32 v147, v134, v135
    v_mfma_f32_32x32x16_bf16 v[80:95], v[180:183], v[148:151], v[80:95]
    v_exp_f32 v140, v140
    v_exp_f32 v141, v141
    v_exp_f32 v142, v142
    v_exp_f32 v143, v143
    v_cvt_pk_bf16_f32 v148, v136, v137
    v_cvt_pk_bf16_f32 v149, v138, v139
    v_cvt_pk_bf16_f32 v150, v140, v141
    v_cvt_pk_bf16_f32 v151, v142, v143
    s_add_u32 m0, s80, 67584
    s_mov_b32 s81, 286720
    buffer_load_dwordx4 v222, s[36:39], s81 offen offset:0 lds
    buffer_load_dwordx4 v223, s[36:39], s81 offen offset:1024 lds
    v_mfma_f32_32x32x16_bf16 v[128:143], v[184:187], v[24:27], 0
    v_exp_f32 v112, v112
    v_exp_f32 v113, v113
    v_exp_f32 v114, v114
    v_exp_f32 v115, v115
    v_mfma_f32_32x32x16_bf16 v[96:111], v[176:179], v[144:147], v[96:111]
    v_exp_f32 v116, v116
    v_exp_f32 v117, v117
    v_exp_f32 v118, v118
    v_exp_f32 v119, v119
    v_cvt_pk_bf16_f32 v144, v112, v113
    v_cvt_pk_bf16_f32 v145, v114, v115
    v_mfma_f32_32x32x16_bf16 v[128:143], v[188:191], v[28:31], v[128:143]
    v_exp_f32 v120, v120
    v_exp_f32 v121, v121
    v_exp_f32 v122, v122
    v_exp_f32 v123, v123
    v_cvt_pk_bf16_f32 v146, v116, v117
    v_cvt_pk_bf16_f32 v147, v118, v119
    v_mfma_f32_32x32x16_bf16 v[96:111], v[180:183], v[148:151], v[96:111]
    v_exp_f32 v124, v124
    v_exp_f32 v125, v125
    v_exp_f32 v126, v126
    v_exp_f32 v127, v127
    v_cvt_pk_bf16_f32 v148, v120, v121
    v_cvt_pk_bf16_f32 v149, v122, v123
    v_cvt_pk_bf16_f32 v150, v124, v125
    v_cvt_pk_bf16_f32 v151, v126, v127
    v_mfma_f32_32x32x16_bf16 v[112:127], v[184:187], v[32:35], 0
    v_exp_f32 v128, v128
    v_exp_f32 v129, v129
    v_exp_f32 v130, v130
    v_exp_f32 v131, v131
    v_mfma_f32_32x32x16_bf16 v[48:63], v[192:195], v[144:147], v[48:63]
    v_exp_f32 v132, v132
    v_exp_f32 v133, v133
    v_exp_f32 v134, v134
    v_exp_f32 v135, v135
    v_cvt_pk_bf16_f32 v144, v128, v129
    v_cvt_pk_bf16_f32 v145, v130, v131
    v_mfma_f32_32x32x16_bf16 v[112:127], v[188:191], v[36:39], v[112:127]
    v_exp_f32 v136, v136
    v_exp_f32 v137, v137
    v_exp_f32 v138, v138
    v_exp_f32 v139, v139
    v_cvt_pk_bf16_f32 v146, v132, v133
    v_cvt_pk_bf16_f32 v147, v134, v135
    v_mfma_f32_32x32x16_bf16 v[48:63], v[196:199], v[148:151], v[48:63]
    v_exp_f32 v140, v140
    v_exp_f32 v141, v141
    v_exp_f32 v142, v142
    v_exp_f32 v143, v143
    v_cvt_pk_bf16_f32 v148, v136, v137
    v_cvt_pk_bf16_f32 v149, v138, v139
    v_cvt_pk_bf16_f32 v150, v140, v141
    v_cvt_pk_bf16_f32 v151, v142, v143
    s_waitcnt vmcnt(4)
    ds_read_b128 a[176:179], v12 offset:8192
    ds_read_b128 a[180:183], v13 offset:8192
    ds_read_b128 a[184:187], v14 offset:8192
    ds_read_b128 a[188:191], v15 offset:8192
    v_mfma_f32_32x32x16_bf16 v[128:143], v[184:187], v[40:43], 0
    v_exp_f32 v112, v112
    v_exp_f32 v113, v113
    v_exp_f32 v114, v114
    v_exp_f32 v115, v115
    v_mfma_f32_32x32x16_bf16 v[64:79], v[192:195], v[144:147], v[64:79]
    v_exp_f32 v116, v116
    v_exp_f32 v117, v117
    v_exp_f32 v118, v118
    v_exp_f32 v119, v119
    v_cvt_pk_bf16_f32 v144, v112, v113
    v_cvt_pk_bf16_f32 v145, v114, v115
    v_mfma_f32_32x32x16_bf16 v[128:143], v[188:191], v[44:47], v[128:143]
    v_exp_f32 v120, v120
    v_exp_f32 v121, v121
    v_exp_f32 v122, v122
    v_exp_f32 v123, v123
    v_cvt_pk_bf16_f32 v146, v116, v117
    v_cvt_pk_bf16_f32 v147, v118, v119
    v_mfma_f32_32x32x16_bf16 v[64:79], v[196:199], v[148:151], v[64:79]
    v_exp_f32 v124, v124
    v_exp_f32 v125, v125
    v_exp_f32 v126, v126
    v_exp_f32 v127, v127
    v_cvt_pk_bf16_f32 v148, v120, v121
    v_cvt_pk_bf16_f32 v149, v122, v123
    v_cvt_pk_bf16_f32 v150, v124, v125
    v_cvt_pk_bf16_f32 v151, v126, v127
    v_mfma_f32_32x32x16_bf16 v[112:127], v[200:203], v[16:19], 0
    v_exp_f32 v128, v128
    v_exp_f32 v129, v129
    v_exp_f32 v130, v130
    s_branch L_pg6
    .p2align 12
L_stub6:
    s_setpc_b64 s[70:71]
L_pg6:
    v_exp_f32 v131, v131
    v_mfma_f32_32x32x16_bf16 v[80:95], v[192:195], v[144:147], v[80:95]
    v_exp_f32 v132, v132
    v_exp_f32 v133, v133
    v_exp_f32 v134, v134
    v_exp_f32 v135, v135
    v_cvt_pk_bf16_f32 v144, v128, v129
    v_cvt_pk_bf16_f32 v145, v130, v131
    v_mfma_f32_32x32x16_bf16 v[112:127], v[204:207], v[20:23], v[112:127]
    v_exp_f32 v136, v136
    v_exp_f32 v137, v137
    v_exp_f32 v138, v138
    v_exp_f32 v139, v139
    v_cvt_pk_bf16_f32 v146, v132, v133
    v_cvt_pk_bf16_f32 v147, v134, v135
    v_mfma_f32_32x32x16_bf16 v[80:95], v[196:199], v[148:151], v[80:95]
    v_exp_f32 v140, v140
    v_exp_f32 v141, v141
    v_exp_f32 v142, v142
    v_exp_f32 v143, v143
    v_cvt_pk_bf16_f32 v148, v136, v137
    v_cvt_pk_bf16_f32 v149, v138, v139
    v_cvt_pk_bf16_f32 v150, v140, v141
    v_cvt_pk_bf16_f32 v151, v142, v143
    s_add_u32 m0, s80, 69632
    s_mov_b32 s81, 344064
    buffer_load_dwordx4 v222, s[36:39], s81 offen offset:0 lds
    buffer_load_dwordx4 v223, s[36:39], s81 offen offset:1024 lds
    v_mfma_f32_32x32x16_bf16 v[128:143], v[200:203], v[24:27], 0
    v_exp_f32 v112, v112
    v_exp_f32 v113, v113
    v_exp_f32 v114, v114
    v_exp_f32 v115, v115
    v_mfma_f32_32x32x16_bf16 v[96:111], v[192:195], v[144:147], v[96:111]
    v_exp_f32 v116, v116
    v_exp_f32 v117, v117
    v_exp_f32 v118, v118
    v_exp_f32 v119, v119
    v_cvt_pk_bf16_f32 v144, v112, v113
    v_cvt_pk_bf16_f32 v145, v114, v115
    v_mfma_f32_32x32x16_bf16 v[128:143], v[204:207], v[28:31], v[128:143]
    v_exp_f32 v120, v120
    v_exp_f32 v121, v121
    v_exp_f32 v122, v122
    v_exp_f32 v123, v123
    v_cvt_pk_bf16_f32 v146, v116, v117
    v_cvt_pk_bf16_f32 v147, v118, v119
    v_mfma_f32_32x32x16_bf16 v[96:111], v[196:199], v[148:151], v[96:111]
    v_exp_f32 v124, v124
    v_exp_f32 v125, v125
    v_exp_f32 v126, v126
    v_exp_f32 v127, v127
    v_cvt_pk_bf16_f32 v148, v120, v121
    v_cvt_pk_bf16_f32 v149, v122, v123
    v_cvt_pk_bf16_f32 v150, v124, v125
    v_cvt_pk_bf16_f32 v151, v126, v127
    v_mfma_f32_32x32x16_bf16 v[112:127], v[200:203], v[32:35], 0
    v_exp_f32 v128, v128
    v_exp_f32 v129, v129
    v_exp_f32 v130, v130
    v_exp_f32 v131, v131
    v_mfma_f32_32x32x16_bf16 v[48:63], v[208:211], v[144:147], v[48:63]
    v_exp_f32 v132, v132
    v_exp_f32 v133, v133
    v_exp_f32 v134, v134
    v_exp_f32 v135, v135
    v_cvt_pk_bf16_f32 v144, v128, v129
    v_cvt_pk_bf16_f32 v145, v130, v131
    v_mfma_f32_32x32x16_bf16 v[112:127], v[204:207], v[36:39], v[112:127]
    v_exp_f32 v136, v136
    v_exp_f32 v137, v137
    v_exp_f32 v138, v138
    v_exp_f32 v139, v139
    v_cvt_pk_bf16_f32 v146, v132, v133
    v_cvt_pk_bf16_f32 v147, v134, v135
    v_mfma_f32_32x32x16_bf16 v[48:63], v[212:215], v[148:151], v[48:63]
    v_exp_f32 v140, v140
    v_exp_f32 v141, v141
    v_exp_f32 v142, v142
    v_exp_f32 v143, v143
    v_cvt_pk_bf16_f32 v148, v136, v137
    v_cvt_pk_bf16_f32 v149, v138, v139
    v_cvt_pk_bf16_f32 v150, v140, v141
    v_cvt_pk_bf16_f32 v151, v142, v143
    s_waitcnt lgkmcnt(0)
    s_barrier
    v_mfma_f32_32x32x16_bf16 v[128:143], v[200:203], v[40:43], 0
    v_exp_f32 v112, v112
    v_exp_f32 v113, v113
    v_exp_f32 v114, v114
    v_exp_f32 v115, v115
    v_mfma_f32_32x32x16_bf16 v[64:79], v[208:211], v[144:147], v[64:79]
    v_exp_f32 v116, v116
    v_exp_f32 v117, v117
    v_exp_f32 v118, v118
    v_exp_f32 v119, v119
    v_cvt_pk_bf16_f32 v144, v112, v113
    v_cvt_pk_bf16_f32 v145, v114, v115
    v_mfma_f32_32x32x16_bf16 v[128:143], v[204:207], v[44:47], v[128:143]
    v_exp_f32 v120, v120
    v_exp_f32 v121, v121
    v_exp_f32 v122, v122
    v_exp_f32 v123, v123
    v_cvt_pk_bf16_f32 v146, v116, v117
    v_cvt_pk_bf16_f32 v147, v118, v119
    v_mfma_f32_32x32x16_bf16 v[64:79], v[212:215], v[148:151], v[64:79]
    v_exp_f32 v124, v124
    v_exp_f32 v125, v125
    v_exp_f32 v126, v126
    v_exp_f32 v127, v127
    v_cvt_pk_bf16_f32 v148, v120, v121
    v_cvt_pk_bf16_f32 v149, v122, v123
    v_cvt_pk_bf16_f32 v150, v124, v125
    v_cvt_pk_bf16_f32 v151, v126, v127
    v_exp_f32 v128, v128
    v_exp_f32 v129, v129
    v_exp_f32 v130, v130
    v_exp_f32 v131, v131
    v_mfma_f32_32x32x16_bf16 v[80:95], v[208:211], v[144:147], v[80:95]
    v_exp_f32 v132, v132
    v_exp_f32 v133, v133
    v_exp_f32 v134, v134
    v_exp_f32 v135, v135
    v_cvt_pk_bf16_f32 v144, v128, v129
    v_cvt_pk_bf16_f32 v145, v130, v131
    v_exp_f32 v136, v136
    v_exp_f32 v137, v137
    v_exp_f32 v138, v138
    v_exp_f32 v139, v139
    v_cvt_pk_bf16_f32 v146, v132, v133
    v_cvt_pk_bf16_f32 v147, v134, v135
    v_mfma_f32_32x32x16_bf16 v[80:95], v[212:215], v[148:151], v[80:95]
    v_exp_f32 v140, v140
    v_exp_f32 v141, v141
    v_exp_f32 v142, v142
    v_exp_f32 v143, v143
    v_cvt_pk_bf16_f32 v148, v136, v137
    v_cvt_pk_bf16_f32 v149, v138, v139
    v_cvt_pk_bf16_f32 v150, v140, v141
    v_cvt_pk_bf16_f32 v151, v142, v143
    v_mfma_f32_32x32x16_bf16 v[96:111], v[208:211], v[144:147], v[96:111]
    s_nop 0
    v_mfma_f32_32x32x16_bf16 v[96:111], v[212:215], v[148:151], v[96:111]
    ds_write_b128 v226, v[48:51] offset:0
    ds_write_b128 v226, v[52:55] offset:1024
    ds_write_b128 v226, v[56:59] offset:2048
    ds_write_b128 v226, v[60:63] offset:3072
    ds_write_b128 v227, v[64:67] offset:0
    ds_write_b128 v227, v[68:71] offset:1024
    ds_write_b128 v227, v[72:75] offset:2048
    ds_write_b128 v227, v[76:79] offset:3072
    ds_write_b128 v228, v[80:83] offset:0
    ds_write_b128 v228, v[84:87] offset:1024
    ds_write_b128 v228, v[88:91] offset:2048
    ds_write_b128 v228, v[92:95] offset:3072
    v_and_b32 v219, 15, v219
    v_cmp_ne_u32 vcc, s45, v219
    s_nop 1
    s_cmp_eq_u64 vcc, 0
    s_cselect_b32 s48, 1, 0
    s_waitcnt lgkmcnt(0)
    s_barrier
    ds_read_b128 v[48:51], v229 offset:0
    ds_read_b128 v[52:55], v229 offset:1024
    ds_read_b128 v[56:59], v229 offset:2048
    ds_read_b128 v[60:63], v229 offset:3072
    ds_read_b128 v[64:67], v229 offset:4096
    ds_read_b128 v[68:71], v229 offset:5120
    ds_read_b128 v[72:75], v229 offset:6144
    ds_read_b128 v[76:79], v229 offset:7168
    ds_read_b128 v[80:83], v229 offset:8192
    ds_read_b128 v[84:87], v229 offset:9216
    ds_read_b128 v[88:91], v229 offset:10240
    ds_read_b128 v[92:95], v229 offset:11264
    s_waitcnt lgkmcnt(8)
    v_pk_add_f32 v[96:97], v[96:97], v[48:49]
    v_pk_add_f32 v[98:99], v[98:99], v[50:51]
    v_pk_add_f32 v[100:101], v[100:101], v[52:53]
    v_pk_add_f32 v[102:103], v[102:103], v[54:55]
    v_pk_add_f32 v[104:105], v[104:105], v[56:57]
    v_pk_add_f32 v[106:107], v[106:107], v[58:59]
    v_pk_add_f32 v[108:109], v[108:109], v[60:61]
    v_pk_add_f32 v[110:111], v[110:111], v[62:63]
    s_waitcnt lgkmcnt(4)
    v_pk_add_f32 v[96:97], v[96:97], v[64:65]
    v_pk_add_f32 v[98:99], v[98:99], v[66:67]
    v_pk_add_f32 v[100:101], v[100:101], v[68:69]
    v_pk_add_f32 v[102:103], v[102:103], v[70:71]
    v_pk_add_f32 v[104:105], v[104:105], v[72:73]
    v_pk_add_f32 v[106:107], v[106:107], v[74:75]
    v_pk_add_f32 v[108:109], v[108:109], v[76:77]
    v_pk_add_f32 v[110:111], v[110:111], v[78:79]
    s_waitcnt lgkmcnt(0)
    v_pk_add_f32 v[96:97], v[96:97], v[80:81]
    v_pk_add_f32 v[98:99], v[98:99], v[82:83]
    v_pk_add_f32 v[100:101], v[100:101], v[84:85]
    v_pk_add_f32 v[102:103], v[102:103], v[86:87]
    v_pk_add_f32 v[104:105], v[104:105], v[88:89]
    v_pk_add_f32 v[106:107], v[106:107], v[90:91]
    v_pk_add_f32 v[108:109], v[108:109], v[92:93]
    v_pk_add_f32 v[110:111], v[110:111], v[94:95]
L_att_norm:
    v_mov_b32 v7, v108
    v_mov_b32 v8, v108
    s_nop 1
    v_permlane32_swap_b32 v7, v8
    v_cmp_gt_f32 vcc, 0x53800000, v8
    s_nop 1
    s_mov_b64 s[62:63], vcc
    v_cmp_lt_f32 vcc, 0x2b800000, v8
    s_nop 1
    s_and_b64 vcc, vcc, s[62:63]
    s_cmp_eq_u64 vcc, -1
    s_cbranch_scc0 L_att_slow
L_att_ok:
    v_rcp_f32 v8, v8
    s_nop 3
    v_pk_mul_f32 v[96:97], v[96:97], v[8:9] op_sel_hi:[1,0]
    v_pk_mul_f32 v[98:99], v[98:99], v[8:9] op_sel_hi:[1,0]
    v_pk_mul_f32 v[100:101], v[100:101], v[8:9] op_sel_hi:[1,0]
    v_pk_mul_f32 v[102:103], v[102:103], v[8:9] op_sel_hi:[1,0]
    v_pk_mul_f32 v[104:105], v[104:105], v[8:9] op_sel_hi:[1,0]
    v_pk_mul_f32 v[106:107], v[106:107], v[8:9] op_sel_hi:[1,0]
    v_pk_mul_f32 v[108:109], v[108:109], v[8:9] op_sel_hi:[1,0]
    v_pk_mul_f32 v[110:111], v[110:111], v[8:9] op_sel_hi:[1,0]
    v_cvt_pk_bf16_f32 v144, v96, v97
    v_cvt_pk_bf16_f32 v145, v98, v99
    v_cvt_pk_bf16_f32 v146, v100, v101
    v_cvt_pk_bf16_f32 v147, v102, v103
    v_cvt_pk_bf16_f32 v148, v104, v105
    v_cvt_pk_bf16_f32 v149, v106, v107
    v_cvt_pk_bf16_f32 v150, v108, v109
    v_cvt_pk_bf16_f32 v151, v110, v111
    v_cndmask_b32 v150, v150, 0, s[50:51]
    v_cndmask_b32 v151, v151, 0, s[50:51]
    buffer_store_dwordx4 v[144:147], v3, s[28:31], s73 offen offset:0 sc1
    buffer_store_dwordx4 v[148:151], v3, s[28:31], s73 offen offset:1024 sc1
    s_mul_i32 s62, s56, 28672
    s_add_u32 s62, s62, 0
    s_lshl_b32 s63, s56, 6
    v_xor_b32 v12, s63, v4
    v_xor_b32 v13, s63, v5
    v_add_u32 v12, s62, v12
    v_add_u32 v13, s62, v13
    s_lshl_b32 s62, s26, 12
    s_add_u32 s62, s62, 131072
    v_add_u32 v240, s62, v3
    v_xor_b32 v241, 0x2000, v240
    s_lshl_b32 s66, s57, 15
    s_lshl_b32 s63, s56, 14
    s_add_u32 s66, s66, s63
    s_add_u32 s66, s66, 6291456
    ds_read_b64_tr_b16 v[112:113], v12 offset:0
    ds_read_b64_tr_b16 v[114:115], v12 offset:512
    ds_read_b64_tr_b16 v[116:117], v13 offset:0
    ds_read_b64_tr_b16 v[118:119], v13 offset:512
    ds_read_b64_tr_b16 v[120:121], v12 offset:2048
    ds_read_b64_tr_b16 v[122:123], v12 offset:2560
    ds_read_b64_tr_b16 v[124:125], v13 offset:2048
    ds_read_b64_tr_b16 v[126:127], v13 offset:2560
    ds_read_b64_tr_b16 v[128:129], v12 offset:3584
    ds_read_b64_tr_b16 v[130:131], v12 offset:4096
    ds_read_b64_tr_b16 v[132:133], v13 offset:3584
    ds_read_b64_tr_b16 v[134:135], v13 offset:4096
    ds_read_b64_tr_b16 v[136:137], v12 offset:5632
    ds_read_b64_tr_b16 v[138:139], v12 offset:6144
    ds_read_b64_tr_b16 v[140:141], v13 offset:5632
    ds_read_b64_tr_b16 v[142:143], v13 offset:6144
    ds_read_b64_tr_b16 v[144:145], v12 offset:7168
    ds_read_b64_tr_b16 v[146:147], v12 offset:7680
    ds_read_b64_tr_b16 v[148:149], v13 offset:7168
    ds_read_b64_tr_b16 v[150:151], v13 offset:7680
    ds_read_b64_tr_b16 v[152:153], v12 offset:9216
    ds_read_b64_tr_b16 v[154:155], v12 offset:9728
    ds_read_b64_tr_b16 v[156:157], v13 offset:9216
    ds_read_b64_tr_b16 v[158:159], v13 offset:9728
    ds_read_b64_tr_b16 v[160:161], v12 offset:10752
    ds_read_b64_tr_b16 v[162:163], v12 offset:11264
    ds_read_b64_tr_b16 v[164:165], v13 offset:10752
    ds_read_b64_tr_b16 v[166:167], v13 offset:11264
    ds_read_b64_tr_b16 v[168:169], v12 offset:12800
    ds_read_b64_tr_b16 v[170:171], v12 offset:13312
    ds_read_b64_tr_b16 v[172:173], v13 offset:12800
    ds_read_b64_tr_b16 v[174:175], v13 offset:13312
    ds_read_b64_tr_b16 v[176:177], v12 offset:14336
    ds_read_b64_tr_b16 v[178:179], v12 offset:14848
    ds_read_b64_tr_b16 v[180:181], v13 offset:14336
    ds_read_b64_tr_b16 v[182:183], v13 offset:14848
    ds_read_b64_tr_b16 v[184:185], v12 offset:16384
    ds_read_b64_tr_b16 v[186:187], v12 offset:16896
    ds_read_b64_tr_b16 v[188:189], v13 offset:16384
    ds_read_b64_tr_b16 v[190:191], v13 offset:16896
    ds_read_b64_tr_b16 v[192:193], v12 offset:17920
    ds_read_b64_tr_b16 v[194:195], v12 offset:18432
    ds_read_b64_tr_b16 v[196:197], v13 offset:17920
    ds_read_b64_tr_b16 v[198:199], v13 offset:18432
    ds_read_b64_tr_b16 v[200:201], v12 offset:19968
    ds_read_b64_tr_b16 v[202:203], v12 offset:20480
    ds_read_b64_tr_b16 v[204:205], v13 offset:19968
    ds_read_b64_tr_b16 v[206:207], v13 offset:20480
    ds_read_b64_tr_b16 v[208:209], v12 offset:21504
    ds_read_b64_tr_b16 v[210:211], v12 offset:22016
    ds_read_b64_tr_b16 v[212:213], v13 offset:21504
    ds_read_b64_tr_b16 v[214:215], v13 offset:22016
    ds_read_b64_tr_b16 v[216:217], v12 offset:23552
    ds_read_b64_tr_b16 v[218:219], v12 offset:24064
    ds_read_b64_tr_b16 v[220:221], v13 offset:23552
    ds_read_b64_tr_b16 v[222:223], v13 offset:24064
    ds_read_b64_tr_b16 v[224:225], v12 offset:25088
    ds_read_b64_tr_b16 v[226:227], v12 offset:25600
    ds_read_b64_tr_b16 v[228:229], v13 offset:25088
    ds_read_b64_tr_b16 v[230:231], v13 offset:25600
    ds_read_b64_tr_b16 v[232:233], v12 offset:27136
    ds_read_b64_tr_b16 v[234:235], v12 offset:27648
    ds_read_b64_tr_b16 v[236:237], v13 offset:27136
    ds_read_b64_tr_b16 v[238:239], v13 offset:27648
    s_lshl_b32 s62, s55, 1
    s_add_u32 s62, s62, s56
    s_mul_i32 s64, s57, 28672
    s_lshl_b32 s63, s62, 11
    s_add_u32 s64, s64, s63
    s_add_u32 s64, s64, 8388608
    s_lshl_b32 s65, s57, 12
    s_lshl_b32 s63, s62, 8
    s_add_u32 s65, s65, s63
    s_add_u32 s65, s65, 1572864
    v_lshlrev_b32 v10, 3, v2
    s_lshl_b32 s68, s27, 7
    s_add_u32 s68, s68, 4096
    s_waitcnt lgkmcnt(0)
    s_add_u32 s67, s77, 4096
    v_mov_b32 v8, s46
    v_mov_b32 v9, s47
    s_cmp_eq_u32 s26, 0
    s_waitcnt vmcnt(0)
    s_barrier
    s_cbranch_scc0 L_pub_15
    s_mov_b64 exec, 1
    s_cmp_eq_u32 s48, 1
    s_cbranch_scc1 L_plain_16
    buffer_store_dwordx2 v[8:9], v0, s[28:31], s67 offen sc1
    s_branch L_join_17
L_plain_16:
    buffer_store_dwordx2 v[8:9], v0, s[28:31], s67 offen
L_join_17:
    s_mov_b64 exec, -1
L_pub_15:
    s_cmp_ge_u32 s44, 14
    s_cbranch_scc1 L_fin
    s_cmp_eq_u32 s26, 0
    s_cbranch_scc0 L_pollskip_18
    v_lshlrev_b32 v7, 3, v0
    s_mov_b64 exec, 0xffff
    s_mov_b32 s72, 0
L_poll_19:
    buffer_load_dwordx2 v[8:9], v7, s[28:31], s68 offen sc1
    s_add_u32 s72, s72, 1
    s_waitcnt vmcnt(0)
    v_cmp_ne_u64 vcc, s[46:47], v[8:9]
    s_cbranch_vccz L_poll_19_d
    s_cmp_lt_u32 s72, 100000
    s_cbranch_scc1 L_poll_19
L_poll_19_d:
    s_mov_b64 exec, -1
L_pollskip_18:
    s_barrier
    buffer_load_dwordx4 v[16:19], v3, s[28:31], s66 offen offset:0 sc1
    buffer_load_dwordx4 v[20:23], v3, s[28:31], s66 offen offset:1024 sc1
    buffer_load_dwordx4 v[24:27], v3, s[28:31], s66 offen offset:2048 sc1
    buffer_load_dwordx4 v[28:31], v3, s[28:31], s66 offen offset:3072 sc1
    s_add_u32 s66, s66, 4096
    buffer_load_dwordx4 v[32:35], v3, s[28:31], s66 offen offset:0 sc1
    buffer_load_dwordx4 v[36:39], v3, s[28:31], s66 offen offset:1024 sc1
    buffer_load_dwordx4 v[40:43], v3, s[28:31], s66 offen offset:2048 sc1
    buffer_load_dwordx4 v[44:47], v3, s[28:31], s66 offen offset:3072 sc1
    s_add_u32 s66, s66, 4096
    buffer_load_dwordx4 v[48:51], v3, s[28:31], s66 offen offset:0 sc1
    buffer_load_dwordx4 v[52:55], v3, s[28:31], s66 offen offset:1024 sc1
    buffer_load_dwordx4 v[56:59], v3, s[28:31], s66 offen offset:2048 sc1
    s_waitcnt vmcnt(10)
    v_mfma_f32_32x32x16_bf16 v[80:95], v[112:115], v[16:19], 0
    v_mfma_f32_32x32x16_bf16 v[96:111], v[116:119], v[16:19], 0
    buffer_load_dwordx4 v[60:63], v3, s[28:31], s66 offen offset:3072 sc1
    s_waitcnt vmcnt(10)
    v_mfma_f32_32x32x16_bf16 v[80:95], v[120:123], v[20:23], v[80:95]
    v_mfma_f32_32x32x16_bf16 v[96:111], v[124:127], v[20:23], v[96:111]
    s_add_u32 s66, s66, 4096
    buffer_load_dwordx4 v[64:67], v3, s[28:31], s66 offen offset:0 sc1
    s_waitcnt vmcnt(10)
    v_mfma_f32_32x32x16_bf16 v[80:95], v[128:131], v[24:27], v[80:95]
    v_mfma_f32_32x32x16_bf16 v[96:111], v[132:135], v[24:27], v[96:111]
    buffer_load_dwordx4 v[68:71], v3, s[28:31], s66 offen offset:1024 sc1
    s_waitcnt vmcnt(10)
    v_mfma_f32_32x32x16_bf16 v[80:95], v[136:139], v[28:31], v[80:95]
    v_mfma_f32_32x32x16_bf16 v[96:111], v[140:143], v[28:31], v[96:111]
    buffer_load_dwordx4 v[72:75], v3, s[28:31], s66 offen offset:2048 sc1
    s_waitcnt vmcnt(10)
    v_mfma_f32_32x32x16_bf16 v[80:95], v[144:147], v[32:35], v[80:95]
    v_mfma_f32_32x32x16_bf16 v[96:111], v[148:151], v[32:35], v[96:111]
    buffer_load_dwordx4 v[76:79], v3, s[28:31], s66 offen offset:3072 sc1
    s_waitcnt vmcnt(10)
    v_mfma_f32_32x32x16_bf16 v[80:95], v[152:155], v[36:39], v[80:95]
    v_mfma_f32_32x32x16_bf16 v[96:111], v[156:159], v[36:39], v[96:111]
    s_waitcnt vmcnt(9)
    v_mfma_f32_32x32x16_bf16 v[80:95], v[160:163], v[40:43], v[80:95]
    v_mfma_f32_32x32x16_bf16 v[96:111], v[164:167], v[40:43], v[96:111]
    s_waitcnt vmcnt(8)
    v_mfma_f32_32x32x16_bf16 v[80:95], v[168:171], v[44:47], v[80:95]
    v_mfma_f32_32x32x16_bf16 v[96:111], v[172:175], v[44:47], v[96:111]
    s_waitcnt vmcnt(7)
    v_mfma_f32_32x32x16_bf16 v[80:95], v[176:179], v[48:51], v[80:95]
    v_mfma_f32_32x32x16_bf16 v[96:111], v[180:183], v[48:51], v[96:111]
    s_waitcnt vmcnt(6)
    v_mfma_f32_32x32x16_bf16 v[80:95], v[184:187], v[52:55], v[80:95]
    v_mfma_f32_32x32x16_bf16 v[96:111], v[188:191], v[52:55], v[96:111]
    s_waitcnt vmcnt(5)
    v_mfma_f32_32x32x16_bf16 v[80:95], v[192:195], v[56:59], v[80:95]
    v_mfma_f32_32x32x16_bf16 v[96:111], v[196:199], v[56:59], v[96:111]
    s_waitcnt vmcnt(4)
    v_mfma_f32_32x32x16_bf16 v[80:95], v[200:203], v[60:63], v[80:95]
    v_mfma_f32_32x32x16_bf16 v[96:111], v[204:207], v[60:63], v[96:111]
    s_waitcnt vmcnt(3)
    v_mfma_f32_32x32x16_bf16 v[80:95], v[208:211], v[64:67], v[80:95]
    v_mfma_f32_32x32x16_bf16 v[96:111], v[212:215], v[64:67], v[96:111]
    s_waitcnt vmcnt(2)
    v_mfma_f32_32x32x16_bf16 v[80:95], v[216:219], v[68:71], v[80:95]
    v_mfma_f32_32x32x16_bf16 v[96:111], v[220:223], v[68:71], v[96:111]
    s_waitcnt vmcnt(1)
    v_mfma_f32_32x32x16_bf16 v[80:95], v[224:227], v[72:75], v[80:95]
    v_mfma_f32_32x32x16_bf16 v[96:111], v[228:231], v[72:75], v[96:111]
    s_waitcnt vmcnt(0)
    v_mfma_f32_32x32x16_bf16 v[80:95], v[232:235], v[76:79], v[80:95]
    v_mfma_f32_32x32x16_bf16 v[96:111], v[236:239], v[76:79], v[96:111]
    v_lshlrev_b32 v32, 16, v244
    v_and_b32 v33, 0xffff0000, v244
    v_lshlrev_b32 v34, 16, v245
    v_and_b32 v35, 0xffff0000, v245
    v_lshlrev_b32 v36, 16, v246
    v_and_b32 v37, 0xffff0000, v246
    v_lshlrev_b32 v38, 16, v247
    v_and_b32 v39, 0xffff0000, v247
    v_lshlrev_b32 v40, 16, v248
    v_and_b32 v41, 0xffff0000, v248
    v_lshlrev_b32 v42, 16, v249
    v_and_b32 v43, 0xffff0000, v249
    v_lshlrev_b32 v44, 16, v250
    v_and_b32 v45, 0xffff0000, v250
    v_lshlrev_b32 v46, 16, v251
    v_and_b32 v47, 0xffff0000, v251
    ds_write_b128 v240, v[96:99] offset:0
    ds_write_b128 v240, v[100:103] offset:1024
    ds_write_b128 v240, v[104:107] offset:2048
    ds_write_b128 v240, v[108:111] offset:3072
    v_pk_add_f32 v[80:81], v[80:81], v[32:33]
    v_pk_add_f32 v[82:83], v[82:83], v[34:35]
    v_pk_add_f32 v[84:85], v[84:85], v[36:37]
    v_pk_add_f32 v[86:87], v[86:87], v[38:39]
    v_pk_add_f32 v[88:89], v[88:89], v[40:41]
    v_pk_add_f32 v[90:91], v[90:91], v[42:43]
    v_pk_add_f32 v[92:93], v[92:93], v[44:45]
    v_pk_add_f32 v[94:95], v[94:95], v[46:47]
    s_waitcnt lgkmcnt(0)
    s_barrier
    ds_read_b128 v[16:19], v241 offset:0
    ds_read_b128 v[20:23], v241 offset:1024
    ds_read_b128 v[24:27], v241 offset:2048
    ds_read_b128 v[28:31], v241 offset:3072
    s_waitcnt lgkmcnt(3)
    v_pk_add_f32 v[80:81], v[80:81], v[16:17]
    v_pk_add_f32 v[82:83], v[82:83], v[18:19]
    s_waitcnt lgkmcnt(2)
    v_pk_add_f32 v[84:85], v[84:85], v[20:21]
    v_pk_add_f32 v[86:87], v[86:87], v[22:23]
    s_waitcnt lgkmcnt(1)
    v_pk_add_f32 v[88:89], v[88:89], v[24:25]
    v_pk_add_f32 v[90:91], v[90:91], v[26:27]
    s_waitcnt lgkmcnt(0)
    v_pk_add_f32 v[92:93], v[92:93], v[28:29]
    v_pk_add_f32 v[94:95], v[94:95], v[30:31]
    v_cvt_pk_bf16_f32 v244, v80, v81
    v_cvt_pk_bf16_f32 v245, v82, v83
    v_cvt_pk_bf16_f32 v246, v84, v85
    v_cvt_pk_bf16_f32 v247, v86, v87
    v_cvt_pk_bf16_f32 v248, v88, v89
    v_cvt_pk_bf16_f32 v249, v90, v91
    v_cvt_pk_bf16_f32 v250, v92, v93
    v_cvt_pk_bf16_f32 v251, v94, v95
    buffer_store_dwordx4 v[244:247], v3, s[28:31], s64 offen offset:0 sc1
    buffer_store_dwordx4 v[248:251], v3, s[28:31], s64 offen offset:1024 sc1
    v_pk_mul_f32 v[16:17], v[80:81], v[80:81]
    v_pk_fma_f32 v[16:17], v[82:83], v[82:83], v[16:17]
    v_pk_add_f32 v[80:81], v[80:81], v[82:83]
    v_pk_fma_f32 v[16:17], v[84:85], v[84:85], v[16:17]
    v_pk_add_f32 v[80:81], v[80:81], v[84:85]
    v_pk_fma_f32 v[16:17], v[86:87], v[86:87], v[16:17]
    v_pk_add_f32 v[80:81], v[80:81], v[86:87]
    v_pk_fma_f32 v[16:17], v[88:89], v[88:89], v[16:17]
    v_pk_add_f32 v[80:81], v[80:81], v[88:89]
    v_pk_fma_f32 v[16:17], v[90:91], v[90:91], v[16:17]
    v_pk_add_f32 v[80:81], v[80:81], v[90:91]
    v_pk_fma_f32 v[16:17], v[92:93], v[92:93], v[16:17]
    v_pk_add_f32 v[80:81], v[80:81], v[92:93]
    v_pk_fma_f32 v[16:17], v[94:95], v[94:95], v[16:17]
    v_pk_add_f32 v[80:81], v[80:81], v[94:95]
    v_add_f32 v80, v80, v81
    v_add_f32 v81, v16, v17
    v_mov_b32 v16, v80
    v_mov_b32 v17, v81
    s_nop 0
    v_permlane32_swap_b32 v16, v80
    v_permlane32_swap_b32 v17, v81
    v_add_f32 v80, v80, v16
    v_add_f32 v81, v81, v17
    buffer_store_dwordx2 v[80:81], v10, s[28:31], s65 offen offset:0 sc1
    s_mul_i32 s62, s26, 14336
    s_add_u32 s62, s62, 57344
    v_add_u32 v7, s62, v4
    v_add_u32 v8, s62, v5
    ds_read_b64_tr_b16 v[16:17], v7 offset:0
    ds_read_b64_tr_b16 v[18:19], v7 offset:512
    ds_read_b64_tr_b16 v[44:45], v8 offset:0
    ds_read_b64_tr_b16 v[46:47], v8 offset:512
    ds_read_b64_tr_b16 v[20:21], v7 offset:2048
    ds_read_b64_tr_b16 v[22:23], v7 offset:2560
    ds_read_b64_tr_b16 v[48:49], v8 offset:2048
    ds_read_b64_tr_b16 v[50:51], v8 offset:2560
    ds_read_b64_tr_b16 v[24:25], v7 offset:4096
    ds_read_b64_tr_b16 v[26:27], v7 offset:4608
    ds_read_b64_tr_b16 v[52:53], v8 offset:4096
    ds_read_b64_tr_b16 v[54:55], v8 offset:4608
    ds_read_b64_tr_b16 v[28:29], v7 offset:6144
    ds_read_b64_tr_b16 v[30:31], v7 offset:6656
    ds_read_b64_tr_b16 v[56:57], v8 offset:6144
    ds_read_b64_tr_b16 v[58:59], v8 offset:6656
    ds_read_b64_tr_b16 v[32:33], v7 offset:8192
    ds_read_b64_tr_b16 v[34:35], v7 offset:8704
    ds_read_b64_tr_b16 v[60:61], v8 offset:8192
    ds_read_b64_tr_b16 v[62:63], v8 offset:8704
    ds_read_b64_tr_b16 v[36:37], v7 offset:10240
    ds_read_b64_tr_b16 v[38:39], v7 offset:10752
    ds_read_b64_tr_b16 v[64:65], v8 offset:10240
    ds_read_b64_tr_b16 v[66:67], v8 offset:10752
    ds_read_b64_tr_b16 v[40:41], v7 offset:12288
    ds_read_b64_tr_b16 v[42:43], v7 offset:12800
    ds_read_b64_tr_b16 v[68:69], v8 offset:12288
    ds_read_b64_tr_b16 v[70:71], v8 offset:12800
    s_waitcnt lgkmcnt(15)
    v_mfma_f32_16x16x32_bf16 v[72:75], a[252:255], v[16:19], 0
    v_mfma_f32_16x16x32_bf16 v[76:79], a[252:255], v[44:47], 0
    v_mfma_f32_16x16x32_bf16 v[72:75], a[252:255], v[20:23], v[72:75]
    v_mfma_f32_16x16x32_bf16 v[76:79], a[252:255], v[48:51], v[76:79]
    v_mfma_f32_16x16x32_bf16 v[72:75], a[252:255], v[24:27], v[72:75]
    v_mfma_f32_16x16x32_bf16 v[76:79], a[252:255], v[52:55], v[76:79]
    s_waitcnt lgkmcnt(12)
    v_mfma_f32_16x16x32_bf16 v[72:75], a[252:255], v[28:31], v[72:75]
    v_mfma_f32_16x16x32_bf16 v[76:79], a[252:255], v[56:59], v[76:79]
    s_waitcnt lgkmcnt(8)
    v_mfma_f32_16x16x32_bf16 v[72:75], a[252:255], v[32:35], v[72:75]
    v_mfma_f32_16x16x32_bf16 v[76:79], a[252:255], v[60:63], v[76:79]
    s_waitcnt lgkmcnt(4)
    v_mfma_f32_16x16x32_bf16 v[72:75], a[252:255], v[36:39], v[72:75]
    v_mfma_f32_16x16x32_bf16 v[76:79], a[252:255], v[64:67], v[76:79]
    s_waitcnt lgkmcnt(0)
    v_mfma_f32_16x16x32_bf16 v[72:75], a[252:255], v[40:43], v[72:75]
    v_mfma_f32_16x16x32_bf16 v[76:79], a[252:255], v[68:71], v[76:79]
    s_lshl_b32 s62, s26, 2
    s_add_u32 s62, s62, 155648
    v_lshl_add_u32 v7, v2, 4, s62
    s_nop 3
    ds_write_b32 v7, v72
    ds_write_b32 v7, v76 offset:512
    s_lshl_b32 s68, s27, 7
    s_add_u32 s68, s68, 8192
    s_lshl_b32 s64, s44, 7
    v_lshrrev_b32 v222, 3, v0
    v_mul_u32_u24 v222, 3584, v222
    v_bfe_u32 v223, v0, 4, 1
    v_lshlrev_b32 v223, 2, v223
    v_xor_b32 v223, v223, v0
    v_and_b32 v223, 7, v223
    v_lshl_add_u32 v222, v223, 4, v222
    s_mul_i32 s62, s26, 401408
    s_add_u32 s62, s62, s64
    v_add_u32 v222, s62, v222
    v_add_u32 v223, 27648, v222
    s_mul_i32 s64, s54, 28672
    s_add_u32 s64, s64, 8388608
    s_lshl_b32 s65, s54, 12
    s_add_u32 s65, s65, 1572864
    v_mul_u32_u24 v11, 1792, v1
    v_lshl_add_u32 v11, v2, 3, v11
    v_add_u32 v12, 57344, v4
    v_add_u32 v13, 57344, v5
    ds_read_b64_tr_b16 v[128:129], v12 offset:0
    ds_read_b64_tr_b16 v[130:131], v12 offset:512
    ds_read_b64_tr_b16 v[132:133], v13 offset:0
    ds_read_b64_tr_b16 v[134:135], v13 offset:512
    ds_read_b64_tr_b16 v[136:137], v12 offset:2048
    ds_read_b64_tr_b16 v[138:139], v12 offset:2560
    ds_read_b64_tr_b16 v[140:141], v13 offset:2048
    ds_read_b64_tr_b16 v[142:143], v13 offset:2560
    ds_read_b64_tr_b16 v[144:145], v12 offset:4096
    ds_read_b64_tr_b16 v[146:147], v12 offset:4608
    ds_read_b64_tr_b16 v[148:149], v13 offset:4096
    ds_read_b64_tr_b16 v[150:151], v13 offset:4608
    s_waitcnt lgkmcnt(12)
    s_add_u32 s67, s77, 8192
    v_mov_b32 v8, s46
    v_mov_b32 v9, s47
    s_cmp_eq_u32 s26, 0
    s_waitcnt vmcnt(0)
    s_barrier
    s_cbranch_scc0 L_pub_20
    s_mov_b64 exec, 1
    s_cmp_eq_u32 s48, 1
    s_cbranch_scc1 L_plain_21
    buffer_store_dwordx2 v[8:9], v0, s[28:31], s67 offen sc1
    s_branch L_join_22
L_plain_21:
    buffer_store_dwordx2 v[8:9], v0, s[28:31], s67 offen
L_join_22:
    s_mov_b64 exec, -1
L_pub_20:
    s_cmp_eq_u32 s26, 0
    s_cbranch_scc0 L_pollskip_23
    v_lshlrev_b32 v7, 3, v0
    s_mov_b64 exec, 0x3fff
    s_mov_b32 s72, 0
L_poll_24:
    buffer_load_dwordx2 v[8:9], v7, s[28:31], s68 offen sc1
    s_add_u32 s72, s72, 1
    s_waitcnt vmcnt(0)
    v_cmp_ne_u64 vcc, s[46:47], v[8:9]
    s_cbranch_vccz L_poll_24_d
    s_cmp_lt_u32 s72, 100000
    s_branch L_pg7
    .p2align 12
L_stub7:
    s_setpc_b64 s[70:71]
L_pg7:
    s_cbranch_scc1 L_poll_24
L_poll_24_d:
    s_mov_b64 exec, -1
L_pollskip_23:
    s_barrier
    buffer_load_dwordx4 v[16:19], v3, s[28:31], s64 offen offset:0 sc1
    buffer_load_dwordx4 v[20:23], v3, s[28:31], s64 offen offset:1024 sc1
    buffer_load_dwordx4 v[24:27], v3, s[28:31], s64 offen offset:2048 sc1
    buffer_load_dwordx4 v[28:31], v3, s[28:31], s64 offen offset:3072 sc1
    s_add_u32 s64, s64, 4096
    buffer_load_dwordx4 v[32:35], v3, s[28:31], s64 offen offset:0 sc1
    buffer_load_dwordx4 v[36:39], v3, s[28:31], s64 offen offset:1024 sc1
    buffer_load_dwordx4 v[40:43], v3, s[28:31], s64 offen offset:2048 sc1
    buffer_load_dwordx4 v[44:47], v3, s[28:31], s64 offen offset:3072 sc1
    s_add_u32 s64, s64, 4096
    buffer_load_dwordx4 v[48:51], v3, s[28:31], s64 offen offset:0 sc1
    buffer_load_dwordx4 v[52:55], v3, s[28:31], s64 offen offset:1024 sc1
    buffer_load_dwordx4 v[56:59], v3, s[28:31], s64 offen offset:2048 sc1
    v_lshlrev_b32 v7, 4, v2
    v_add_u32 v7, 155648, v7
    ds_read_b128 v[224:227], v7 offset:0
    ds_read_b128 v[228:231], v7 offset:512
    s_waitcnt lgkmcnt(0)
    v_add_f32 v224, v224, v225
    v_add_f32 v226, v226, v227
    v_add_f32 v224, v224, v226
    v_cvt_pk_bf16_f32 v232, v224, v224
    v_and_b32 v233, 0xffff0000, v232
    v_sub_f32 v233, v224, v233
    v_cvt_pk_bf16_f32 v233, v233, 0
    v_mov_b32 v234, 0
    v_mov_b32 v235, 0
    v_add_f32 v228, v228, v229
    v_add_f32 v230, v230, v231
    v_add_f32 v228, v228, v230
    v_cvt_pk_bf16_f32 v236, v228, v228
    v_and_b32 v237, 0xffff0000, v236
    v_sub_f32 v237, v228, v237
    v_cvt_pk_bf16_f32 v237, v237, 0
    v_mov_b32 v238, 0
    v_mov_b32 v239, 0
    s_waitcnt vmcnt(10)
    v_mfma_f32_32x32x16_bf16 v[160:175], v[128:131], v[16:19], 0
    ds_read_b64_tr_b16 v[152:153], v12 offset:6144
    ds_read_b64_tr_b16 v[154:155], v12 offset:6656
    ds_read_b64_tr_b16 v[156:157], v13 offset:6144
    ds_read_b64_tr_b16 v[158:159], v13 offset:6656
    v_mfma_f32_32x32x16_bf16 v[176:191], v[132:135], v[16:19], 0
    buffer_load_dwordx4 v[60:63], v3, s[28:31], s64 offen offset:3072 sc1
    s_add_u32 s64, s64, 4096
    buffer_load_dwordx4 v[64:67], v3, s[28:31], s64 offen offset:0 sc1
    s_waitcnt vmcnt(11)
    v_mfma_f32_32x32x16_bf16 v[160:175], v[136:139], v[20:23], v[160:175]
    ds_read_b64_tr_b16 v[128:129], v12 offset:8192
    ds_read_b64_tr_b16 v[130:131], v12 offset:8704
    ds_read_b64_tr_b16 v[132:133], v13 offset:8192
    ds_read_b64_tr_b16 v[134:135], v13 offset:8704
    v_mfma_f32_32x32x16_bf16 v[176:191], v[140:143], v[20:23], v[176:191]
    buffer_load_dwordx4 v[68:71], v3, s[28:31], s64 offen offset:1024 sc1
    buffer_load_dwordx4 v[72:75], v3, s[28:31], s64 offen offset:2048 sc1
    s_waitcnt vmcnt(12)
    v_mfma_f32_32x32x16_bf16 v[160:175], v[144:147], v[24:27], v[160:175]
    ds_read_b64_tr_b16 v[136:137], v12 offset:10240
    ds_read_b64_tr_b16 v[138:139], v12 offset:10752
    ds_read_b64_tr_b16 v[140:141], v13 offset:10240
    ds_read_b64_tr_b16 v[142:143], v13 offset:10752
    v_mfma_f32_32x32x16_bf16 v[176:191], v[148:151], v[24:27], v[176:191]
    buffer_load_dwordx4 v[76:79], v3, s[28:31], s64 offen offset:3072 sc1
    buffer_load_dwordx2 v[192:193], v11, s[28:31], s65 offen offset:0 sc1
    s_waitcnt vmcnt(13)
    s_waitcnt lgkmcnt(8)
    v_mfma_f32_32x32x16_bf16 v[160:175], v[152:155], v[28:31], v[160:175]
    ds_read_b64_tr_b16 v[144:145], v12 offset:12288
    ds_read_b64_tr_b16 v[146:147], v12 offset:12800
    ds_read_b64_tr_b16 v[148:149], v13 offset:12288
    ds_read_b64_tr_b16 v[150:151], v13 offset:12800
    v_mfma_f32_32x32x16_bf16 v[176:191], v[156:159], v[28:31], v[176:191]
    buffer_load_dwordx2 v[194:195], v11, s[28:31], s65 offen offset:256 sc1
    buffer_load_dwordx2 v[196:197], v11, s[28:31], s65 offen offset:512 sc1
    s_waitcnt vmcnt(14)
    s_waitcnt lgkmcnt(8)
    v_mfma_f32_32x32x16_bf16 v[160:175], v[128:131], v[32:35], v[160:175]
    ds_read_b64_tr_b16 v[152:153], v12 offset:14336
    ds_read_b64_tr_b16 v[154:155], v12 offset:14848
    ds_read_b64_tr_b16 v[156:157], v13 offset:14336
    ds_read_b64_tr_b16 v[158:159], v13 offset:14848
    v_mfma_f32_32x32x16_bf16 v[176:191], v[132:135], v[32:35], v[176:191]
    buffer_load_dwordx2 v[198:199], v11, s[28:31], s65 offen offset:768 sc1
    s_waitcnt vmcnt(14)
    s_waitcnt lgkmcnt(8)
    v_mfma_f32_32x32x16_bf16 v[160:175], v[136:139], v[36:39], v[160:175]
    ds_read_b64_tr_b16 v[128:129], v12 offset:16384
    ds_read_b64_tr_b16 v[130:131], v12 offset:16896
    ds_read_b64_tr_b16 v[132:133], v13 offset:16384
    ds_read_b64_tr_b16 v[134:135], v13 offset:16896
    v_mfma_f32_32x32x16_bf16 v[176:191], v[140:143], v[36:39], v[176:191]
    buffer_load_dwordx2 v[200:201], v11, s[28:31], s65 offen offset:1024 sc1
    s_waitcnt vmcnt(14)
    s_waitcnt lgkmcnt(8)
    v_mfma_f32_32x32x16_bf16 v[160:175], v[144:147], v[40:43], v[160:175]
    ds_read_b64_tr_b16 v[136:137], v12 offset:18432
    ds_read_b64_tr_b16 v[138:139], v12 offset:18944
    ds_read_b64_tr_b16 v[140:141], v13 offset:18432
    ds_read_b64_tr_b16 v[142:143], v13 offset:18944
    v_mfma_f32_32x32x16_bf16 v[176:191], v[148:151], v[40:43], v[176:191]
    buffer_load_dwordx2 v[202:203], v11, s[28:31], s65 offen offset:1280 sc1
    s_waitcnt vmcnt(14)
    s_waitcnt lgkmcnt(8)
    v_mfma_f32_32x32x16_bf16 v[160:175], v[152:155], v[44:47], v[160:175]
    ds_read_b64_tr_b16 v[144:145], v12 offset:20480
    ds_read_b64_tr_b16 v[146:147], v12 offset:20992
    ds_read_b64_tr_b16 v[148:149], v13 offset:20480
    ds_read_b64_tr_b16 v[150:151], v13 offset:20992
    v_mfma_f32_32x32x16_bf16 v[176:191], v[156:159], v[44:47], v[176:191]
    buffer_load_dwordx2 v[204:205], v11, s[28:31], s65 offen offset:1536 sc1
    s_waitcnt vmcnt(14)
    s_waitcnt lgkmcnt(8)
    v_mfma_f32_32x32x16_bf16 v[160:175], v[128:131], v[48:51], v[160:175]
    ds_read_b64_tr_b16 v[152:153], v12 offset:22528
    ds_read_b64_tr_b16 v[154:155], v12 offset:23040
    ds_read_b64_tr_b16 v[156:157], v13 offset:22528
    ds_read_b64_tr_b16 v[158:159], v13 offset:23040
    v_mfma_f32_32x32x16_bf16 v[176:191], v[132:135], v[48:51], v[176:191]
    s_add_u32 s64, s64, 4096
    buffer_load_dwordx4 v[80:83], v3, s[28:31], s64 offen offset:0 sc1
    s_waitcnt vmcnt(14)
    s_waitcnt lgkmcnt(8)
    v_mfma_f32_32x32x16_bf16 v[160:175], v[136:139], v[52:55], v[160:175]
    ds_read_b64_tr_b16 v[128:129], v12 offset:24576
    ds_read_b64_tr_b16 v[130:131], v12 offset:25088
    ds_read_b64_tr_b16 v[132:133], v13 offset:24576
    ds_read_b64_tr_b16 v[134:135], v13 offset:25088
    v_mfma_f32_32x32x16_bf16 v[176:191], v[140:143], v[52:55], v[176:191]
    buffer_load_dwordx4 v[84:87], v3, s[28:31], s64 offen offset:1024 sc1
    s_waitcnt vmcnt(14)
    s_waitcnt lgkmcnt(8)
    v_mfma_f32_32x32x16_bf16 v[160:175], v[144:147], v[56:59], v[160:175]
    ds_read_b64_tr_b16 v[136:137], v12 offset:26624
    ds_read_b64_tr_b16 v[138:139], v12 offset:27136
    ds_read_b64_tr_b16 v[140:141], v13 offset:26624
    ds_read_b64_tr_b16 v[142:143], v13 offset:27136
    v_mfma_f32_32x32x16_bf16 v[176:191], v[148:151], v[56:59], v[176:191]
    buffer_load_dwordx4 v[88:91], v3, s[28:31], s64 offen offset:2048 sc1
    s_waitcnt vmcnt(14)
    s_waitcnt lgkmcnt(8)
    v_mfma_f32_32x32x16_bf16 v[160:175], v[152:155], v[60:63], v[160:175]
    ds_read_b64_tr_b16 v[144:145], v12 offset:28672
    ds_read_b64_tr_b16 v[146:147], v12 offset:29184
    ds_read_b64_tr_b16 v[148:149], v13 offset:28672
    ds_read_b64_tr_b16 v[150:151], v13 offset:29184
    v_mfma_f32_32x32x16_bf16 v[176:191], v[156:159], v[60:63], v[176:191]
    buffer_load_dwordx4 v[92:95], v3, s[28:31], s64 offen offset:3072 sc1
    s_waitcnt vmcnt(14)
    s_waitcnt lgkmcnt(8)
    v_mfma_f32_32x32x16_bf16 v[160:175], v[128:131], v[64:67], v[160:175]
    ds_read_b64_tr_b16 v[152:153], v12 offset:30720
    ds_read_b64_tr_b16 v[154:155], v12 offset:31232
    ds_read_b64_tr_b16 v[156:157], v13 offset:30720
    ds_read_b64_tr_b16 v[158:159], v13 offset:31232
    v_mfma_f32_32x32x16_bf16 v[176:191], v[132:135], v[64:67], v[176:191]
    s_add_u32 s64, s64, 4096
    buffer_load_dwordx4 v[96:99], v3, s[28:31], s64 offen offset:0 sc1
    s_waitcnt vmcnt(14)
    s_waitcnt lgkmcnt(8)
    v_mfma_f32_32x32x16_bf16 v[160:175], v[136:139], v[68:71], v[160:175]
    ds_read_b64_tr_b16 v[128:129], v12 offset:32768
    ds_read_b64_tr_b16 v[130:131], v12 offset:33280
    ds_read_b64_tr_b16 v[132:133], v13 offset:32768
    ds_read_b64_tr_b16 v[134:135], v13 offset:33280
    v_mfma_f32_32x32x16_bf16 v[176:191], v[140:143], v[68:71], v[176:191]
    buffer_load_dwordx4 v[100:103], v3, s[28:31], s64 offen offset:1024 sc1
    s_waitcnt vmcnt(14)
    s_waitcnt lgkmcnt(8)
    v_mfma_f32_32x32x16_bf16 v[160:175], v[144:147], v[72:75], v[160:175]
    ds_read_b64_tr_b16 v[136:137], v12 offset:34816
    ds_read_b64_tr_b16 v[138:139], v12 offset:35328
    ds_read_b64_tr_b16 v[140:141], v13 offset:34816
    ds_read_b64_tr_b16 v[142:143], v13 offset:35328
    v_mfma_f32_32x32x16_bf16 v[176:191], v[148:151], v[72:75], v[176:191]
    buffer_load_dwordx4 v[104:107], v3, s[28:31], s64 offen offset:2048 sc1
    s_waitcnt vmcnt(14)
    s_waitcnt lgkmcnt(8)
    v_mfma_f32_32x32x16_bf16 v[160:175], v[152:155], v[76:79], v[160:175]
    ds_read_b64_tr_b16 v[144:145], v12 offset:36864
    ds_read_b64_tr_b16 v[146:147], v12 offset:37376
    ds_read_b64_tr_b16 v[148:149], v13 offset:36864
    ds_read_b64_tr_b16 v[150:151], v13 offset:37376
    v_mfma_f32_32x32x16_bf16 v[176:191], v[156:159], v[76:79], v[176:191]
    buffer_load_dwordx4 v[108:111], v3, s[28:31], s64 offen offset:3072 sc1
    s_waitcnt vmcnt(7)
    s_waitcnt lgkmcnt(8)
    v_mfma_f32_32x32x16_bf16 v[160:175], v[128:131], v[80:83], v[160:175]
    ds_read_b64_tr_b16 v[152:153], v12 offset:38912
    ds_read_b64_tr_b16 v[154:155], v12 offset:39424
    ds_read_b64_tr_b16 v[156:157], v13 offset:38912
    ds_read_b64_tr_b16 v[158:159], v13 offset:39424
    v_mfma_f32_32x32x16_bf16 v[176:191], v[132:135], v[80:83], v[176:191]
    s_add_u32 s64, s64, 4096
    buffer_load_dwordx4 v[112:115], v3, s[28:31], s64 offen offset:0 sc1
    s_waitcnt vmcnt(7)
    s_waitcnt lgkmcnt(8)
    v_mfma_f32_32x32x16_bf16 v[160:175], v[136:139], v[84:87], v[160:175]
    ds_read_b64_tr_b16 v[128:129], v12 offset:40960
    ds_read_b64_tr_b16 v[130:131], v12 offset:41472
    ds_read_b64_tr_b16 v[132:133], v13 offset:40960
    ds_read_b64_tr_b16 v[134:135], v13 offset:41472
    v_mfma_f32_32x32x16_bf16 v[176:191], v[140:143], v[84:87], v[176:191]
    buffer_load_dwordx4 v[116:119], v3, s[28:31], s64 offen offset:1024 sc1
    s_waitcnt vmcnt(7)
    s_waitcnt lgkmcnt(8)
    v_mfma_f32_32x32x16_bf16 v[160:175], v[144:147], v[88:91], v[160:175]
    ds_read_b64_tr_b16 v[136:137], v12 offset:43008
    ds_read_b64_tr_b16 v[138:139], v12 offset:43520
    ds_read_b64_tr_b16 v[140:141], v13 offset:43008
    ds_read_b64_tr_b16 v[142:143], v13 offset:43520
    v_mfma_f32_32x32x16_bf16 v[176:191], v[148:151], v[88:91], v[176:191]
    buffer_load_dwordx4 v[120:123], v3, s[28:31], s64 offen offset:2048 sc1
    s_waitcnt vmcnt(7)
    s_waitcnt lgkmcnt(8)
    v_mfma_f32_32x32x16_bf16 v[160:175], v[152:155], v[92:95], v[160:175]
    ds_read_b64_tr_b16 v[144:145], v12 offset:45056
    ds_read_b64_tr_b16 v[146:147], v12 offset:45568
    ds_read_b64_tr_b16 v[148:149], v13 offset:45056
    ds_read_b64_tr_b16 v[150:151], v13 offset:45568
    v_mfma_f32_32x32x16_bf16 v[176:191], v[156:159], v[92:95], v[176:191]
    buffer_load_dwordx4 v[124:127], v3, s[28:31], s64 offen offset:3072 sc1
    s_waitcnt vmcnt(7)
    s_waitcnt lgkmcnt(8)
    v_mfma_f32_32x32x16_bf16 v[160:175], v[128:131], v[96:99], v[160:175]
    ds_read_b64_tr_b16 v[152:153], v12 offset:47104
    ds_read_b64_tr_b16 v[154:155], v12 offset:47616
    ds_read_b64_tr_b16 v[156:157], v13 offset:47104
    ds_read_b64_tr_b16 v[158:159], v13 offset:47616
    v_mfma_f32_32x32x16_bf16 v[176:191], v[132:135], v[96:99], v[176:191]
    v_add_f32 v192, v192, v194
    v_add_f32 v193, v193, v195
    v_add_f32 v192, v192, v196
    s_waitcnt vmcnt(6)
    s_waitcnt lgkmcnt(8)
    v_mfma_f32_32x32x16_bf16 v[160:175], v[136:139], v[100:103], v[160:175]
    ds_read_b64_tr_b16 v[128:129], v12 offset:49152
    ds_read_b64_tr_b16 v[130:131], v12 offset:49664
    ds_read_b64_tr_b16 v[132:133], v13 offset:49152
    ds_read_b64_tr_b16 v[134:135], v13 offset:49664
    v_mfma_f32_32x32x16_bf16 v[176:191], v[140:143], v[100:103], v[176:191]
    v_add_f32 v193, v193, v197
    v_add_f32 v192, v192, v198
    v_add_f32 v193, v193, v199
    s_waitcnt vmcnt(5)
    s_waitcnt lgkmcnt(8)
    v_mfma_f32_32x32x16_bf16 v[160:175], v[144:147], v[104:107], v[160:175]
    ds_read_b64_tr_b16 v[136:137], v12 offset:51200
    ds_read_b64_tr_b16 v[138:139], v12 offset:51712
    ds_read_b64_tr_b16 v[140:141], v13 offset:51200
    ds_read_b64_tr_b16 v[142:143], v13 offset:51712
    v_mfma_f32_32x32x16_bf16 v[176:191], v[148:151], v[104:107], v[176:191]
    v_add_f32 v192, v192, v200
    v_add_f32 v193, v193, v201
    v_add_f32 v192, v192, v202
    s_waitcnt vmcnt(4)
    s_waitcnt lgkmcnt(8)
    v_mfma_f32_32x32x16_bf16 v[160:175], v[152:155], v[108:111], v[160:175]
    ds_read_b64_tr_b16 v[144:145], v12 offset:53248
    ds_read_b64_tr_b16 v[146:147], v12 offset:53760
    ds_read_b64_tr_b16 v[148:149], v13 offset:53248
    ds_read_b64_tr_b16 v[150:151], v13 offset:53760
    v_mfma_f32_32x32x16_bf16 v[176:191], v[156:159], v[108:111], v[176:191]
    v_add_f32 v193, v193, v203
    v_add_f32 v192, v192, v204
    v_add_f32 v193, v193, v205
    s_waitcnt vmcnt(3)
    s_waitcnt lgkmcnt(8)
    v_mfma_f32_32x32x16_bf16 v[160:175], v[128:131], v[112:115], v[160:175]
    ds_read_b64_tr_b16 v[152:153], v12 offset:55296
    ds_read_b64_tr_b16 v[154:155], v12 offset:55808
    ds_read_b64_tr_b16 v[156:157], v13 offset:55296
    ds_read_b64_tr_b16 v[158:159], v13 offset:55808
    v_mfma_f32_32x32x16_bf16 v[176:191], v[132:135], v[112:115], v[176:191]
    v_mov_b32 v194, v192
    v_mov_b32 v195, v193
    s_nop 0
    s_waitcnt vmcnt(2)
    s_waitcnt lgkmcnt(8)
    v_mfma_f32_32x32x16_bf16 v[160:175], v[136:139], v[116:119], v[160:175]
    v_permlane32_swap_b32 v194, v192
    v_permlane32_swap_b32 v195, v193
    v_add_f32 v192, v192, v194
    v_add_f32 v193, v193, v195
    v_mul_f32 v194, 0x3b124925, v192
    v_mul_f32 v253, 0x3b124925, v193
    v_mfma_f32_32x32x16_bf16 v[176:191], v[140:143], v[116:119], v[176:191]
    v_fma_f32 v253, -v194, v194, v253
    v_max_f32 v253, 0, v253
    v_add_f32 v253, 0x3727c5ac, v253
    s_waitcnt vmcnt(1)
    s_waitcnt lgkmcnt(4)
    v_mfma_f32_32x32x16_bf16 v[160:175], v[144:147], v[120:123], v[160:175]
    v_rsq_f32 v253, v253
    v_sub_f32 v195, 0, v194
    v_cndmask_b32 v195, v195, 0, s[50:51]
    v_cvt_pk_bf16_f32 v241, v195, 0
    v_lshlrev_b32 v240, 16, v241
    v_sub_f32 v240, v195, v240
    v_mfma_f32_32x32x16_bf16 v[176:191], v[148:151], v[120:123], v[176:191]
    v_cvt_pk_bf16_f32 v240, v195, v240
    v_mov_b32 v242, 0
    v_mov_b32 v243, 0
    s_waitcnt vmcnt(0)
    s_waitcnt lgkmcnt(0)
    v_mfma_f32_32x32x16_bf16 v[160:175], v[152:155], v[124:127], v[160:175]
    v_mul_f32 v14, s58, v253
    v_mul_f32 v15, v253, v253
    v_rcp_f32 v6, v253
    v_mul_f32 v15, v15, v253
    v_mul_f32 v15, s60, v15
    s_lshl_b32 s65, s54, 13
    v_mfma_f32_32x32x16_bf16 v[176:191], v[156:159], v[124:127], v[176:191]
    s_add_u32 s65, s65, 1048576
    s_lshl_b32 s63, s44, 9
    s_add_u32 s66, s65, s63
    v_lshlrev_b32 v10, 4, v2
    v_mov_b32 v198, s46
    v_mov_b32 v199, s47
    v_mfma_f32_32x32x16_bf16 v[160:175], v[232:235], v[240:243], v[160:175]
    v_mfma_f32_32x32x16_bf16 v[176:191], v[236:239], v[240:243], v[176:191]
    v_mov_b32 v12, v4
    v_mov_b32 v13, v5
    s_mul_i32 s80, s26, 14336
    s_add_u32 m0, s80, 0
    s_mov_b32 s81, 0
    buffer_load_dwordx4 v222, s[36:39], s81 offen offset:0 lds
    buffer_load_dwordx4 v223, s[36:39], s81 offen offset:1024 lds
    s_add_u32 m0, s80, 2048
    s_mov_b32 s81, 57344
    buffer_load_dwordx4 v222, s[36:39], s81 offen offset:0 lds
    buffer_load_dwordx4 v223, s[36:39], s81 offen offset:1024 lds
    s_add_u32 m0, s80, 4096
    s_mov_b32 s81, 114688
    buffer_load_dwordx4 v222, s[36:39], s81 offen offset:0 lds
    v_pk_mul_f32 v[200:201], v[160:161], v[160:161]
    v_pk_mul_f32 v[202:203], v[162:163], v[162:163]
    v_pk_mul_f32 v[204:205], v[164:165], v[164:165]
    v_pk_mul_f32 v[206:207], v[166:167], v[166:167]
    v_pk_fma_f32 v[200:201], v[200:201], v[14:15], v[14:15] op_sel:[0,1,0] op_sel_hi:[1,1,0]
    v_pk_fma_f32 v[202:203], v[202:203], v[14:15], v[14:15] op_sel:[0,1,0] op_sel_hi:[1,1,0]
    v_pk_fma_f32 v[204:205], v[204:205], v[14:15], v[14:15] op_sel:[0,1,0] op_sel_hi:[1,1,0]
    v_pk_fma_f32 v[206:207], v[206:207], v[14:15], v[14:15] op_sel:[0,1,0] op_sel_hi:[1,1,0]
    v_pk_mul_f32 v[200:201], v[200:201], v[160:161]
    v_pk_mul_f32 v[202:203], v[202:203], v[162:163]
    v_pk_mul_f32 v[204:205], v[204:205], v[164:165]
    v_pk_mul_f32 v[206:207], v[206:207], v[166:167]
    v_exp_f32 v200, v200
    v_exp_f32 v201, v201
    v_exp_f32 v202, v202
    v_exp_f32 v203, v203
    v_exp_f32 v204, v204
    v_exp_f32 v205, v205
    v_exp_f32 v206, v206
    v_exp_f32 v207, v207
    v_pk_fma_f32 v[200:201], v[200:201], v[6:7], v[6:7] op_sel_hi:[1,0,0]
    v_pk_fma_f32 v[202:203], v[202:203], v[6:7], v[6:7] op_sel_hi:[1,0,0]
    v_pk_fma_f32 v[204:205], v[204:205], v[6:7], v[6:7] op_sel_hi:[1,0,0]
    v_pk_fma_f32 v[206:207], v[206:207], v[6:7], v[6:7] op_sel_hi:[1,0,0]
    v_rcp_f32 v200, v200
    v_rcp_f32 v201, v201
    v_rcp_f32 v202, v202
    v_rcp_f32 v203, v203
    v_rcp_f32 v204, v204
    v_rcp_f32 v205, v205
    v_rcp_f32 v206, v206
    v_rcp_f32 v207, v207
    buffer_load_dwordx4 v223, s[36:39], s81 offen offset:1024 lds
    s_add_u32 m0, s80, 6144
    s_mov_b32 s81, 172032
    buffer_load_dwordx4 v222, s[36:39], s81 offen offset:0 lds
    buffer_load_dwordx4 v223, s[36:39], s81 offen offset:1024 lds
    v_pk_mul_f32 v[160:161], v[160:161], v[200:201]
    v_pk_mul_f32 v[162:163], v[162:163], v[202:203]
    v_pk_mul_f32 v[164:165], v[164:165], v[204:205]
    v_pk_mul_f32 v[166:167], v[166:167], v[206:207]
    v_pk_mul_f32 v[200:201], v[168:169], v[168:169]
    v_pk_mul_f32 v[202:203], v[170:171], v[170:171]
    v_pk_mul_f32 v[204:205], v[172:173], v[172:173]
    v_pk_mul_f32 v[206:207], v[174:175], v[174:175]
    v_pk_fma_f32 v[200:201], v[200:201], v[14:15], v[14:15] op_sel:[0,1,0] op_sel_hi:[1,1,0]
    v_pk_fma_f32 v[202:203], v[202:203], v[14:15], v[14:15] op_sel:[0,1,0] op_sel_hi:[1,1,0]
    v_pk_fma_f32 v[204:205], v[204:205], v[14:15], v[14:15] op_sel:[0,1,0] op_sel_hi:[1,1,0]
    v_pk_fma_f32 v[206:207], v[206:207], v[14:15], v[14:15] op_sel:[0,1,0] op_sel_hi:[1,1,0]
    v_pk_mul_f32 v[200:201], v[200:201], v[168:169]
    v_pk_mul_f32 v[202:203], v[202:203], v[170:171]
    v_pk_mul_f32 v[204:205], v[204:205], v[172:173]
    v_pk_mul_f32 v[206:207], v[206:207], v[174:175]
    v_exp_f32 v200, v200
    v_exp_f32 v201, v201
    v_exp_f32 v202, v202
    v_exp_f32 v203, v203
    v_exp_f32 v204, v204
    v_exp_f32 v205, v205
    v_exp_f32 v206, v206
    v_exp_f32 v207, v207
    v_pk_fma_f32 v[200:201], v[200:201], v[6:7], v[6:7] op_sel_hi:[1,0,0]
    v_pk_fma_f32 v[202:203], v[202:203], v[6:7], v[6:7] op_sel_hi:[1,0,0]
    v_pk_fma_f32 v[204:205], v[204:205], v[6:7], v[6:7] op_sel_hi:[1,0,0]
    v_pk_fma_f32 v[206:207], v[206:207], v[6:7], v[6:7] op_sel_hi:[1,0,0]
    v_rcp_f32 v200, v200
    v_rcp_f32 v201, v201
    v_rcp_f32 v202, v202
    v_rcp_f32 v203, v203
    v_rcp_f32 v204, v204
    v_rcp_f32 v205, v205
    v_rcp_f32 v206, v206
    v_rcp_f32 v207, v207
    s_add_u32 m0, s80, 8192
    s_mov_b32 s81, 229376
    buffer_load_dwordx4 v222, s[36:39], s81 offen offset:0 lds
    buffer_load_dwordx4 v223, s[36:39], s81 offen offset:1024 lds
    s_add_u32 m0, s80, 10240
    s_mov_b32 s81, 286720
    buffer_load_dwordx4 v222, s[36:39], s81 offen offset:0 lds
    v_pk_mul_f32 v[168:169], v[168:169], v[200:201]
    v_pk_mul_f32 v[170:171], v[170:171], v[202:203]
    v_pk_mul_f32 v[172:173], v[172:173], v[204:205]
    v_pk_mul_f32 v[174:175], v[174:175], v[206:207]
    v_pk_mul_f32 v[200:201], v[176:177], v[176:177]
    v_pk_mul_f32 v[202:203], v[178:179], v[178:179]
    v_pk_mul_f32 v[204:205], v[180:181], v[180:181]
    v_pk_mul_f32 v[206:207], v[182:183], v[182:183]
    v_pk_fma_f32 v[200:201], v[200:201], v[14:15], v[14:15] op_sel:[0,1,0] op_sel_hi:[1,1,0]
    v_pk_fma_f32 v[202:203], v[202:203], v[14:15], v[14:15] op_sel:[0,1,0] op_sel_hi:[1,1,0]
    v_pk_fma_f32 v[204:205], v[204:205], v[14:15], v[14:15] op_sel:[0,1,0] op_sel_hi:[1,1,0]
    v_pk_fma_f32 v[206:207], v[206:207], v[14:15], v[14:15] op_sel:[0,1,0] op_sel_hi:[1,1,0]
    v_pk_mul_f32 v[200:201], v[200:201], v[176:177]
    v_pk_mul_f32 v[202:203], v[202:203], v[178:179]
    v_pk_mul_f32 v[204:205], v[204:205], v[180:181]
    v_pk_mul_f32 v[206:207], v[206:207], v[182:183]
    v_exp_f32 v200, v200
    v_exp_f32 v201, v201
    v_exp_f32 v202, v202
    v_exp_f32 v203, v203
    v_exp_f32 v204, v204
    v_exp_f32 v205, v205
    v_exp_f32 v206, v206
    v_exp_f32 v207, v207
    v_pk_fma_f32 v[200:201], v[200:201], v[6:7], v[6:7] op_sel_hi:[1,0,0]
    v_pk_fma_f32 v[202:203], v[202:203], v[6:7], v[6:7] op_sel_hi:[1,0,0]
    v_pk_fma_f32 v[204:205], v[204:205], v[6:7], v[6:7] op_sel_hi:[1,0,0]
    v_pk_fma_f32 v[206:207], v[206:207], v[6:7], v[6:7] op_sel_hi:[1,0,0]
    v_rcp_f32 v200, v200
    v_rcp_f32 v201, v201
    v_rcp_f32 v202, v202
    v_rcp_f32 v203, v203
    v_rcp_f32 v204, v204
    v_rcp_f32 v205, v205
    v_rcp_f32 v206, v206
    v_rcp_f32 v207, v207
    buffer_load_dwordx4 v223, s[36:39], s81 offen offset:1024 lds
    s_add_u32 m0, s80, 12288
    s_mov_b32 s81, 344064
    buffer_load_dwordx4 v222, s[36:39], s81 offen offset:0 lds
    buffer_load_dwordx4 v223, s[36:39], s81 offen offset:1024 lds
    v_pk_mul_f32 v[176:177], v[176:177], v[200:201]
    v_pk_mul_f32 v[178:179], v[178:179], v[202:203]
    v_pk_mul_f32 v[180:181], v[180:181], v[204:205]
    v_pk_mul_f32 v[182:183], v[182:183], v[206:207]
    v_pk_mul_f32 v[200:201], v[184:185], v[184:185]
    v_pk_mul_f32 v[202:203], v[186:187], v[186:187]
    v_pk_mul_f32 v[204:205], v[188:189], v[188:189]
    v_pk_mul_f32 v[206:207], v[190:191], v[190:191]
    v_pk_fma_f32 v[200:201], v[200:201], v[14:15], v[14:15] op_sel:[0,1,0] op_sel_hi:[1,1,0]
    v_pk_fma_f32 v[202:203], v[202:203], v[14:15], v[14:15] op_sel:[0,1,0] op_sel_hi:[1,1,0]
    v_pk_fma_f32 v[204:205], v[204:205], v[14:15], v[14:15] op_sel:[0,1,0] op_sel_hi:[1,1,0]
    v_pk_fma_f32 v[206:207], v[206:207], v[14:15], v[14:15] op_sel:[0,1,0] op_sel_hi:[1,1,0]
    v_pk_mul_f32 v[200:201], v[200:201], v[184:185]
    v_pk_mul_f32 v[202:203], v[202:203], v[186:187]
    v_pk_mul_f32 v[204:205], v[204:205], v[188:189]
    v_pk_mul_f32 v[206:207], v[206:207], v[190:191]
    v_exp_f32 v200, v200
    v_exp_f32 v201, v201
    v_exp_f32 v202, v202
    v_exp_f32 v203, v203
    v_exp_f32 v204, v204
    v_exp_f32 v205, v205
    v_exp_f32 v206, v206
    v_exp_f32 v207, v207
    v_pk_fma_f32 v[200:201], v[200:201], v[6:7], v[6:7] op_sel_hi:[1,0,0]
    v_pk_fma_f32 v[202:203], v[202:203], v[6:7], v[6:7] op_sel_hi:[1,0,0]
    v_pk_fma_f32 v[204:205], v[204:205], v[6:7], v[6:7] op_sel_hi:[1,0,0]
    v_pk_fma_f32 v[206:207], v[206:207], v[6:7], v[6:7] op_sel_hi:[1,0,0]
    v_rcp_f32 v200, v200
    v_rcp_f32 v201, v201
    v_rcp_f32 v202, v202
    v_rcp_f32 v203, v203
    v_rcp_f32 v204, v204
    v_rcp_f32 v205, v205
    v_rcp_f32 v206, v206
    v_rcp_f32 v207, v207
    v_pk_mul_f32 v[184:185], v[184:185], v[200:201]
    v_pk_mul_f32 v[186:187], v[186:187], v[202:203]
    v_pk_mul_f32 v[188:189], v[188:189], v[204:205]
    v_pk_mul_f32 v[190:191], v[190:191], v[206:207]
    v_pk_mul_f32 v[192:193], v[160:161], v[160:161]
    v_pk_add_f32 v[196:197], v[160:161], v[162:163]
    v_pk_fma_f32 v[192:193], v[162:163], v[162:163], v[192:193]
    v_pk_fma_f32 v[192:193], v[164:165], v[164:165], v[192:193]
    v_pk_add_f32 v[196:197], v[196:197], v[164:165]
    v_pk_fma_f32 v[192:193], v[166:167], v[166:167], v[192:193]
    v_pk_add_f32 v[196:197], v[196:197], v[166:167]
    v_pk_fma_f32 v[192:193], v[168:169], v[168:169], v[192:193]
    v_pk_add_f32 v[196:197], v[196:197], v[168:169]
    v_pk_fma_f32 v[192:193], v[170:171], v[170:171], v[192:193]
    v_pk_add_f32 v[196:197], v[196:197], v[170:171]
    v_pk_fma_f32 v[192:193], v[172:173], v[172:173], v[192:193]
    v_pk_add_f32 v[196:197], v[196:197], v[172:173]
    v_pk_fma_f32 v[192:193], v[174:175], v[174:175], v[192:193]
    v_pk_add_f32 v[196:197], v[196:197], v[174:175]
    v_pk_fma_f32 v[192:193], v[176:177], v[176:177], v[192:193]
    v_pk_add_f32 v[196:197], v[196:197], v[176:177]
    v_pk_fma_f32 v[192:193], v[178:179], v[178:179], v[192:193]
    v_pk_add_f32 v[196:197], v[196:197], v[178:179]
    v_pk_fma_f32 v[192:193], v[180:181], v[180:181], v[192:193]
    v_pk_add_f32 v[196:197], v[196:197], v[180:181]
    v_pk_fma_f32 v[192:193], v[182:183], v[182:183], v[192:193]
    v_pk_add_f32 v[196:197], v[196:197], v[182:183]
    v_pk_fma_f32 v[192:193], v[184:185], v[184:185], v[192:193]
    v_pk_add_f32 v[196:197], v[196:197], v[184:185]
    v_pk_fma_f32 v[192:193], v[186:187], v[186:187], v[192:193]
    v_pk_add_f32 v[196:197], v[196:197], v[186:187]
    v_pk_fma_f32 v[192:193], v[188:189], v[188:189], v[192:193]
    v_pk_add_f32 v[196:197], v[196:197], v[188:189]
    v_pk_fma_f32 v[192:193], v[190:191], v[190:191], v[192:193]
    v_pk_add_f32 v[196:197], v[196:197], v[190:191]
    v_add_f32 v196, v196, v197
    v_add_f32 v197, v192, v193
    v_mov_b32 v192, v196
    v_mov_b32 v193, v197
    s_nop 0
    v_permlane32_swap_b32 v192, v196
    v_permlane32_swap_b32 v193, v197
    v_add_f32 v196, v196, v192
    v_add_f32 v197, v197, v193
    s_not_b64 exec, s[50:51]
    s_cmp_eq_u32 s48, 1
    s_cbranch_scc1 L_plain_25
    buffer_store_dwordx4 v[196:199], v10, s[28:31], s66 offen offset:0 sc1
    s_branch L_join_26
L_plain_25:
    buffer_store_dwordx4 v[196:199], v10, s[28:31], s66 offen offset:0
L_join_26:
    s_mov_b64 exec, -1
    s_lshl_b32 s64, s44, 18
    s_lshl_b32 s63, s54, 12
    s_add_u32 s64, s64, s63
    s_add_u32 s64, s64, 10485760
    v_lshlrev_b32 v10, 2, v1
    v_xor_b32 v10, v10, v2
    v_lshlrev_b32 v10, 4, v10
    v_lshl_add_u32 v10, v1, 9, v10
    v_xor_b32 v11, 0x80, v10
    v_add_u32 v11, 1024, v11
    s_lshl_b32 s67, s44, 4
    s_add_u32 s67, s67, s27
    s_lshl_b32 s67, s67, 6
    s_add_u32 s67, s67, 49152
    v_mul_u32_u24 v9, 3584, v1
    v_lshl_add_u32 v9, v2, 4, v9
    s_mov_b32 s72, 0
    s_lshl_b32 s62, s54, 17
    s_mul_i32 s100, s26, 8192
    s_add_u32 s100, s100, 114688
    v_lshrrev_b32 v7, 3, v0
    v_mul_u32_u24 v7, 4096, v7
    v_lshrrev_b32 v8, 4, v0
    v_xor_b32 v8, v8, v0
    v_and_b32 v8, 7, v8
    v_lshl_add_u32 v7, v8, 4, v7
    v_xor_b32 v8, 64, v7
    v_add_u32 v232, s62, v7
    v_add_u32 v8, s62, v8
    v_add_u32 v233, 31744, v8
    v_add_u32 v234, 63488, v232
    v_add_u32 v235, 95232, v8
    v_bfe_u32 v8, v2, 1, 3
    v_xor_b32 v8, v8, v1
    v_lshlrev_b32 v8, 4, v8
    v_lshl_add_u32 v8, v2, 7, v8
    v_xor_b32 v236, 0, v8
    v_add_u32 v236, s100, v236
    v_xor_b32 v237, 32, v8
    v_add_u32 v237, s100, v237
    v_xor_b32 v238, 64, v8
    v_add_u32 v238, s100, v238
    v_xor_b32 v239, 96, v8
    v_add_u32 v239, s100, v239
    s_waitcnt vmcnt(1)
    s_barrier
    buffer_load_dwordx4 a[224:227], v9, s[28:31], s65 offen offset:0 sc1
    buffer_load_dwordx4 a[228:231], v9, s[28:31], s65 offen offset:512 sc1
    buffer_load_dwordx4 a[232:235], v9, s[28:31], s65 offen offset:1024 sc1
    buffer_load_dwordx4 a[236:239], v9, s[28:31], s65 offen offset:1536 sc1
    buffer_load_dwordx4 a[240:243], v9, s[28:31], s65 offen offset:2048 sc1
    buffer_load_dwordx4 a[244:247], v9, s[28:31], s65 offen offset:2560 sc1
    buffer_load_dwordx4 a[248:251], v9, s[28:31], s65 offen offset:3072 sc1
    s_mul_i32 s62, s26, 14336
    s_add_u32 s62, s62, 0
    v_add_u32 v7, s62, v4
    v_add_u32 v8, s62, v5
    ds_read_b64_tr_b16 v[128:129], v7 offset:0
    ds_read_b64_tr_b16 v[130:131], v7 offset:512
    ds_read_b64_tr_b16 v[192:193], v8 offset:0
    ds_read_b64_tr_b16 v[194:195], v8 offset:512
    ds_read_b64_tr_b16 v[132:133], v7 offset:2048
    ds_read_b64_tr_b16 v[134:135], v7 offset:2560
    ds_read_b64_tr_b16 v[196:197], v8 offset:2048
    ds_read_b64_tr_b16 v[198:199], v8 offset:2560
    ds_read_b64_tr_b16 v[136:137], v7 offset:4096
    ds_read_b64_tr_b16 v[138:139], v7 offset:4608
    ds_read_b64_tr_b16 v[200:201], v8 offset:4096
    ds_read_b64_tr_b16 v[202:203], v8 offset:4608
    ds_read_b64_tr_b16 v[140:141], v7 offset:6144
    ds_read_b64_tr_b16 v[142:143], v7 offset:6656
    ds_read_b64_tr_b16 v[204:205], v8 offset:6144
    ds_read_b64_tr_b16 v[206:207], v8 offset:6656
    ds_read_b64_tr_b16 v[144:145], v7 offset:8192
    ds_read_b64_tr_b16 v[146:147], v7 offset:8704
    ds_read_b64_tr_b16 v[208:209], v8 offset:8192
    s_branch L_pg8
    .p2align 12
L_stub8:
    s_setpc_b64 s[70:71]
L_pg8:
    ds_read_b64_tr_b16 v[210:211], v8 offset:8704
    ds_read_b64_tr_b16 v[148:149], v7 offset:10240
    ds_read_b64_tr_b16 v[150:151], v7 offset:10752
    ds_read_b64_tr_b16 v[212:213], v8 offset:10240
    ds_read_b64_tr_b16 v[214:215], v8 offset:10752
    ds_read_b64_tr_b16 v[152:153], v7 offset:12288
    ds_read_b64_tr_b16 v[154:155], v7 offset:12800
    ds_read_b64_tr_b16 v[216:217], v8 offset:12288
    ds_read_b64_tr_b16 v[218:219], v8 offset:12800
    s_waitcnt lgkmcnt(15)
    v_mfma_f32_16x16x32_bf16 v[224:227], a[252:255], v[128:131], 0
    v_mfma_f32_16x16x32_bf16 v[228:231], a[252:255], v[192:195], 0
    v_mfma_f32_16x16x32_bf16 v[224:227], a[252:255], v[132:135], v[224:227]
    v_mfma_f32_16x16x32_bf16 v[228:231], a[252:255], v[196:199], v[228:231]
    v_mfma_f32_16x16x32_bf16 v[224:227], a[252:255], v[136:139], v[224:227]
    v_mfma_f32_16x16x32_bf16 v[228:231], a[252:255], v[200:203], v[228:231]
    s_waitcnt lgkmcnt(12)
    v_mfma_f32_16x16x32_bf16 v[224:227], a[252:255], v[140:143], v[224:227]
    v_mfma_f32_16x16x32_bf16 v[228:231], a[252:255], v[204:207], v[228:231]
    s_waitcnt lgkmcnt(8)
    v_mfma_f32_16x16x32_bf16 v[224:227], a[252:255], v[144:147], v[224:227]
    v_mfma_f32_16x16x32_bf16 v[228:231], a[252:255], v[208:211], v[228:231]
    s_waitcnt lgkmcnt(4)
    v_mfma_f32_16x16x32_bf16 v[224:227], a[252:255], v[148:151], v[224:227]
    v_mfma_f32_16x16x32_bf16 v[228:231], a[252:255], v[212:215], v[228:231]
    s_waitcnt lgkmcnt(0)
    v_mfma_f32_16x16x32_bf16 v[224:227], a[252:255], v[152:155], v[224:227]
    v_mfma_f32_16x16x32_bf16 v[228:231], a[252:255], v[216:219], v[228:231]
    s_lshl_b32 s62, s26, 2
    s_add_u32 s62, s62, 156672
    v_lshl_add_u32 v7, v2, 4, s62
    s_nop 3
    ds_write_b32 v7, v224
    ds_write_b32 v7, v228 offset:512
    s_add_u32 m0, s100, 0
    s_movk_i32 s101, 1536
    buffer_load_dwordx4 v232, s[92:95], s101 offen offset:0 lds
    buffer_load_dwordx4 v233, s[92:95], s101 offen offset:1024 lds
    buffer_load_dwordx4 v234, s[92:95], s101 offen offset:2048 lds
    buffer_load_dwordx4 v235, s[92:95], s101 offen offset:3072 lds
    s_add_u32 m0, s100, 4096
    s_movk_i32 s101, 1664
    buffer_load_dwordx4 v232, s[92:95], s101 offen offset:0 lds
    buffer_load_dwordx4 v233, s[92:95], s101 offen offset:1024 lds
    buffer_load_dwordx4 v234, s[92:95], s101 offen offset:2048 lds
    buffer_load_dwordx4 v235, s[92:95], s101 offen offset:3072 lds
    s_waitcnt vmcnt(8)
    v_accvgpr_read_b32 v128, a224
    v_accvgpr_read_b32 v129, a225
    v_accvgpr_read_b32 v130, a226
    v_accvgpr_read_b32 v131, a227
    v_accvgpr_read_b32 v132, a228
    v_accvgpr_read_b32 v133, a229
    v_accvgpr_read_b32 v134, a230
    v_accvgpr_read_b32 v135, a231
    v_accvgpr_read_b32 v136, a232
    v_accvgpr_read_b32 v137, a233
    v_accvgpr_read_b32 v138, a234
    v_accvgpr_read_b32 v139, a235
    v_accvgpr_read_b32 v140, a236
    v_accvgpr_read_b32 v141, a237
    v_accvgpr_read_b32 v142, a238
    v_accvgpr_read_b32 v143, a239
    v_accvgpr_read_b32 v144, a240
    v_accvgpr_read_b32 v145, a241
    v_accvgpr_read_b32 v146, a242
    v_accvgpr_read_b32 v147, a243
    v_accvgpr_read_b32 v148, a244
    v_accvgpr_read_b32 v149, a245
    v_accvgpr_read_b32 v150, a246
    v_accvgpr_read_b32 v151, a247
    v_accvgpr_read_b32 v152, a248
    v_accvgpr_read_b32 v153, a249
    v_accvgpr_read_b32 v154, a250
    v_accvgpr_read_b32 v155, a251
    s_branch L_zs_27_c
L_zs_27:
    buffer_load_dwordx4 v[128:131], v9, s[28:31], s65 offen offset:0 sc1
    buffer_load_dwordx4 v[132:135], v9, s[28:31], s65 offen offset:512 sc1
    buffer_load_dwordx4 v[136:139], v9, s[28:31], s65 offen offset:1024 sc1
    buffer_load_dwordx4 v[140:143], v9, s[28:31], s65 offen offset:1536 sc1
    buffer_load_dwordx4 v[144:147], v9, s[28:31], s65 offen offset:2048 sc1
    buffer_load_dwordx4 v[148:151], v9, s[28:31], s65 offen offset:2560 sc1
    buffer_load_dwordx4 v[152:155], v9, s[28:31], s65 offen offset:3072 sc1
    s_add_u32 s72, s72, 1
    s_waitcnt vmcnt(0)
L_zs_27_c:
    v_xor_b32 v134, s46, v134
    v_xor_b32 v135, s47, v135
    v_xor_b32 v138, s46, v138
    v_xor_b32 v139, s47, v139
    v_xor_b32 v142, s46, v142
    v_xor_b32 v143, s47, v143
    v_xor_b32 v146, s46, v146
    v_xor_b32 v147, s47, v147
    v_xor_b32 v150, s46, v150
    v_xor_b32 v151, s47, v151
    v_xor_b32 v154, s46, v154
    v_xor_b32 v155, s47, v155
    v_or3_b32 v8, v134, v135, v138
    v_or3_b32 v8, v8, v139, v142
    v_or3_b32 v8, v8, v143, v146
    v_or3_b32 v8, v8, v147, v150
    v_or3_b32 v8, v8, v151, v154
    v_or_b32 v8, v8, v155
    v_cmp_ne_u64 s[62:63], s[46:47], v[130:131]
    v_cmp_ne_u32 vcc, 0, v8
    v_pk_add_f32 v[128:129], v[128:129], v[132:133]
    v_pk_add_f32 v[128:129], v[128:129], v[136:137]
    v_pk_add_f32 v[128:129], v[128:129], v[140:141]
    v_pk_add_f32 v[128:129], v[128:129], v[144:145]
    v_pk_add_f32 v[128:129], v[128:129], v[148:149]
    v_pk_add_f32 v[128:129], v[128:129], v[152:153]
    s_or_b64 s[62:63], s[62:63], vcc
    s_cbranch_scc0 L_zs_27_d
    s_cmp_lt_u32 s72, 100000
    s_cbranch_scc1 L_zs_27
L_zs_27_d:
    v_mov_b32 v130, v128
    v_mov_b32 v131, v129
    s_nop 0
    v_permlane32_swap_b32 v130, v128
    v_permlane32_swap_b32 v131, v129
    v_add_f32 v128, v128, v130
    v_add_f32 v129, v129, v131
    v_mul_f32 v130, 0x3a924925, v128
    v_mul_f32 v132, 0x3a924925, v129
    v_fma_f32 v132, -v130, v130, v132
    v_max_f32 v132, 0, v132
    v_add_f32 v132, 0x3727c5ac, v132
    v_rsq_f32 v132, v132
    s_nop 0
    v_mul_f32 v134, -v130, v132
    v_pk_fma_f32 v[160:161], v[160:161], v[132:133], v[134:135] op_sel_hi:[1,0,0]
    v_pk_fma_f32 v[162:163], v[162:163], v[132:133], v[134:135] op_sel_hi:[1,0,0]
    v_pk_fma_f32 v[164:165], v[164:165], v[132:133], v[134:135] op_sel_hi:[1,0,0]
    v_pk_fma_f32 v[166:167], v[166:167], v[132:133], v[134:135] op_sel_hi:[1,0,0]
    v_cvt_pk_bf16_f32 v136, v160, v161
    v_cvt_pk_bf16_f32 v137, v162, v163
    v_cvt_pk_bf16_f32 v138, v164, v165
    v_cvt_pk_bf16_f32 v139, v166, v167
    buffer_store_dwordx4 v[136:139], v10, s[28:31], s64 offen offset:0 sc1
    v_pk_fma_f32 v[168:169], v[168:169], v[132:133], v[134:135] op_sel_hi:[1,0,0]
    v_pk_fma_f32 v[170:171], v[170:171], v[132:133], v[134:135] op_sel_hi:[1,0,0]
    v_pk_fma_f32 v[172:173], v[172:173], v[132:133], v[134:135] op_sel_hi:[1,0,0]
    v_pk_fma_f32 v[174:175], v[174:175], v[132:133], v[134:135] op_sel_hi:[1,0,0]
    v_cvt_pk_bf16_f32 v140, v168, v169
    v_cvt_pk_bf16_f32 v141, v170, v171
    v_cvt_pk_bf16_f32 v142, v172, v173
    v_cvt_pk_bf16_f32 v143, v174, v175
    buffer_store_dwordx4 v[140:143], v11, s[28:31], s64 offen offset:0 sc1
    v_pk_fma_f32 v[176:177], v[176:177], v[132:133], v[134:135] op_sel_hi:[1,0,0]
    v_pk_fma_f32 v[178:179], v[178:179], v[132:133], v[134:135] op_sel_hi:[1,0,0]
    v_pk_fma_f32 v[180:181], v[180:181], v[132:133], v[134:135] op_sel_hi:[1,0,0]
    v_pk_fma_f32 v[182:183], v[182:183], v[132:133], v[134:135] op_sel_hi:[1,0,0]
    v_cvt_pk_bf16_f32 v144, v176, v177
    v_cvt_pk_bf16_f32 v145, v178, v179
    v_cvt_pk_bf16_f32 v146, v180, v181
    v_cvt_pk_bf16_f32 v147, v182, v183
    buffer_store_dwordx4 v[144:147], v10, s[28:31], s64 offen offset:2048 sc1
    v_pk_fma_f32 v[184:185], v[184:185], v[132:133], v[134:135] op_sel_hi:[1,0,0]
    v_pk_fma_f32 v[186:187], v[186:187], v[132:133], v[134:135] op_sel_hi:[1,0,0]
    v_pk_fma_f32 v[188:189], v[188:189], v[132:133], v[134:135] op_sel_hi:[1,0,0]
    v_pk_fma_f32 v[190:191], v[190:191], v[132:133], v[134:135] op_sel_hi:[1,0,0]
    v_cvt_pk_bf16_f32 v148, v184, v185
    v_cvt_pk_bf16_f32 v149, v186, v187
    v_cvt_pk_bf16_f32 v150, v188, v189
    v_cvt_pk_bf16_f32 v151, v190, v191
    buffer_store_dwordx4 v[148:151], v11, s[28:31], s64 offen offset:2048 sc1
    s_waitcnt vmcnt(4)
    ds_read_b128 a[192:195], v236 offset:0
    ds_read_b128 a[196:199], v237 offset:0
    ds_read_b128 a[200:203], v238 offset:0
    ds_read_b128 a[204:207], v239 offset:0
    ds_read_b128 a[208:211], v236 offset:4096
    ds_read_b128 a[212:215], v237 offset:4096
    ds_read_b128 a[216:219], v238 offset:4096
    ds_read_b128 a[220:223], v239 offset:4096
    ds_read_b64_tr_b16 v[128:129], v12 offset:0
    ds_read_b64_tr_b16 v[130:131], v12 offset:512
    ds_read_b64_tr_b16 v[132:133], v13 offset:0
    ds_read_b64_tr_b16 v[134:135], v13 offset:512
    ds_read_b64_tr_b16 v[136:137], v12 offset:2048
    ds_read_b64_tr_b16 v[138:139], v12 offset:2560
    ds_read_b64_tr_b16 v[140:141], v13 offset:2048
    ds_read_b64_tr_b16 v[142:143], v13 offset:2560
    ds_read_b64_tr_b16 v[144:145], v12 offset:4096
    ds_read_b64_tr_b16 v[146:147], v12 offset:4608
    ds_read_b64_tr_b16 v[148:149], v13 offset:4096
    ds_read_b64_tr_b16 v[150:151], v13 offset:4608
    s_waitcnt lgkmcnt(8)
    v_mfma_f32_32x32x16_bf16 v[192:207], v[128:131], v[16:19], 0
    ds_read_b64_tr_b16 v[152:153], v12 offset:6144
    ds_read_b64_tr_b16 v[154:155], v12 offset:6656
    ds_read_b64_tr_b16 v[156:157], v13 offset:6144
    ds_read_b64_tr_b16 v[158:159], v13 offset:6656
    v_mfma_f32_32x32x16_bf16 v[208:223], v[132:135], v[16:19], 0
    s_waitcnt lgkmcnt(8)
    v_mfma_f32_32x32x16_bf16 v[192:207], v[136:139], v[20:23], v[192:207]
    ds_read_b64_tr_b16 v[128:129], v12 offset:8192
    ds_read_b64_tr_b16 v[130:131], v12 offset:8704
    ds_read_b64_tr_b16 v[132:133], v13 offset:8192
    ds_read_b64_tr_b16 v[134:135], v13 offset:8704
    v_mfma_f32_32x32x16_bf16 v[208:223], v[140:143], v[20:23], v[208:223]
    s_waitcnt lgkmcnt(8)
    v_mfma_f32_32x32x16_bf16 v[192:207], v[144:147], v[24:27], v[192:207]
    ds_read_b64_tr_b16 v[136:137], v12 offset:10240
    ds_read_b64_tr_b16 v[138:139], v12 offset:10752
    ds_read_b64_tr_b16 v[140:141], v13 offset:10240
    ds_read_b64_tr_b16 v[142:143], v13 offset:10752
    v_mfma_f32_32x32x16_bf16 v[208:223], v[148:151], v[24:27], v[208:223]
    s_waitcnt lgkmcnt(8)
    v_mfma_f32_32x32x16_bf16 v[192:207], v[152:155], v[28:31], v[192:207]
    ds_read_b64_tr_b16 v[144:145], v12 offset:12288
    ds_read_b64_tr_b16 v[146:147], v12 offset:12800
    ds_read_b64_tr_b16 v[148:149], v13 offset:12288
    ds_read_b64_tr_b16 v[150:151], v13 offset:12800
    v_mfma_f32_32x32x16_bf16 v[208:223], v[156:159], v[28:31], v[208:223]
    s_waitcnt lgkmcnt(8)
    v_mfma_f32_32x32x16_bf16 v[192:207], v[128:131], v[32:35], v[192:207]
    ds_read_b64_tr_b16 v[152:153], v12 offset:14336
    ds_read_b64_tr_b16 v[154:155], v12 offset:14848
    ds_read_b64_tr_b16 v[156:157], v13 offset:14336
    ds_read_b64_tr_b16 v[158:159], v13 offset:14848
    v_mfma_f32_32x32x16_bf16 v[208:223], v[132:135], v[32:35], v[208:223]
    s_waitcnt lgkmcnt(8)
    v_mfma_f32_32x32x16_bf16 v[192:207], v[136:139], v[36:39], v[192:207]
    ds_read_b64_tr_b16 v[128:129], v12 offset:16384
    ds_read_b64_tr_b16 v[130:131], v12 offset:16896
    ds_read_b64_tr_b16 v[132:133], v13 offset:16384
    ds_read_b64_tr_b16 v[134:135], v13 offset:16896
    v_mfma_f32_32x32x16_bf16 v[208:223], v[140:143], v[36:39], v[208:223]
    v_mov_b32 v8, s46
    v_mov_b32 v9, s47
    s_cmp_eq_u32 s26, 0
    s_waitcnt vmcnt(0)
    s_barrier
    s_cbranch_scc0 L_pub_28
    s_mov_b64 exec, 15
    buffer_store_dwordx4 v[8:11], v3, s[28:31], s67 offen sc1
    s_mov_b64 exec, -1
L_pub_28:
    s_lshl_b32 s62, s54, 17
    s_mul_i32 s66, s26, 24576
    s_add_u32 s66, s66, 57344
    v_lshrrev_b32 v7, 3, v0
    v_mul_u32_u24 v7, 4096, v7
    v_lshrrev_b32 v8, 4, v0
    v_xor_b32 v8, v8, v0
    v_and_b32 v8, 7, v8
    v_lshl_add_u32 v7, v8, 4, v7
    v_xor_b32 v8, 64, v7
    v_add_u32 v160, s62, v7
    v_add_u32 v8, s62, v8
    v_add_u32 v161, 31744, v8
    v_add_u32 v162, 63488, v160
    v_add_u32 v163, 95232, v8
    v_bfe_u32 v8, v2, 1, 3
    v_xor_b32 v8, v8, v1
    v_lshlrev_b32 v8, 4, v8
    v_lshl_add_u32 v8, v2, 7, v8
    v_xor_b32 v164, 0, v8
    v_add_u32 v164, s66, v164
    v_xor_b32 v165, 32, v8
    v_add_u32 v165, s66, v165
    v_xor_b32 v166, 64, v8
    v_add_u32 v166, s66, v166
    v_xor_b32 v167, 96, v8
    v_add_u32 v167, s66, v167
    v_lshlrev_b32 v7, 4, v2
    v_add_u32 v7, 156672, v7
    ds_read_b128 v[172:175], v7 offset:0
    ds_read_b128 v[176:179], v7 offset:512
    s_waitcnt lgkmcnt(0)
    v_add_f32 v172, v172, v173
    v_add_f32 v174, v174, v175
    v_add_f32 v172, v172, v174
    v_cvt_pk_bf16_f32 v224, v172, v172
    v_and_b32 v225, 0xffff0000, v224
    v_sub_f32 v225, v172, v225
    v_cvt_pk_bf16_f32 v225, v225, 0
    v_mov_b32 v226, 0
    v_mov_b32 v227, 0
    v_add_f32 v176, v176, v177
    v_add_f32 v178, v178, v179
    v_add_f32 v176, v176, v178
    v_cvt_pk_bf16_f32 v228, v176, v176
    v_and_b32 v229, 0xffff0000, v228
    v_sub_f32 v229, v176, v229
    v_cvt_pk_bf16_f32 v229, v229, 0
    v_mov_b32 v230, 0
    v_mov_b32 v231, 0
    v_mfma_f32_32x32x16_bf16 v[192:207], v[144:147], v[40:43], v[192:207]
    ds_read_b64_tr_b16 v[136:137], v12 offset:18432
    ds_read_b64_tr_b16 v[138:139], v12 offset:18944
    ds_read_b64_tr_b16 v[140:141], v13 offset:18432
    ds_read_b64_tr_b16 v[142:143], v13 offset:18944
    v_mfma_f32_32x32x16_bf16 v[208:223], v[148:151], v[40:43], v[208:223]
    s_add_u32 m0, s66, 0
    s_movk_i32 s101, 1792
    buffer_load_dwordx4 v160, s[92:95], s101 offen offset:0 lds
    v_mfma_f32_32x32x16_bf16 v[192:207], v[152:155], v[44:47], v[192:207]
    ds_read_b64_tr_b16 v[144:145], v12 offset:20480
    ds_read_b64_tr_b16 v[146:147], v12 offset:20992
    ds_read_b64_tr_b16 v[148:149], v13 offset:20480
    ds_read_b64_tr_b16 v[150:151], v13 offset:20992
    v_mfma_f32_32x32x16_bf16 v[208:223], v[156:159], v[44:47], v[208:223]
    buffer_load_dwordx4 v161, s[92:95], s101 offen offset:1024 lds
    v_mfma_f32_32x32x16_bf16 v[192:207], v[128:131], v[48:51], v[192:207]
    ds_read_b64_tr_b16 v[152:153], v12 offset:22528
    ds_read_b64_tr_b16 v[154:155], v12 offset:23040
    ds_read_b64_tr_b16 v[156:157], v13 offset:22528
    ds_read_b64_tr_b16 v[158:159], v13 offset:23040
    v_mfma_f32_32x32x16_bf16 v[208:223], v[132:135], v[48:51], v[208:223]
    buffer_load_dwordx4 v162, s[92:95], s101 offen offset:2048 lds
    s_waitcnt lgkmcnt(8)
    v_mfma_f32_32x32x16_bf16 v[192:207], v[136:139], v[52:55], v[192:207]
    ds_read_b64_tr_b16 v[128:129], v12 offset:24576
    ds_read_b64_tr_b16 v[130:131], v12 offset:25088
    ds_read_b64_tr_b16 v[132:133], v13 offset:24576
    ds_read_b64_tr_b16 v[134:135], v13 offset:25088
    v_mfma_f32_32x32x16_bf16 v[208:223], v[140:143], v[52:55], v[208:223]
    buffer_load_dwordx4 v163, s[92:95], s101 offen offset:3072 lds
    s_waitcnt lgkmcnt(8)
    v_mfma_f32_32x32x16_bf16 v[192:207], v[144:147], v[56:59], v[192:207]
    ds_read_b64_tr_b16 v[136:137], v12 offset:26624
    ds_read_b64_tr_b16 v[138:139], v12 offset:27136
    ds_read_b64_tr_b16 v[140:141], v13 offset:26624
    ds_read_b64_tr_b16 v[142:143], v13 offset:27136
    v_mfma_f32_32x32x16_bf16 v[208:223], v[148:151], v[56:59], v[208:223]
    s_add_u32 m0, s66, 4096
    s_movk_i32 s101, 1920
    buffer_load_dwordx4 v160, s[92:95], s101 offen offset:0 lds
    s_waitcnt lgkmcnt(8)
    v_mfma_f32_32x32x16_bf16 v[192:207], v[152:155], v[60:63], v[192:207]
    ds_read_b64_tr_b16 v[144:145], v12 offset:28672
    ds_read_b64_tr_b16 v[146:147], v12 offset:29184
    ds_read_b64_tr_b16 v[148:149], v13 offset:28672
    ds_read_b64_tr_b16 v[150:151], v13 offset:29184
    v_mfma_f32_32x32x16_bf16 v[208:223], v[156:159], v[60:63], v[208:223]
    buffer_load_dwordx4 v161, s[92:95], s101 offen offset:1024 lds
    s_waitcnt lgkmcnt(8)
    v_mfma_f32_32x32x16_bf16 v[192:207], v[128:131], v[64:67], v[192:207]
    ds_read_b64_tr_b16 v[152:153], v12 offset:30720
    ds_read_b64_tr_b16 v[154:155], v12 offset:31232
    ds_read_b64_tr_b16 v[156:157], v13 offset:30720
    ds_read_b64_tr_b16 v[158:159], v13 offset:31232
    v_mfma_f32_32x32x16_bf16 v[208:223], v[132:135], v[64:67], v[208:223]
    buffer_load_dwordx4 v162, s[92:95], s101 offen offset:2048 lds
    s_waitcnt lgkmcnt(8)
    v_mfma_f32_32x32x16_bf16 v[192:207], v[136:139], v[68:71], v[192:207]
    ds_read_b64_tr_b16 v[128:129], v12 offset:32768
    ds_read_b64_tr_b16 v[130:131], v12 offset:33280
    ds_read_b64_tr_b16 v[132:133], v13 offset:32768
    ds_read_b64_tr_b16 v[134:135], v13 offset:33280
    v_mfma_f32_32x32x16_bf16 v[208:223], v[140:143], v[68:71], v[208:223]
    buffer_load_dwordx4 v163, s[92:95], s101 offen offset:3072 lds
    s_waitcnt lgkmcnt(8)
    v_mfma_f32_32x32x16_bf16 v[192:207], v[144:147], v[72:75], v[192:207]
    ds_read_b64_tr_b16 v[136:137], v12 offset:34816
    ds_read_b64_tr_b16 v[138:139], v12 offset:35328
    ds_read_b64_tr_b16 v[140:141], v13 offset:34816
    ds_read_b64_tr_b16 v[142:143], v13 offset:35328
    v_mfma_f32_32x32x16_bf16 v[208:223], v[148:151], v[72:75], v[208:223]
    s_add_u32 m0, s66, 8192
    s_movk_i32 s101, 2048
    buffer_load_dwordx4 v160, s[92:95], s101 offen offset:0 lds
    s_waitcnt lgkmcnt(8)
    v_mfma_f32_32x32x16_bf16 v[192:207], v[152:155], v[76:79], v[192:207]
    ds_read_b64_tr_b16 v[144:145], v12 offset:36864
    ds_read_b64_tr_b16 v[146:147], v12 offset:37376
    ds_read_b64_tr_b16 v[148:149], v13 offset:36864
    ds_read_b64_tr_b16 v[150:151], v13 offset:37376
    v_mfma_f32_32x32x16_bf16 v[208:223], v[156:159], v[76:79], v[208:223]
    buffer_load_dwordx4 v161, s[92:95], s101 offen offset:1024 lds
    s_waitcnt lgkmcnt(8)
    v_mfma_f32_32x32x16_bf16 v[192:207], v[128:131], v[80:83], v[192:207]
    ds_read_b64_tr_b16 v[152:153], v12 offset:38912
    ds_read_b64_tr_b16 v[154:155], v12 offset:39424
    ds_read_b64_tr_b16 v[156:157], v13 offset:38912
    ds_read_b64_tr_b16 v[158:159], v13 offset:39424
    v_mfma_f32_32x32x16_bf16 v[208:223], v[132:135], v[80:83], v[208:223]
    buffer_load_dwordx4 v162, s[92:95], s101 offen offset:2048 lds
    s_waitcnt lgkmcnt(8)
    v_mfma_f32_32x32x16_bf16 v[192:207], v[136:139], v[84:87], v[192:207]
    ds_read_b64_tr_b16 v[128:129], v12 offset:40960
    ds_read_b64_tr_b16 v[130:131], v12 offset:41472
    ds_read_b64_tr_b16 v[132:133], v13 offset:40960
    ds_read_b64_tr_b16 v[134:135], v13 offset:41472
    v_mfma_f32_32x32x16_bf16 v[208:223], v[140:143], v[84:87], v[208:223]
    buffer_load_dwordx4 v163, s[92:95], s101 offen offset:3072 lds
    s_waitcnt lgkmcnt(8)
    v_mfma_f32_32x32x16_bf16 v[192:207], v[144:147], v[88:91], v[192:207]
    ds_read_b64_tr_b16 v[136:137], v12 offset:43008
    ds_read_b64_tr_b16 v[138:139], v12 offset:43520
    ds_read_b64_tr_b16 v[140:141], v13 offset:43008
    ds_read_b64_tr_b16 v[142:143], v13 offset:43520
    v_mfma_f32_32x32x16_bf16 v[208:223], v[148:151], v[88:91], v[208:223]
    s_add_u32 m0, s66, 12288
    s_movk_i32 s101, 2176
    buffer_load_dwordx4 v160, s[92:95], s101 offen offset:0 lds
    s_waitcnt lgkmcnt(8)
    v_mfma_f32_32x32x16_bf16 v[192:207], v[152:155], v[92:95], v[192:207]
    ds_read_b64_tr_b16 v[144:145], v12 offset:45056
    ds_read_b64_tr_b16 v[146:147], v12 offset:45568
    ds_read_b64_tr_b16 v[148:149], v13 offset:45056
    ds_read_b64_tr_b16 v[150:151], v13 offset:45568
    v_mfma_f32_32x32x16_bf16 v[208:223], v[156:159], v[92:95], v[208:223]
    buffer_load_dwordx4 v161, s[92:95], s101 offen offset:1024 lds
    s_waitcnt lgkmcnt(8)
    v_mfma_f32_32x32x16_bf16 v[192:207], v[128:131], v[96:99], v[192:207]
    ds_read_b64_tr_b16 v[152:153], v12 offset:47104
    ds_read_b64_tr_b16 v[154:155], v12 offset:47616
    ds_read_b64_tr_b16 v[156:157], v13 offset:47104
    ds_read_b64_tr_b16 v[158:159], v13 offset:47616
    v_mfma_f32_32x32x16_bf16 v[208:223], v[132:135], v[96:99], v[208:223]
    buffer_load_dwordx4 v162, s[92:95], s101 offen offset:2048 lds
    s_waitcnt lgkmcnt(8)
    v_mfma_f32_32x32x16_bf16 v[192:207], v[136:139], v[100:103], v[192:207]
    ds_read_b64_tr_b16 v[128:129], v12 offset:49152
    ds_read_b64_tr_b16 v[130:131], v12 offset:49664
    ds_read_b64_tr_b16 v[132:133], v13 offset:49152
    ds_read_b64_tr_b16 v[134:135], v13 offset:49664
    v_mfma_f32_32x32x16_bf16 v[208:223], v[140:143], v[100:103], v[208:223]
    buffer_load_dwordx4 v163, s[92:95], s101 offen offset:3072 lds
    s_waitcnt lgkmcnt(8)
    v_mfma_f32_32x32x16_bf16 v[192:207], v[144:147], v[104:107], v[192:207]
    ds_read_b64_tr_b16 v[136:137], v12 offset:51200
    ds_read_b64_tr_b16 v[138:139], v12 offset:51712
    ds_read_b64_tr_b16 v[140:141], v13 offset:51200
    ds_read_b64_tr_b16 v[142:143], v13 offset:51712
    v_mfma_f32_32x32x16_bf16 v[208:223], v[148:151], v[104:107], v[208:223]
    s_add_u32 m0, s66, 16384
    s_movk_i32 s101, 2304
    buffer_load_dwordx4 v160, s[92:95], s101 offen offset:0 lds
    s_waitcnt lgkmcnt(8)
    v_mfma_f32_32x32x16_bf16 v[192:207], v[152:155], v[108:111], v[192:207]
    ds_read_b64_tr_b16 v[144:145], v12 offset:53248
    ds_read_b64_tr_b16 v[146:147], v12 offset:53760
    ds_read_b64_tr_b16 v[148:149], v13 offset:53248
    ds_read_b64_tr_b16 v[150:151], v13 offset:53760
    v_mfma_f32_32x32x16_bf16 v[208:223], v[156:159], v[108:111], v[208:223]
    buffer_load_dwordx4 v161, s[92:95], s101 offen offset:1024 lds
    s_waitcnt lgkmcnt(8)
    v_mfma_f32_32x32x16_bf16 v[192:207], v[128:131], v[112:115], v[192:207]
    ds_read_b64_tr_b16 v[152:153], v12 offset:55296
    ds_read_b64_tr_b16 v[154:155], v12 offset:55808
    ds_read_b64_tr_b16 v[156:157], v13 offset:55296
    ds_read_b64_tr_b16 v[158:159], v13 offset:55808
    v_mfma_f32_32x32x16_bf16 v[208:223], v[132:135], v[112:115], v[208:223]
    buffer_load_dwordx4 v162, s[92:95], s101 offen offset:2048 lds
    s_waitcnt lgkmcnt(8)
    v_mfma_f32_32x32x16_bf16 v[192:207], v[136:139], v[116:119], v[192:207]
    v_mfma_f32_32x32x16_bf16 v[208:223], v[140:143], v[116:119], v[208:223]
    buffer_load_dwordx4 v163, s[92:95], s101 offen offset:3072 lds
    s_waitcnt lgkmcnt(4)
    v_mfma_f32_32x32x16_bf16 v[192:207], v[144:147], v[120:123], v[192:207]
    v_mfma_f32_32x32x16_bf16 v[208:223], v[148:151], v[120:123], v[208:223]
    s_add_u32 m0, s66, 20480
    s_movk_i32 s101, 2432
    buffer_load_dwordx4 v160, s[92:95], s101 offen offset:0 lds
    s_waitcnt lgkmcnt(0)
    v_mfma_f32_32x32x16_bf16 v[192:207], v[152:155], v[124:127], v[192:207]
    v_mfma_f32_32x32x16_bf16 v[208:223], v[156:159], v[124:127], v[208:223]
    buffer_load_dwordx4 v161, s[92:95], s101 offen offset:1024 lds
    v_mfma_f32_32x32x16_bf16 v[192:207], v[224:227], v[240:243], v[192:207]
    v_mfma_f32_32x32x16_bf16 v[208:223], v[228:231], v[240:243], v[208:223]
    v_lshlrev_b32 v252, 16, v252
    v_bfe_u32 v7, v0, 4, 1
    v_and_b32 v8, 1, v0
    v_lshl_add_u32 v7, v7, 1, v8
    v_lshlrev_b32 v8, 1, v1
    v_xor_b32 v8, v8, v7
    v_lshlrev_b32 v8, 6, v8
    v_lshl_add_u32 v8, v7, 9, v8
    v_bfe_u32 v7, v0, 2, 2
    v_lshl_add_u32 v8, v7, 4, v8
    v_bfe_u32 v7, v0, 1, 1
    v_lshl_add_u32 v168, v7, 3, v8
    v_xor_b32 v169, 64, v168
    s_lshl_b32 s64, s55, 7
    v_lshrrev_b32 v170, 3, v0
    v_mul_u32_u24 v170, 896, v170
    v_bfe_u32 v171, v0, 4, 1
    v_lshlrev_b32 v171, 2, v171
    v_xor_b32 v171, v171, v0
    v_and_b32 v171, 7, v171
    v_lshl_add_u32 v170, v171, 4, v170
    s_mul_i32 s62, s26, 200704
    s_add_u32 s62, s62, s64
    v_add_u32 v170, s62, v170
    v_add_u32 v171, 6144, v170
    s_lshl_b32 s63, s26, 11
    s_lshl_b32 s64, s44, 18
    s_add_u32 s64, s64, s63
    s_add_u32 s64, s64, 10485760
    s_lshl_b32 s67, s44, 10
    s_add_u32 s67, s67, 49152
    v_pk_mul_f32 v[128:129], v[192:193], v[192:193]
    v_pk_mul_f32 v[130:131], v[194:195], v[194:195]
    v_pk_mul_f32 v[132:133], v[196:197], v[196:197]
    v_pk_mul_f32 v[134:135], v[198:199], v[198:199]
    v_pk_fma_f32 v[128:129], v[128:129], v[14:15], v[14:15] op_sel:[0,1,0] op_sel_hi:[1,1,0]
    v_pk_fma_f32 v[130:131], v[130:131], v[14:15], v[14:15] op_sel:[0,1,0] op_sel_hi:[1,1,0]
    v_pk_fma_f32 v[132:133], v[132:133], v[14:15], v[14:15] op_sel:[0,1,0] op_sel_hi:[1,1,0]
    v_pk_fma_f32 v[134:135], v[134:135], v[14:15], v[14:15] op_sel:[0,1,0] op_sel_hi:[1,1,0]
    v_pk_mul_f32 v[128:129], v[128:129], v[192:193]
    v_pk_mul_f32 v[130:131], v[130:131], v[194:195]
    v_pk_mul_f32 v[132:133], v[132:133], v[196:197]
    v_pk_mul_f32 v[134:135], v[134:135], v[198:199]
    v_exp_f32 v128, v128
    v_exp_f32 v129, v129
    v_exp_f32 v130, v130
    v_exp_f32 v131, v131
    v_exp_f32 v132, v132
    v_exp_f32 v133, v133
    v_exp_f32 v134, v134
    v_exp_f32 v135, v135
    v_pk_fma_f32 v[128:129], v[128:129], v[6:7], v[6:7] op_sel_hi:[1,0,0]
    v_pk_fma_f32 v[130:131], v[130:131], v[6:7], v[6:7] op_sel_hi:[1,0,0]
    v_pk_fma_f32 v[132:133], v[132:133], v[6:7], v[6:7] op_sel_hi:[1,0,0]
    v_pk_fma_f32 v[134:135], v[134:135], v[6:7], v[6:7] op_sel_hi:[1,0,0]
    v_rcp_f32 v128, v128
    v_rcp_f32 v129, v129
    v_rcp_f32 v130, v130
    v_rcp_f32 v131, v131
    v_rcp_f32 v132, v132
    v_rcp_f32 v133, v133
    v_rcp_f32 v134, v134
    v_rcp_f32 v135, v135
    buffer_load_dwordx4 v162, s[92:95], s101 offen offset:2048 lds
    v_pk_mul_f32 v[192:193], v[192:193], v[128:129]
    v_pk_mul_f32 v[194:195], v[194:195], v[130:131]
    v_pk_mul_f32 v[196:197], v[196:197], v[132:133]
    v_pk_mul_f32 v[198:199], v[198:199], v[134:135]
    v_pk_mul_f32 v[128:129], v[200:201], v[200:201]
    v_pk_mul_f32 v[130:131], v[202:203], v[202:203]
    v_pk_mul_f32 v[132:133], v[204:205], v[204:205]
    v_pk_mul_f32 v[134:135], v[206:207], v[206:207]
    v_pk_fma_f32 v[128:129], v[128:129], v[14:15], v[14:15] op_sel:[0,1,0] op_sel_hi:[1,1,0]
    v_pk_fma_f32 v[130:131], v[130:131], v[14:15], v[14:15] op_sel:[0,1,0] op_sel_hi:[1,1,0]
    v_pk_fma_f32 v[132:133], v[132:133], v[14:15], v[14:15] op_sel:[0,1,0] op_sel_hi:[1,1,0]
    v_pk_fma_f32 v[134:135], v[134:135], v[14:15], v[14:15] op_sel:[0,1,0] op_sel_hi:[1,1,0]
    v_pk_mul_f32 v[128:129], v[128:129], v[200:201]
    v_pk_mul_f32 v[130:131], v[130:131], v[202:203]
    v_pk_mul_f32 v[132:133], v[132:133], v[204:205]
    v_pk_mul_f32 v[134:135], v[134:135], v[206:207]
    v_exp_f32 v128, v128
    v_exp_f32 v129, v129
    v_exp_f32 v130, v130
    v_exp_f32 v131, v131
    v_exp_f32 v132, v132
    v_exp_f32 v133, v133
    v_exp_f32 v134, v134
    v_exp_f32 v135, v135
    v_pk_fma_f32 v[128:129], v[128:129], v[6:7], v[6:7] op_sel_hi:[1,0,0]
    v_pk_fma_f32 v[130:131], v[130:131], v[6:7], v[6:7] op_sel_hi:[1,0,0]
    v_pk_fma_f32 v[132:133], v[132:133], v[6:7], v[6:7] op_sel_hi:[1,0,0]
    v_pk_fma_f32 v[134:135], v[134:135], v[6:7], v[6:7] op_sel_hi:[1,0,0]
    v_rcp_f32 v128, v128
    v_rcp_f32 v129, v129
    v_rcp_f32 v130, v130
    v_rcp_f32 v131, v131
    v_rcp_f32 v132, v132
    v_rcp_f32 v133, v133
    v_rcp_f32 v134, v134
    v_rcp_f32 v135, v135
    buffer_load_dwordx4 v163, s[92:95], s101 offen offset:3072 lds
    v_pk_mul_f32 v[200:201], v[200:201], v[128:129]
    v_pk_mul_f32 v[202:203], v[202:203], v[130:131]
    v_pk_mul_f32 v[204:205], v[204:205], v[132:133]
    v_pk_mul_f32 v[206:207], v[206:207], v[134:135]
    v_cmp_gt_u32 vcc, 16, v0
    v_lshlrev_b32 v172, 6, v0
    s_nop 0
    v_cndmask_b32 v172, 0, v172, vcc
    buffer_load_dwordx2 v[172:173], v172, s[28:31], s67 offen offset:0 sc1
    v_pk_mul_f32 v[128:129], v[208:209], v[208:209]
    v_pk_mul_f32 v[130:131], v[210:211], v[210:211]
    v_pk_mul_f32 v[132:133], v[212:213], v[212:213]
    v_pk_mul_f32 v[134:135], v[214:215], v[214:215]
    v_pk_fma_f32 v[128:129], v[128:129], v[14:15], v[14:15] op_sel:[0,1,0] op_sel_hi:[1,1,0]
    v_pk_fma_f32 v[130:131], v[130:131], v[14:15], v[14:15] op_sel:[0,1,0] op_sel_hi:[1,1,0]
    v_pk_fma_f32 v[132:133], v[132:133], v[14:15], v[14:15] op_sel:[0,1,0] op_sel_hi:[1,1,0]
    v_pk_fma_f32 v[134:135], v[134:135], v[14:15], v[14:15] op_sel:[0,1,0] op_sel_hi:[1,1,0]
    v_pk_mul_f32 v[128:129], v[128:129], v[208:209]
    v_pk_mul_f32 v[130:131], v[130:131], v[210:211]
    v_pk_mul_f32 v[132:133], v[132:133], v[212:213]
    v_pk_mul_f32 v[134:135], v[134:135], v[214:215]
    v_exp_f32 v128, v128
    v_exp_f32 v129, v129
    v_exp_f32 v130, v130
    v_exp_f32 v131, v131
    v_exp_f32 v132, v132
    v_exp_f32 v133, v133
    v_exp_f32 v134, v134
    v_exp_f32 v135, v135
    v_pk_fma_f32 v[128:129], v[128:129], v[6:7], v[6:7] op_sel_hi:[1,0,0]
    v_pk_fma_f32 v[130:131], v[130:131], v[6:7], v[6:7] op_sel_hi:[1,0,0]
    v_pk_fma_f32 v[132:133], v[132:133], v[6:7], v[6:7] op_sel_hi:[1,0,0]
    v_pk_fma_f32 v[134:135], v[134:135], v[6:7], v[6:7] op_sel_hi:[1,0,0]
    v_rcp_f32 v128, v128
    v_rcp_f32 v129, v129
    s_branch L_pg9
    .p2align 12
L_stub9:
    s_setpc_b64 s[70:71]
L_pg9:
    v_rcp_f32 v130, v130
    v_rcp_f32 v131, v131
    v_rcp_f32 v132, v132
    v_rcp_f32 v133, v133
    v_rcp_f32 v134, v134
    v_rcp_f32 v135, v135
    v_pk_mul_f32 v[208:209], v[208:209], v[128:129]
    v_pk_mul_f32 v[210:211], v[210:211], v[130:131]
    v_pk_mul_f32 v[212:213], v[212:213], v[132:133]
    v_pk_mul_f32 v[214:215], v[214:215], v[134:135]
    s_waitcnt vmcnt(0)
    v_cmp_ne_u64 vcc, s[46:47], v[172:173]
    s_cbranch_vccz L_pollskip_29
    s_cmp_eq_u32 s26, 0
    s_cbranch_scc0 L_pollskip_29
    v_lshlrev_b32 v7, 6, v0
    s_mov_b64 exec, 0xffff
    s_mov_b32 s72, 0
L_poll_30:
    buffer_load_dwordx2 v[8:9], v7, s[28:31], s67 offen sc1
    s_add_u32 s72, s72, 1
    s_waitcnt vmcnt(0)
    v_cmp_ne_u64 vcc, s[46:47], v[8:9]
    s_cbranch_vccz L_poll_30_d
    s_cmp_lt_u32 s72, 100000
    s_cbranch_scc1 L_poll_30
L_poll_30_d:
    s_mov_b64 exec, -1
L_pollskip_29:
    s_barrier
    s_add_u32 m0, s63, 0
    s_add_u32 s62, s64, 114688
    buffer_load_dwordx4 v3, s[28:31], s62 offen offset:0 sc1 lds
    buffer_load_dwordx4 v3, s[28:31], s62 offen offset:1024 sc1 lds
    s_add_u32 m0, s63, 8192
    s_add_u32 s62, s64, 0
    buffer_load_dwordx4 v3, s[28:31], s62 offen offset:0 sc1 lds
    buffer_load_dwordx4 v3, s[28:31], s62 offen offset:1024 sc1 lds
    s_add_u32 m0, s63, 16384
    s_add_u32 s62, s64, 122880
    buffer_load_dwordx4 v3, s[28:31], s62 offen offset:0 sc1 lds
    buffer_load_dwordx4 v3, s[28:31], s62 offen offset:1024 sc1 lds
    s_add_u32 m0, s63, 24576
    s_add_u32 s62, s64, 8192
    buffer_load_dwordx4 v3, s[28:31], s62 offen offset:0 sc1 lds
    buffer_load_dwordx4 v3, s[28:31], s62 offen offset:1024 sc1 lds
    s_add_u32 m0, s63, 32768
    s_add_u32 s62, s64, 131072
    buffer_load_dwordx4 v3, s[28:31], s62 offen offset:0 sc1 lds
    buffer_load_dwordx4 v3, s[28:31], s62 offen offset:1024 sc1 lds
    v_pk_mul_f32 v[128:129], v[216:217], v[216:217]
    v_pk_mul_f32 v[130:131], v[218:219], v[218:219]
    v_pk_mul_f32 v[132:133], v[220:221], v[220:221]
    v_pk_mul_f32 v[134:135], v[222:223], v[222:223]
    v_pk_fma_f32 v[128:129], v[128:129], v[14:15], v[14:15] op_sel:[0,1,0] op_sel_hi:[1,1,0]
    v_pk_fma_f32 v[130:131], v[130:131], v[14:15], v[14:15] op_sel:[0,1,0] op_sel_hi:[1,1,0]
    v_pk_fma_f32 v[132:133], v[132:133], v[14:15], v[14:15] op_sel:[0,1,0] op_sel_hi:[1,1,0]
    v_pk_fma_f32 v[134:135], v[134:135], v[14:15], v[14:15] op_sel:[0,1,0] op_sel_hi:[1,1,0]
    v_pk_mul_f32 v[128:129], v[128:129], v[216:217]
    v_pk_mul_f32 v[130:131], v[130:131], v[218:219]
    v_pk_mul_f32 v[132:133], v[132:133], v[220:221]
    v_pk_mul_f32 v[134:135], v[134:135], v[222:223]
    v_exp_f32 v128, v128
    v_exp_f32 v129, v129
    v_exp_f32 v130, v130
    v_exp_f32 v131, v131
    v_exp_f32 v132, v132
    v_exp_f32 v133, v133
    v_exp_f32 v134, v134
    v_exp_f32 v135, v135
    v_pk_fma_f32 v[128:129], v[128:129], v[6:7], v[6:7] op_sel_hi:[1,0,0]
    v_pk_fma_f32 v[130:131], v[130:131], v[6:7], v[6:7] op_sel_hi:[1,0,0]
    v_pk_fma_f32 v[132:133], v[132:133], v[6:7], v[6:7] op_sel_hi:[1,0,0]
    v_pk_fma_f32 v[134:135], v[134:135], v[6:7], v[6:7] op_sel_hi:[1,0,0]
    v_rcp_f32 v128, v128
    v_rcp_f32 v129, v129
    v_rcp_f32 v130, v130
    v_rcp_f32 v131, v131
    v_rcp_f32 v132, v132
    v_rcp_f32 v133, v133
    v_rcp_f32 v134, v134
    v_rcp_f32 v135, v135
    v_pk_mul_f32 v[216:217], v[216:217], v[128:129]
    v_pk_mul_f32 v[218:219], v[218:219], v[130:131]
    v_pk_mul_f32 v[220:221], v[220:221], v[132:133]
    v_pk_mul_f32 v[222:223], v[222:223], v[134:135]
    s_waitcnt vmcnt(8)
    s_barrier
    ds_read_b64_tr_b16 v[48:49], v168 offset:0
    ds_read_b64_tr_b16 v[50:51], v169 offset:0
    ds_read_b64_tr_b16 v[52:53], v168 offset:2048
    ds_read_b64_tr_b16 v[54:55], v169 offset:2048
    ds_read_b128 v[80:83], v164 offset:0
    ds_read_b64_tr_b16 v[56:57], v168 offset:256
    ds_read_b64_tr_b16 v[58:59], v169 offset:256
    ds_read_b64_tr_b16 v[60:61], v168 offset:2304
    ds_read_b64_tr_b16 v[62:63], v169 offset:2304
    ds_read_b128 v[84:87], v165 offset:0
    s_waitcnt lgkmcnt(5)
    v_mfma_f32_32x32x16_bf16 v[16:31], v[48:51], v[80:83], 0
    ds_read_b64_tr_b16 v[64:65], v168 offset:4096
    ds_read_b64_tr_b16 v[66:67], v169 offset:4096
    ds_read_b128 v[88:91], v166 offset:0
    v_mfma_f32_32x32x16_bf16 v[32:47], v[52:55], v[80:83], 0
    ds_read_b64_tr_b16 v[68:69], v168 offset:6144
    ds_read_b64_tr_b16 v[70:71], v169 offset:6144
    s_waitcnt lgkmcnt(5)
    v_mfma_f32_32x32x16_bf16 v[16:31], v[56:59], v[84:87], v[16:31]
    ds_read_b64_tr_b16 v[72:73], v168 offset:4352
    ds_read_b64_tr_b16 v[74:75], v169 offset:4352
    ds_read_b128 v[92:95], v167 offset:0
    v_mfma_f32_32x32x16_bf16 v[32:47], v[60:63], v[84:87], v[32:47]
    ds_read_b64_tr_b16 v[76:77], v168 offset:6400
    ds_read_b64_tr_b16 v[78:79], v169 offset:6400
    s_waitcnt lgkmcnt(5)
    v_mfma_f32_32x32x16_bf16 v[16:31], v[64:67], v[88:91], v[16:31]
    s_waitcnt vmcnt(6)
    s_barrier
    ds_read_b64_tr_b16 v[48:49], v168 offset:8192
    ds_read_b64_tr_b16 v[50:51], v169 offset:8192
    v_mfma_f32_32x32x16_bf16 v[32:47], v[68:71], v[88:91], v[32:47]
    ds_read_b64_tr_b16 v[52:53], v168 offset:10240
    ds_read_b64_tr_b16 v[54:55], v169 offset:10240
    s_add_u32 m0, s63, 40960
    s_add_u32 s62, s64, 16384
    buffer_load_dwordx4 v3, s[28:31], s62 offen offset:0 sc1 lds
    s_waitcnt lgkmcnt(4)
    v_mfma_f32_32x32x16_bf16 v[16:31], v[72:75], v[92:95], v[16:31]
    ds_read_b64_tr_b16 v[56:57], v168 offset:8448
    ds_read_b64_tr_b16 v[58:59], v169 offset:8448
    v_mfma_f32_32x32x16_bf16 v[32:47], v[76:79], v[92:95], v[32:47]
    ds_read_b64_tr_b16 v[60:61], v168 offset:10496
    ds_read_b64_tr_b16 v[62:63], v169 offset:10496
    buffer_load_dwordx4 v3, s[28:31], s62 offen offset:1024 sc1 lds
    s_waitcnt lgkmcnt(4)
    v_mfma_f32_32x32x16_bf16 v[16:31], v[48:51], a[0:3], v[16:31]
    ds_read_b64_tr_b16 v[64:65], v168 offset:12288
    ds_read_b64_tr_b16 v[66:67], v169 offset:12288
    v_mfma_f32_32x32x16_bf16 v[32:47], v[52:55], a[0:3], v[32:47]
    ds_read_b64_tr_b16 v[68:69], v168 offset:14336
    ds_read_b64_tr_b16 v[70:71], v169 offset:14336
    s_waitcnt lgkmcnt(4)
    v_mfma_f32_32x32x16_bf16 v[16:31], v[56:59], a[4:7], v[16:31]
    ds_read_b64_tr_b16 v[72:73], v168 offset:12544
    ds_read_b64_tr_b16 v[74:75], v169 offset:12544
    v_mfma_f32_32x32x16_bf16 v[32:47], v[60:63], a[4:7], v[32:47]
    ds_read_b64_tr_b16 v[76:77], v168 offset:14592
    ds_read_b64_tr_b16 v[78:79], v169 offset:14592
    s_waitcnt lgkmcnt(4)
    v_mfma_f32_32x32x16_bf16 v[16:31], v[64:67], a[8:11], v[16:31]
    s_waitcnt vmcnt(6)
    s_barrier
    ds_read_b64_tr_b16 v[48:49], v168 offset:16384
    ds_read_b64_tr_b16 v[50:51], v169 offset:16384
    ds_read_b128 v[80:83], v164 offset:4096
    v_mfma_f32_32x32x16_bf16 v[32:47], v[68:71], a[8:11], v[32:47]
    ds_read_b64_tr_b16 v[52:53], v168 offset:18432
    ds_read_b64_tr_b16 v[54:55], v169 offset:18432
    s_add_u32 m0, s63, 0
    s_add_u32 s62, s64, 139264
    buffer_load_dwordx4 v3, s[28:31], s62 offen offset:0 sc1 lds
    s_waitcnt lgkmcnt(5)
    v_mfma_f32_32x32x16_bf16 v[16:31], v[72:75], a[12:15], v[16:31]
    ds_read_b64_tr_b16 v[56:57], v168 offset:16640
    ds_read_b64_tr_b16 v[58:59], v169 offset:16640
    ds_read_b128 v[84:87], v165 offset:4096
    v_mfma_f32_32x32x16_bf16 v[32:47], v[76:79], a[12:15], v[32:47]
    ds_read_b64_tr_b16 v[60:61], v168 offset:18688
    ds_read_b64_tr_b16 v[62:63], v169 offset:18688
    buffer_load_dwordx4 v3, s[28:31], s62 offen offset:1024 sc1 lds
    s_waitcnt lgkmcnt(5)
    v_mfma_f32_32x32x16_bf16 v[16:31], v[48:51], v[80:83], v[16:31]
    ds_read_b64_tr_b16 v[64:65], v168 offset:20480
    ds_read_b64_tr_b16 v[66:67], v169 offset:20480
    ds_read_b128 v[88:91], v166 offset:4096
    v_mfma_f32_32x32x16_bf16 v[32:47], v[52:55], v[80:83], v[32:47]
    ds_read_b64_tr_b16 v[68:69], v168 offset:22528
    ds_read_b64_tr_b16 v[70:71], v169 offset:22528
    s_add_u32 m0, s66, 0
    s_movk_i32 s101, 2560
    buffer_load_dwordx4 v160, s[92:95], s101 offen offset:0 lds
    s_waitcnt lgkmcnt(5)
    v_mfma_f32_32x32x16_bf16 v[16:31], v[56:59], v[84:87], v[16:31]
    ds_read_b64_tr_b16 v[72:73], v168 offset:20736
    ds_read_b64_tr_b16 v[74:75], v169 offset:20736
    ds_read_b128 v[92:95], v167 offset:4096
    v_mfma_f32_32x32x16_bf16 v[32:47], v[60:63], v[84:87], v[32:47]
    ds_read_b64_tr_b16 v[76:77], v168 offset:22784
    ds_read_b64_tr_b16 v[78:79], v169 offset:22784
    buffer_load_dwordx4 v161, s[92:95], s101 offen offset:1024 lds
    s_waitcnt lgkmcnt(5)
    v_mfma_f32_32x32x16_bf16 v[16:31], v[64:67], v[88:91], v[16:31]
    s_waitcnt vmcnt(8)
    s_barrier
    ds_read_b64_tr_b16 v[48:49], v168 offset:24576
    ds_read_b64_tr_b16 v[50:51], v169 offset:24576
    v_mfma_f32_32x32x16_bf16 v[32:47], v[68:71], v[88:91], v[32:47]
    ds_read_b64_tr_b16 v[52:53], v168 offset:26624
    ds_read_b64_tr_b16 v[54:55], v169 offset:26624
    buffer_load_dwordx4 v162, s[92:95], s101 offen offset:2048 lds
    s_waitcnt lgkmcnt(4)
    v_mfma_f32_32x32x16_bf16 v[16:31], v[72:75], v[92:95], v[16:31]
    ds_read_b64_tr_b16 v[56:57], v168 offset:24832
    ds_read_b64_tr_b16 v[58:59], v169 offset:24832
    v_mfma_f32_32x32x16_bf16 v[32:47], v[76:79], v[92:95], v[32:47]
    ds_read_b64_tr_b16 v[60:61], v168 offset:26880
    ds_read_b64_tr_b16 v[62:63], v169 offset:26880
    buffer_load_dwordx4 v163, s[92:95], s101 offen offset:3072 lds
    s_waitcnt lgkmcnt(4)
    v_mfma_f32_32x32x16_bf16 v[16:31], v[48:51], a[16:19], v[16:31]
    ds_read_b64_tr_b16 v[64:65], v168 offset:28672
    ds_read_b64_tr_b16 v[66:67], v169 offset:28672
    v_mfma_f32_32x32x16_bf16 v[32:47], v[52:55], a[16:19], v[32:47]
    ds_read_b64_tr_b16 v[68:69], v168 offset:30720
    ds_read_b64_tr_b16 v[70:71], v169 offset:30720
    s_add_u32 m0, s63, 8192
    s_add_u32 s62, s64, 24576
    buffer_load_dwordx4 v3, s[28:31], s62 offen offset:0 sc1 lds
    s_waitcnt lgkmcnt(4)
    v_mfma_f32_32x32x16_bf16 v[16:31], v[56:59], a[20:23], v[16:31]
    ds_read_b64_tr_b16 v[72:73], v168 offset:28928
    ds_read_b64_tr_b16 v[74:75], v169 offset:28928
    v_mfma_f32_32x32x16_bf16 v[32:47], v[60:63], a[20:23], v[32:47]
    ds_read_b64_tr_b16 v[76:77], v168 offset:30976
    ds_read_b64_tr_b16 v[78:79], v169 offset:30976
    buffer_load_dwordx4 v3, s[28:31], s62 offen offset:1024 sc1 lds
    s_waitcnt lgkmcnt(4)
    v_mfma_f32_32x32x16_bf16 v[16:31], v[64:67], a[24:27], v[16:31]
    s_waitcnt vmcnt(10)
    s_barrier
    ds_read_b64_tr_b16 v[48:49], v168 offset:32768
    ds_read_b64_tr_b16 v[50:51], v169 offset:32768
    ds_read_b128 v[80:83], v164 offset:8192
    v_mfma_f32_32x32x16_bf16 v[32:47], v[68:71], a[24:27], v[32:47]
    ds_read_b64_tr_b16 v[52:53], v168 offset:34816
    ds_read_b64_tr_b16 v[54:55], v169 offset:34816
    s_add_u32 m0, s63, 16384
    s_add_u32 s62, s64, 147456
    buffer_load_dwordx4 v3, s[28:31], s62 offen offset:0 sc1 lds
    s_waitcnt lgkmcnt(5)
    v_mfma_f32_32x32x16_bf16 v[16:31], v[72:75], a[28:31], v[16:31]
    ds_read_b64_tr_b16 v[56:57], v168 offset:33024
    ds_read_b64_tr_b16 v[58:59], v169 offset:33024
    ds_read_b128 v[84:87], v165 offset:8192
    v_mfma_f32_32x32x16_bf16 v[32:47], v[76:79], a[28:31], v[32:47]
    ds_read_b64_tr_b16 v[60:61], v168 offset:35072
    ds_read_b64_tr_b16 v[62:63], v169 offset:35072
    buffer_load_dwordx4 v3, s[28:31], s62 offen offset:1024 sc1 lds
    s_waitcnt lgkmcnt(5)
    v_mfma_f32_32x32x16_bf16 v[16:31], v[48:51], v[80:83], v[16:31]
    ds_read_b64_tr_b16 v[64:65], v168 offset:36864
    ds_read_b64_tr_b16 v[66:67], v169 offset:36864
    ds_read_b128 v[88:91], v166 offset:8192
    v_mfma_f32_32x32x16_bf16 v[32:47], v[52:55], v[80:83], v[32:47]
    ds_read_b64_tr_b16 v[68:69], v168 offset:38912
    ds_read_b64_tr_b16 v[70:71], v169 offset:38912
    s_add_u32 m0, s66, 4096
    s_movk_i32 s101, 2688
    buffer_load_dwordx4 v160, s[92:95], s101 offen offset:0 lds
    s_waitcnt lgkmcnt(5)
    v_mfma_f32_32x32x16_bf16 v[16:31], v[56:59], v[84:87], v[16:31]
    ds_read_b64_tr_b16 v[72:73], v168 offset:37120
    ds_read_b64_tr_b16 v[74:75], v169 offset:37120
    ds_read_b128 v[92:95], v167 offset:8192
    v_mfma_f32_32x32x16_bf16 v[32:47], v[60:63], v[84:87], v[32:47]
    ds_read_b64_tr_b16 v[76:77], v168 offset:39168
    ds_read_b64_tr_b16 v[78:79], v169 offset:39168
    buffer_load_dwordx4 v161, s[92:95], s101 offen offset:1024 lds
    s_waitcnt lgkmcnt(5)
    v_mfma_f32_32x32x16_bf16 v[16:31], v[64:67], v[88:91], v[16:31]
    s_waitcnt vmcnt(12)
    s_barrier
    ds_read_b64_tr_b16 v[48:49], v168 offset:40960
    ds_read_b64_tr_b16 v[50:51], v169 offset:40960
    v_mfma_f32_32x32x16_bf16 v[32:47], v[68:71], v[88:91], v[32:47]
    ds_read_b64_tr_b16 v[52:53], v168 offset:43008
    ds_read_b64_tr_b16 v[54:55], v169 offset:43008
    buffer_load_dwordx4 v162, s[92:95], s101 offen offset:2048 lds
    s_waitcnt lgkmcnt(4)
    v_mfma_f32_32x32x16_bf16 v[16:31], v[72:75], v[92:95], v[16:31]
    ds_read_b64_tr_b16 v[56:57], v168 offset:41216
    ds_read_b64_tr_b16 v[58:59], v169 offset:41216
    v_mfma_f32_32x32x16_bf16 v[32:47], v[76:79], v[92:95], v[32:47]
    ds_read_b64_tr_b16 v[60:61], v168 offset:43264
    ds_read_b64_tr_b16 v[62:63], v169 offset:43264
    buffer_load_dwordx4 v163, s[92:95], s101 offen offset:3072 lds
    s_waitcnt lgkmcnt(4)
    v_mfma_f32_32x32x16_bf16 v[16:31], v[48:51], a[32:35], v[16:31]
    ds_read_b64_tr_b16 v[64:65], v168 offset:45056
    ds_read_b64_tr_b16 v[66:67], v169 offset:45056
    v_mfma_f32_32x32x16_bf16 v[32:47], v[52:55], a[32:35], v[32:47]
    ds_read_b64_tr_b16 v[68:69], v168 offset:47104
    ds_read_b64_tr_b16 v[70:71], v169 offset:47104
    s_add_u32 m0, s63, 24576
    s_add_u32 s62, s64, 32768
    buffer_load_dwordx4 v3, s[28:31], s62 offen offset:0 sc1 lds
    s_waitcnt lgkmcnt(4)
    v_mfma_f32_32x32x16_bf16 v[16:31], v[56:59], a[36:39], v[16:31]
    ds_read_b64_tr_b16 v[72:73], v168 offset:45312
    ds_read_b64_tr_b16 v[74:75], v169 offset:45312
    v_mfma_f32_32x32x16_bf16 v[32:47], v[60:63], a[36:39], v[32:47]
    ds_read_b64_tr_b16 v[76:77], v168 offset:47360
    ds_read_b64_tr_b16 v[78:79], v169 offset:47360
    buffer_load_dwordx4 v3, s[28:31], s62 offen offset:1024 sc1 lds
    s_waitcnt lgkmcnt(4)
    v_mfma_f32_32x32x16_bf16 v[16:31], v[64:67], a[40:43], v[16:31]
    s_waitcnt vmcnt(14)
    s_barrier
    ds_read_b64_tr_b16 v[48:49], v168 offset:0
    ds_read_b64_tr_b16 v[50:51], v169 offset:0
    ds_read_b128 v[80:83], v164 offset:12288
    v_mfma_f32_32x32x16_bf16 v[32:47], v[68:71], a[40:43], v[32:47]
    ds_read_b64_tr_b16 v[52:53], v168 offset:2048
    ds_read_b64_tr_b16 v[54:55], v169 offset:2048
    s_add_u32 m0, s63, 32768
    s_add_u32 s62, s64, 155648
    buffer_load_dwordx4 v3, s[28:31], s62 offen offset:0 sc1 lds
    s_waitcnt lgkmcnt(5)
    v_mfma_f32_32x32x16_bf16 v[16:31], v[72:75], a[44:47], v[16:31]
    ds_read_b64_tr_b16 v[56:57], v168 offset:256
    ds_read_b64_tr_b16 v[58:59], v169 offset:256
    ds_read_b128 v[84:87], v165 offset:12288
    v_mfma_f32_32x32x16_bf16 v[32:47], v[76:79], a[44:47], v[32:47]
    ds_read_b64_tr_b16 v[60:61], v168 offset:2304
    ds_read_b64_tr_b16 v[62:63], v169 offset:2304
    buffer_load_dwordx4 v3, s[28:31], s62 offen offset:1024 sc1 lds
    s_waitcnt lgkmcnt(5)
    v_mfma_f32_32x32x16_bf16 v[16:31], v[48:51], v[80:83], v[16:31]
    ds_read_b64_tr_b16 v[64:65], v168 offset:4096
    ds_read_b64_tr_b16 v[66:67], v169 offset:4096
    ds_read_b128 v[88:91], v166 offset:12288
    v_mfma_f32_32x32x16_bf16 v[32:47], v[52:55], v[80:83], v[32:47]
    ds_read_b64_tr_b16 v[68:69], v168 offset:6144
    ds_read_b64_tr_b16 v[70:71], v169 offset:6144
    s_add_u32 m0, s66, 8192
    s_movk_i32 s101, 2816
    buffer_load_dwordx4 v160, s[92:95], s101 offen offset:0 lds
    s_waitcnt lgkmcnt(5)
    v_mfma_f32_32x32x16_bf16 v[16:31], v[56:59], v[84:87], v[16:31]
    ds_read_b64_tr_b16 v[72:73], v168 offset:4352
    ds_read_b64_tr_b16 v[74:75], v169 offset:4352
    ds_read_b128 v[92:95], v167 offset:12288
    v_mfma_f32_32x32x16_bf16 v[32:47], v[60:63], v[84:87], v[32:47]
    ds_read_b64_tr_b16 v[76:77], v168 offset:6400
    ds_read_b64_tr_b16 v[78:79], v169 offset:6400
    buffer_load_dwordx4 v161, s[92:95], s101 offen offset:1024 lds
    s_waitcnt lgkmcnt(5)
    v_mfma_f32_32x32x16_bf16 v[16:31], v[64:67], v[88:91], v[16:31]
    s_waitcnt vmcnt(12)
    s_barrier
    ds_read_b64_tr_b16 v[48:49], v168 offset:8192
    ds_read_b64_tr_b16 v[50:51], v169 offset:8192
    v_mfma_f32_32x32x16_bf16 v[32:47], v[68:71], v[88:91], v[32:47]
    ds_read_b64_tr_b16 v[52:53], v168 offset:10240
    ds_read_b64_tr_b16 v[54:55], v169 offset:10240
    buffer_load_dwordx4 v162, s[92:95], s101 offen offset:2048 lds
    s_waitcnt lgkmcnt(4)
    v_mfma_f32_32x32x16_bf16 v[16:31], v[72:75], v[92:95], v[16:31]
    ds_read_b64_tr_b16 v[56:57], v168 offset:8448
    ds_read_b64_tr_b16 v[58:59], v169 offset:8448
    v_mfma_f32_32x32x16_bf16 v[32:47], v[76:79], v[92:95], v[32:47]
    ds_read_b64_tr_b16 v[60:61], v168 offset:10496
    ds_read_b64_tr_b16 v[62:63], v169 offset:10496
    buffer_load_dwordx4 v163, s[92:95], s101 offen offset:3072 lds
    s_waitcnt lgkmcnt(4)
    v_mfma_f32_32x32x16_bf16 v[16:31], v[48:51], a[48:51], v[16:31]
    ds_read_b64_tr_b16 v[64:65], v168 offset:12288
    ds_read_b64_tr_b16 v[66:67], v169 offset:12288
    v_mfma_f32_32x32x16_bf16 v[32:47], v[52:55], a[48:51], v[32:47]
    ds_read_b64_tr_b16 v[68:69], v168 offset:14336
    ds_read_b64_tr_b16 v[70:71], v169 offset:14336
    s_add_u32 m0, s63, 40960
    s_add_u32 s62, s64, 40960
    buffer_load_dwordx4 v3, s[28:31], s62 offen offset:0 sc1 lds
    s_waitcnt lgkmcnt(4)
    v_mfma_f32_32x32x16_bf16 v[16:31], v[56:59], a[52:55], v[16:31]
    ds_read_b64_tr_b16 v[72:73], v168 offset:12544
    ds_read_b64_tr_b16 v[74:75], v169 offset:12544
    v_mfma_f32_32x32x16_bf16 v[32:47], v[60:63], a[52:55], v[32:47]
    ds_read_b64_tr_b16 v[76:77], v168 offset:14592
    ds_read_b64_tr_b16 v[78:79], v169 offset:14592
    buffer_load_dwordx4 v3, s[28:31], s62 offen offset:1024 sc1 lds
    s_waitcnt lgkmcnt(4)
    v_mfma_f32_32x32x16_bf16 v[16:31], v[64:67], a[56:59], v[16:31]
    s_waitcnt vmcnt(14)
    s_barrier
    ds_read_b64_tr_b16 v[48:49], v168 offset:16384
    ds_read_b64_tr_b16 v[50:51], v169 offset:16384
    ds_read_b128 v[80:83], v164 offset:16384
    v_mfma_f32_32x32x16_bf16 v[32:47], v[68:71], a[56:59], v[32:47]
    ds_read_b64_tr_b16 v[52:53], v168 offset:18432
    ds_read_b64_tr_b16 v[54:55], v169 offset:18432
    s_add_u32 m0, s63, 0
    s_add_u32 s62, s64, 163840
    buffer_load_dwordx4 v3, s[28:31], s62 offen offset:0 sc1 lds
    s_waitcnt lgkmcnt(5)
    v_mfma_f32_32x32x16_bf16 v[16:31], v[72:75], a[60:63], v[16:31]
    ds_read_b64_tr_b16 v[56:57], v168 offset:16640
    ds_read_b64_tr_b16 v[58:59], v169 offset:16640
    ds_read_b128 v[84:87], v165 offset:16384
    v_mfma_f32_32x32x16_bf16 v[32:47], v[76:79], a[60:63], v[32:47]
    ds_read_b64_tr_b16 v[60:61], v168 offset:18688
    ds_read_b64_tr_b16 v[62:63], v169 offset:18688
    buffer_load_dwordx4 v3, s[28:31], s62 offen offset:1024 sc1 lds
    s_waitcnt lgkmcnt(5)
    v_mfma_f32_32x32x16_bf16 v[16:31], v[48:51], v[80:83], v[16:31]
    ds_read_b64_tr_b16 v[64:65], v168 offset:20480
    ds_read_b64_tr_b16 v[66:67], v169 offset:20480
    ds_read_b128 v[88:91], v166 offset:16384
    v_mfma_f32_32x32x16_bf16 v[32:47], v[52:55], v[80:83], v[32:47]
    ds_read_b64_tr_b16 v[68:69], v168 offset:22528
    ds_read_b64_tr_b16 v[70:71], v169 offset:22528
    s_add_u32 m0, s66, 12288
    s_movk_i32 s101, 2944
    buffer_load_dwordx4 v160, s[92:95], s101 offen offset:0 lds
    s_waitcnt lgkmcnt(5)
    v_mfma_f32_32x32x16_bf16 v[16:31], v[56:59], v[84:87], v[16:31]
    ds_read_b64_tr_b16 v[72:73], v168 offset:20736
    ds_read_b64_tr_b16 v[74:75], v169 offset:20736
    ds_read_b128 v[92:95], v167 offset:16384
    v_mfma_f32_32x32x16_bf16 v[32:47], v[60:63], v[84:87], v[32:47]
    ds_read_b64_tr_b16 v[76:77], v168 offset:22784
    ds_read_b64_tr_b16 v[78:79], v169 offset:22784
    buffer_load_dwordx4 v161, s[92:95], s101 offen offset:1024 lds
    s_waitcnt lgkmcnt(5)
    v_mfma_f32_32x32x16_bf16 v[16:31], v[64:67], v[88:91], v[16:31]
    s_waitcnt vmcnt(12)
    s_barrier
    ds_read_b64_tr_b16 v[48:49], v168 offset:24576
    ds_read_b64_tr_b16 v[50:51], v169 offset:24576
    v_mfma_f32_32x32x16_bf16 v[32:47], v[68:71], v[88:91], v[32:47]
    ds_read_b64_tr_b16 v[52:53], v168 offset:26624
    ds_read_b64_tr_b16 v[54:55], v169 offset:26624
    buffer_load_dwordx4 v162, s[92:95], s101 offen offset:2048 lds
    s_waitcnt lgkmcnt(4)
    v_mfma_f32_32x32x16_bf16 v[16:31], v[72:75], v[92:95], v[16:31]
    ds_read_b64_tr_b16 v[56:57], v168 offset:24832
    ds_read_b64_tr_b16 v[58:59], v169 offset:24832
    v_mfma_f32_32x32x16_bf16 v[32:47], v[76:79], v[92:95], v[32:47]
    ds_read_b64_tr_b16 v[60:61], v168 offset:26880
    ds_read_b64_tr_b16 v[62:63], v169 offset:26880
    buffer_load_dwordx4 v163, s[92:95], s101 offen offset:3072 lds
    s_waitcnt lgkmcnt(4)
    v_mfma_f32_32x32x16_bf16 v[16:31], v[48:51], a[64:67], v[16:31]
    ds_read_b64_tr_b16 v[64:65], v168 offset:28672
    ds_read_b64_tr_b16 v[66:67], v169 offset:28672
    v_mfma_f32_32x32x16_bf16 v[32:47], v[52:55], a[64:67], v[32:47]
    ds_read_b64_tr_b16 v[68:69], v168 offset:30720
    ds_read_b64_tr_b16 v[70:71], v169 offset:30720
    s_add_u32 m0, s63, 8192
    s_add_u32 s62, s64, 49152
    buffer_load_dwordx4 v3, s[28:31], s62 offen offset:0 sc1 lds
    s_waitcnt lgkmcnt(4)
    v_mfma_f32_32x32x16_bf16 v[16:31], v[56:59], a[68:71], v[16:31]
    ds_read_b64_tr_b16 v[72:73], v168 offset:28928
    ds_read_b64_tr_b16 v[74:75], v169 offset:28928
    v_mfma_f32_32x32x16_bf16 v[32:47], v[60:63], a[68:71], v[32:47]
    ds_read_b64_tr_b16 v[76:77], v168 offset:30976
    ds_read_b64_tr_b16 v[78:79], v169 offset:30976
    buffer_load_dwordx4 v3, s[28:31], s62 offen offset:1024 sc1 lds
    s_waitcnt lgkmcnt(4)
    v_mfma_f32_32x32x16_bf16 v[16:31], v[64:67], a[72:75], v[16:31]
    s_waitcnt vmcnt(14)
    s_barrier
    ds_read_b64_tr_b16 v[48:49], v168 offset:32768
    ds_read_b64_tr_b16 v[50:51], v169 offset:32768
    ds_read_b128 v[80:83], v164 offset:20480
    v_mfma_f32_32x32x16_bf16 v[32:47], v[68:71], a[72:75], v[32:47]
    ds_read_b64_tr_b16 v[52:53], v168 offset:34816
    ds_read_b64_tr_b16 v[54:55], v169 offset:34816
    s_add_u32 m0, s63, 16384
    s_add_u32 s62, s64, 172032
    buffer_load_dwordx4 v3, s[28:31], s62 offen offset:0 sc1 lds
    s_waitcnt lgkmcnt(5)
    v_mfma_f32_32x32x16_bf16 v[16:31], v[72:75], a[76:79], v[16:31]
    ds_read_b64_tr_b16 v[56:57], v168 offset:33024
    ds_read_b64_tr_b16 v[58:59], v169 offset:33024
    ds_read_b128 v[84:87], v165 offset:20480
    v_mfma_f32_32x32x16_bf16 v[32:47], v[76:79], a[76:79], v[32:47]
    ds_read_b64_tr_b16 v[60:61], v168 offset:35072
    ds_read_b64_tr_b16 v[62:63], v169 offset:35072
    buffer_load_dwordx4 v3, s[28:31], s62 offen offset:1024 sc1 lds
    s_waitcnt lgkmcnt(5)
    v_mfma_f32_32x32x16_bf16 v[16:31], v[48:51], v[80:83], v[16:31]
    ds_read_b64_tr_b16 v[64:65], v168 offset:36864
    ds_read_b64_tr_b16 v[66:67], v169 offset:36864
    ds_read_b128 v[88:91], v166 offset:20480
    v_mfma_f32_32x32x16_bf16 v[32:47], v[52:55], v[80:83], v[32:47]
    ds_read_b64_tr_b16 v[68:69], v168 offset:38912
    ds_read_b64_tr_b16 v[70:71], v169 offset:38912
    s_add_u32 m0, s66, 16384
    s_movk_i32 s101, 3072
    buffer_load_dwordx4 v160, s[92:95], s101 offen offset:0 lds
    s_waitcnt lgkmcnt(5)
    v_mfma_f32_32x32x16_bf16 v[16:31], v[56:59], v[84:87], v[16:31]
    ds_read_b64_tr_b16 v[72:73], v168 offset:37120
    ds_read_b64_tr_b16 v[74:75], v169 offset:37120
    ds_read_b128 v[92:95], v167 offset:20480
    v_mfma_f32_32x32x16_bf16 v[32:47], v[60:63], v[84:87], v[32:47]
    ds_read_b64_tr_b16 v[76:77], v168 offset:39168
    ds_read_b64_tr_b16 v[78:79], v169 offset:39168
    buffer_load_dwordx4 v161, s[92:95], s101 offen offset:1024 lds
    s_waitcnt lgkmcnt(5)
    v_mfma_f32_32x32x16_bf16 v[16:31], v[64:67], v[88:91], v[16:31]
    s_waitcnt vmcnt(12)
    s_barrier
    ds_read_b64_tr_b16 v[48:49], v168 offset:40960
    ds_read_b64_tr_b16 v[50:51], v169 offset:40960
    v_mfma_f32_32x32x16_bf16 v[32:47], v[68:71], v[88:91], v[32:47]
    ds_read_b64_tr_b16 v[52:53], v168 offset:43008
    ds_read_b64_tr_b16 v[54:55], v169 offset:43008
    buffer_load_dwordx4 v162, s[92:95], s101 offen offset:2048 lds
    s_waitcnt lgkmcnt(4)
    v_mfma_f32_32x32x16_bf16 v[16:31], v[72:75], v[92:95], v[16:31]
    ds_read_b64_tr_b16 v[56:57], v168 offset:41216
    ds_read_b64_tr_b16 v[58:59], v169 offset:41216
    v_mfma_f32_32x32x16_bf16 v[32:47], v[76:79], v[92:95], v[32:47]
    ds_read_b64_tr_b16 v[60:61], v168 offset:43264
    ds_read_b64_tr_b16 v[62:63], v169 offset:43264
    buffer_load_dwordx4 v163, s[92:95], s101 offen offset:3072 lds
    s_waitcnt lgkmcnt(4)
    v_mfma_f32_32x32x16_bf16 v[16:31], v[48:51], a[80:83], v[16:31]
    ds_read_b64_tr_b16 v[64:65], v168 offset:45056
    ds_read_b64_tr_b16 v[66:67], v169 offset:45056
    v_mfma_f32_32x32x16_bf16 v[32:47], v[52:55], a[80:83], v[32:47]
    ds_read_b64_tr_b16 v[68:69], v168 offset:47104
    ds_read_b64_tr_b16 v[70:71], v169 offset:47104
    s_add_u32 m0, s63, 24576
    s_add_u32 s62, s64, 57344
    buffer_load_dwordx4 v3, s[28:31], s62 offen offset:0 sc1 lds
    s_waitcnt lgkmcnt(4)
    v_mfma_f32_32x32x16_bf16 v[16:31], v[56:59], a[84:87], v[16:31]
    ds_read_b64_tr_b16 v[72:73], v168 offset:45312
    ds_read_b64_tr_b16 v[74:75], v169 offset:45312
    v_mfma_f32_32x32x16_bf16 v[32:47], v[60:63], a[84:87], v[32:47]
    ds_read_b64_tr_b16 v[76:77], v168 offset:47360
    ds_read_b64_tr_b16 v[78:79], v169 offset:47360
    buffer_load_dwordx4 v3, s[28:31], s62 offen offset:1024 sc1 lds
    s_waitcnt lgkmcnt(4)
    v_mfma_f32_32x32x16_bf16 v[16:31], v[64:67], a[88:91], v[16:31]
    s_waitcnt vmcnt(14)
    s_barrier
    ds_read_b64_tr_b16 v[48:49], v168 offset:0
    ds_read_b64_tr_b16 v[50:51], v169 offset:0
    ds_read_b128 v[80:83], v164 offset:0
    v_mfma_f32_32x32x16_bf16 v[32:47], v[68:71], a[88:91], v[32:47]
    ds_read_b64_tr_b16 v[52:53], v168 offset:2048
    ds_read_b64_tr_b16 v[54:55], v169 offset:2048
    s_add_u32 m0, s63, 32768
    s_add_u32 s62, s64, 180224
    buffer_load_dwordx4 v3, s[28:31], s62 offen offset:0 sc1 lds
    s_waitcnt lgkmcnt(5)
    v_mfma_f32_32x32x16_bf16 v[16:31], v[72:75], a[92:95], v[16:31]
    ds_read_b64_tr_b16 v[56:57], v168 offset:256
    ds_read_b64_tr_b16 v[58:59], v169 offset:256
    ds_read_b128 v[84:87], v165 offset:0
    v_mfma_f32_32x32x16_bf16 v[32:47], v[76:79], a[92:95], v[32:47]
    ds_read_b64_tr_b16 v[60:61], v168 offset:2304
    ds_read_b64_tr_b16 v[62:63], v169 offset:2304
    buffer_load_dwordx4 v3, s[28:31], s62 offen offset:1024 sc1 lds
    s_waitcnt lgkmcnt(5)
    v_mfma_f32_32x32x16_bf16 v[16:31], v[48:51], v[80:83], v[16:31]
    ds_read_b64_tr_b16 v[64:65], v168 offset:4096
    ds_read_b64_tr_b16 v[66:67], v169 offset:4096
    ds_read_b128 v[88:91], v166 offset:0
    v_mfma_f32_32x32x16_bf16 v[32:47], v[52:55], v[80:83], v[32:47]
    ds_read_b64_tr_b16 v[68:69], v168 offset:6144
    ds_read_b64_tr_b16 v[70:71], v169 offset:6144
    s_add_u32 m0, s66, 20480
    s_movk_i32 s101, 3200
    buffer_load_dwordx4 v160, s[92:95], s101 offen offset:0 lds
    s_waitcnt lgkmcnt(5)
    v_mfma_f32_32x32x16_bf16 v[16:31], v[56:59], v[84:87], v[16:31]
    ds_read_b64_tr_b16 v[72:73], v168 offset:4352
    ds_read_b64_tr_b16 v[74:75], v169 offset:4352
    s_branch L_pg10
    .p2align 12
L_stub10:
    s_setpc_b64 s[70:71]
L_pg10:
    ds_read_b128 v[92:95], v167 offset:0
    v_mfma_f32_32x32x16_bf16 v[32:47], v[60:63], v[84:87], v[32:47]
    ds_read_b64_tr_b16 v[76:77], v168 offset:6400
    ds_read_b64_tr_b16 v[78:79], v169 offset:6400
    buffer_load_dwordx4 v161, s[92:95], s101 offen offset:1024 lds
    s_waitcnt lgkmcnt(5)
    v_mfma_f32_32x32x16_bf16 v[16:31], v[64:67], v[88:91], v[16:31]
    s_waitcnt vmcnt(12)
    s_barrier
    ds_read_b64_tr_b16 v[48:49], v168 offset:8192
    ds_read_b64_tr_b16 v[50:51], v169 offset:8192
    v_mfma_f32_32x32x16_bf16 v[32:47], v[68:71], v[88:91], v[32:47]
    ds_read_b64_tr_b16 v[52:53], v168 offset:10240
    ds_read_b64_tr_b16 v[54:55], v169 offset:10240
    buffer_load_dwordx4 v162, s[92:95], s101 offen offset:2048 lds
    s_waitcnt lgkmcnt(4)
    v_mfma_f32_32x32x16_bf16 v[16:31], v[72:75], v[92:95], v[16:31]
    ds_read_b64_tr_b16 v[56:57], v168 offset:8448
    ds_read_b64_tr_b16 v[58:59], v169 offset:8448
    v_mfma_f32_32x32x16_bf16 v[32:47], v[76:79], v[92:95], v[32:47]
    ds_read_b64_tr_b16 v[60:61], v168 offset:10496
    ds_read_b64_tr_b16 v[62:63], v169 offset:10496
    buffer_load_dwordx4 v163, s[92:95], s101 offen offset:3072 lds
    s_waitcnt lgkmcnt(4)
    v_mfma_f32_32x32x16_bf16 v[16:31], v[48:51], a[96:99], v[16:31]
    ds_read_b64_tr_b16 v[64:65], v168 offset:12288
    ds_read_b64_tr_b16 v[66:67], v169 offset:12288
    v_mfma_f32_32x32x16_bf16 v[32:47], v[52:55], a[96:99], v[32:47]
    ds_read_b64_tr_b16 v[68:69], v168 offset:14336
    ds_read_b64_tr_b16 v[70:71], v169 offset:14336
    s_add_u32 m0, s63, 40960
    s_add_u32 s62, s64, 65536
    buffer_load_dwordx4 v3, s[28:31], s62 offen offset:0 sc1 lds
    s_waitcnt lgkmcnt(4)
    v_mfma_f32_32x32x16_bf16 v[16:31], v[56:59], a[100:103], v[16:31]
    ds_read_b64_tr_b16 v[72:73], v168 offset:12544
    ds_read_b64_tr_b16 v[74:75], v169 offset:12544
    v_mfma_f32_32x32x16_bf16 v[32:47], v[60:63], a[100:103], v[32:47]
    ds_read_b64_tr_b16 v[76:77], v168 offset:14592
    ds_read_b64_tr_b16 v[78:79], v169 offset:14592
    buffer_load_dwordx4 v3, s[28:31], s62 offen offset:1024 sc1 lds
    s_waitcnt lgkmcnt(4)
    v_mfma_f32_32x32x16_bf16 v[16:31], v[64:67], a[104:107], v[16:31]
    s_waitcnt vmcnt(14)
    s_barrier
    ds_read_b64_tr_b16 v[48:49], v168 offset:16384
    ds_read_b64_tr_b16 v[50:51], v169 offset:16384
    ds_read_b128 v[80:83], v164 offset:4096
    v_mfma_f32_32x32x16_bf16 v[32:47], v[68:71], a[104:107], v[32:47]
    ds_read_b64_tr_b16 v[52:53], v168 offset:18432
    ds_read_b64_tr_b16 v[54:55], v169 offset:18432
    s_add_u32 m0, s63, 0
    s_add_u32 s62, s64, 188416
    buffer_load_dwordx4 v3, s[28:31], s62 offen offset:0 sc1 lds
    s_waitcnt lgkmcnt(5)
    v_mfma_f32_32x32x16_bf16 v[16:31], v[72:75], a[108:111], v[16:31]
    ds_read_b64_tr_b16 v[56:57], v168 offset:16640
    ds_read_b64_tr_b16 v[58:59], v169 offset:16640
    ds_read_b128 v[84:87], v165 offset:4096
    v_mfma_f32_32x32x16_bf16 v[32:47], v[76:79], a[108:111], v[32:47]
    ds_read_b64_tr_b16 v[60:61], v168 offset:18688
    ds_read_b64_tr_b16 v[62:63], v169 offset:18688
    buffer_load_dwordx4 v3, s[28:31], s62 offen offset:1024 sc1 lds
    s_waitcnt lgkmcnt(5)
    v_mfma_f32_32x32x16_bf16 v[16:31], v[48:51], v[80:83], v[16:31]
    ds_read_b64_tr_b16 v[64:65], v168 offset:20480
    ds_read_b64_tr_b16 v[66:67], v169 offset:20480
    ds_read_b128 v[88:91], v166 offset:4096
    v_mfma_f32_32x32x16_bf16 v[32:47], v[52:55], v[80:83], v[32:47]
    ds_read_b64_tr_b16 v[68:69], v168 offset:22528
    ds_read_b64_tr_b16 v[70:71], v169 offset:22528
    s_add_u32 m0, s66, 0
    s_movk_i32 s101, 3328
    buffer_load_dwordx4 v160, s[92:95], s101 offen offset:0 lds
    s_waitcnt lgkmcnt(5)
    v_mfma_f32_32x32x16_bf16 v[16:31], v[56:59], v[84:87], v[16:31]
    ds_read_b64_tr_b16 v[72:73], v168 offset:20736
    ds_read_b64_tr_b16 v[74:75], v169 offset:20736
    ds_read_b128 v[92:95], v167 offset:4096
    v_mfma_f32_32x32x16_bf16 v[32:47], v[60:63], v[84:87], v[32:47]
    ds_read_b64_tr_b16 v[76:77], v168 offset:22784
    ds_read_b64_tr_b16 v[78:79], v169 offset:22784
    buffer_load_dwordx4 v161, s[92:95], s101 offen offset:1024 lds
    s_waitcnt lgkmcnt(5)
    v_mfma_f32_32x32x16_bf16 v[16:31], v[64:67], v[88:91], v[16:31]
    s_waitcnt vmcnt(12)
    s_barrier
    ds_read_b64_tr_b16 v[48:49], v168 offset:24576
    ds_read_b64_tr_b16 v[50:51], v169 offset:24576
    v_mfma_f32_32x32x16_bf16 v[32:47], v[68:71], v[88:91], v[32:47]
    ds_read_b64_tr_b16 v[52:53], v168 offset:26624
    ds_read_b64_tr_b16 v[54:55], v169 offset:26624
    buffer_load_dwordx4 v162, s[92:95], s101 offen offset:2048 lds
    s_waitcnt lgkmcnt(4)
    v_mfma_f32_32x32x16_bf16 v[16:31], v[72:75], v[92:95], v[16:31]
    ds_read_b64_tr_b16 v[56:57], v168 offset:24832
    ds_read_b64_tr_b16 v[58:59], v169 offset:24832
    v_mfma_f32_32x32x16_bf16 v[32:47], v[76:79], v[92:95], v[32:47]
    ds_read_b64_tr_b16 v[60:61], v168 offset:26880
    ds_read_b64_tr_b16 v[62:63], v169 offset:26880
    buffer_load_dwordx4 v163, s[92:95], s101 offen offset:3072 lds
    s_waitcnt lgkmcnt(4)
    v_mfma_f32_32x32x16_bf16 v[16:31], v[48:51], a[112:115], v[16:31]
    ds_read_b64_tr_b16 v[64:65], v168 offset:28672
    ds_read_b64_tr_b16 v[66:67], v169 offset:28672
    v_mfma_f32_32x32x16_bf16 v[32:47], v[52:55], a[112:115], v[32:47]
    ds_read_b64_tr_b16 v[68:69], v168 offset:30720
    ds_read_b64_tr_b16 v[70:71], v169 offset:30720
    s_add_u32 m0, s63, 8192
    s_add_u32 s62, s64, 73728
    buffer_load_dwordx4 v3, s[28:31], s62 offen offset:0 sc1 lds
    s_waitcnt lgkmcnt(4)
    v_mfma_f32_32x32x16_bf16 v[16:31], v[56:59], a[116:119], v[16:31]
    ds_read_b64_tr_b16 v[72:73], v168 offset:28928
    ds_read_b64_tr_b16 v[74:75], v169 offset:28928
    v_mfma_f32_32x32x16_bf16 v[32:47], v[60:63], a[116:119], v[32:47]
    ds_read_b64_tr_b16 v[76:77], v168 offset:30976
    ds_read_b64_tr_b16 v[78:79], v169 offset:30976
    buffer_load_dwordx4 v3, s[28:31], s62 offen offset:1024 sc1 lds
    s_waitcnt lgkmcnt(4)
    v_mfma_f32_32x32x16_bf16 v[16:31], v[64:67], a[120:123], v[16:31]
    s_waitcnt vmcnt(14)
    s_barrier
    ds_read_b64_tr_b16 v[48:49], v168 offset:32768
    ds_read_b64_tr_b16 v[50:51], v169 offset:32768
    ds_read_b128 v[80:83], v164 offset:8192
    v_mfma_f32_32x32x16_bf16 v[32:47], v[68:71], a[120:123], v[32:47]
    ds_read_b64_tr_b16 v[52:53], v168 offset:34816
    ds_read_b64_tr_b16 v[54:55], v169 offset:34816
    s_add_u32 m0, s63, 16384
    s_add_u32 s62, s64, 196608
    buffer_load_dwordx4 v3, s[28:31], s62 offen offset:0 sc1 lds
    s_waitcnt lgkmcnt(5)
    v_mfma_f32_32x32x16_bf16 v[16:31], v[72:75], a[124:127], v[16:31]
    ds_read_b64_tr_b16 v[56:57], v168 offset:33024
    ds_read_b64_tr_b16 v[58:59], v169 offset:33024
    ds_read_b128 v[84:87], v165 offset:8192
    v_mfma_f32_32x32x16_bf16 v[32:47], v[76:79], a[124:127], v[32:47]
    ds_read_b64_tr_b16 v[60:61], v168 offset:35072
    ds_read_b64_tr_b16 v[62:63], v169 offset:35072
    buffer_load_dwordx4 v3, s[28:31], s62 offen offset:1024 sc1 lds
    s_waitcnt lgkmcnt(5)
    v_mfma_f32_32x32x16_bf16 v[16:31], v[48:51], v[80:83], v[16:31]
    ds_read_b64_tr_b16 v[64:65], v168 offset:36864
    ds_read_b64_tr_b16 v[66:67], v169 offset:36864
    ds_read_b128 v[88:91], v166 offset:8192
    v_mfma_f32_32x32x16_bf16 v[32:47], v[52:55], v[80:83], v[32:47]
    ds_read_b64_tr_b16 v[68:69], v168 offset:38912
    ds_read_b64_tr_b16 v[70:71], v169 offset:38912
    s_add_u32 m0, s66, 4096
    s_movk_i32 s101, 3456
    buffer_load_dwordx4 v160, s[92:95], s101 offen offset:0 lds
    s_waitcnt lgkmcnt(5)
    v_mfma_f32_32x32x16_bf16 v[16:31], v[56:59], v[84:87], v[16:31]
    ds_read_b64_tr_b16 v[72:73], v168 offset:37120
    ds_read_b64_tr_b16 v[74:75], v169 offset:37120
    ds_read_b128 v[92:95], v167 offset:8192
    v_mfma_f32_32x32x16_bf16 v[32:47], v[60:63], v[84:87], v[32:47]
    ds_read_b64_tr_b16 v[76:77], v168 offset:39168
    ds_read_b64_tr_b16 v[78:79], v169 offset:39168
    buffer_load_dwordx4 v161, s[92:95], s101 offen offset:1024 lds
    s_waitcnt lgkmcnt(5)
    v_mfma_f32_32x32x16_bf16 v[16:31], v[64:67], v[88:91], v[16:31]
    s_waitcnt vmcnt(12)
    s_barrier
    ds_read_b64_tr_b16 v[48:49], v168 offset:40960
    ds_read_b64_tr_b16 v[50:51], v169 offset:40960
    v_mfma_f32_32x32x16_bf16 v[32:47], v[68:71], v[88:91], v[32:47]
    ds_read_b64_tr_b16 v[52:53], v168 offset:43008
    ds_read_b64_tr_b16 v[54:55], v169 offset:43008
    buffer_load_dwordx4 v162, s[92:95], s101 offen offset:2048 lds
    s_waitcnt lgkmcnt(4)
    v_mfma_f32_32x32x16_bf16 v[16:31], v[72:75], v[92:95], v[16:31]
    ds_read_b64_tr_b16 v[56:57], v168 offset:41216
    ds_read_b64_tr_b16 v[58:59], v169 offset:41216
    v_mfma_f32_32x32x16_bf16 v[32:47], v[76:79], v[92:95], v[32:47]
    ds_read_b64_tr_b16 v[60:61], v168 offset:43264
    ds_read_b64_tr_b16 v[62:63], v169 offset:43264
    buffer_load_dwordx4 v163, s[92:95], s101 offen offset:3072 lds
    s_waitcnt lgkmcnt(4)
    v_mfma_f32_32x32x16_bf16 v[16:31], v[48:51], a[128:131], v[16:31]
    ds_read_b64_tr_b16 v[64:65], v168 offset:45056
    ds_read_b64_tr_b16 v[66:67], v169 offset:45056
    v_mfma_f32_32x32x16_bf16 v[32:47], v[52:55], a[128:131], v[32:47]
    ds_read_b64_tr_b16 v[68:69], v168 offset:47104
    ds_read_b64_tr_b16 v[70:71], v169 offset:47104
    s_add_u32 m0, s63, 24576
    s_add_u32 s62, s64, 81920
    buffer_load_dwordx4 v3, s[28:31], s62 offen offset:0 sc1 lds
    s_waitcnt lgkmcnt(4)
    v_mfma_f32_32x32x16_bf16 v[16:31], v[56:59], a[132:135], v[16:31]
    ds_read_b64_tr_b16 v[72:73], v168 offset:45312
    ds_read_b64_tr_b16 v[74:75], v169 offset:45312
    v_mfma_f32_32x32x16_bf16 v[32:47], v[60:63], a[132:135], v[32:47]
    ds_read_b64_tr_b16 v[76:77], v168 offset:47360
    ds_read_b64_tr_b16 v[78:79], v169 offset:47360
    buffer_load_dwordx4 v3, s[28:31], s62 offen offset:1024 sc1 lds
    s_waitcnt lgkmcnt(4)
    v_mfma_f32_32x32x16_bf16 v[16:31], v[64:67], a[136:139], v[16:31]
    s_waitcnt vmcnt(14)
    s_barrier
    ds_read_b64_tr_b16 v[48:49], v168 offset:0
    ds_read_b64_tr_b16 v[50:51], v169 offset:0
    ds_read_b128 v[80:83], v164 offset:12288
    v_mfma_f32_32x32x16_bf16 v[32:47], v[68:71], a[136:139], v[32:47]
    ds_read_b64_tr_b16 v[52:53], v168 offset:2048
    ds_read_b64_tr_b16 v[54:55], v169 offset:2048
    s_add_u32 m0, s63, 32768
    s_add_u32 s62, s64, 204800
    buffer_load_dwordx4 v3, s[28:31], s62 offen offset:0 sc1 lds
    s_waitcnt lgkmcnt(5)
    v_mfma_f32_32x32x16_bf16 v[16:31], v[72:75], a[140:143], v[16:31]
    ds_read_b64_tr_b16 v[56:57], v168 offset:256
    ds_read_b64_tr_b16 v[58:59], v169 offset:256
    ds_read_b128 v[84:87], v165 offset:12288
    v_mfma_f32_32x32x16_bf16 v[32:47], v[76:79], a[140:143], v[32:47]
    ds_read_b64_tr_b16 v[60:61], v168 offset:2304
    ds_read_b64_tr_b16 v[62:63], v169 offset:2304
    buffer_load_dwordx4 v3, s[28:31], s62 offen offset:1024 sc1 lds
    s_waitcnt lgkmcnt(5)
    v_mfma_f32_32x32x16_bf16 v[16:31], v[48:51], v[80:83], v[16:31]
    ds_read_b64_tr_b16 v[64:65], v168 offset:4096
    ds_read_b64_tr_b16 v[66:67], v169 offset:4096
    ds_read_b128 v[88:91], v166 offset:12288
    v_mfma_f32_32x32x16_bf16 v[32:47], v[52:55], v[80:83], v[32:47]
    ds_read_b64_tr_b16 v[68:69], v168 offset:6144
    ds_read_b64_tr_b16 v[70:71], v169 offset:6144
    s_add_u32 m0, s66, 8192
    s_movk_i32 s101, 3584
    buffer_load_dwordx4 v160, s[92:95], s101 offen offset:0 lds
    s_waitcnt lgkmcnt(5)
    v_mfma_f32_32x32x16_bf16 v[16:31], v[56:59], v[84:87], v[16:31]
    ds_read_b64_tr_b16 v[72:73], v168 offset:4352
    ds_read_b64_tr_b16 v[74:75], v169 offset:4352
    ds_read_b128 v[92:95], v167 offset:12288
    v_mfma_f32_32x32x16_bf16 v[32:47], v[60:63], v[84:87], v[32:47]
    ds_read_b64_tr_b16 v[76:77], v168 offset:6400
    ds_read_b64_tr_b16 v[78:79], v169 offset:6400
    buffer_load_dwordx4 v161, s[92:95], s101 offen offset:1024 lds
    s_waitcnt lgkmcnt(5)
    v_mfma_f32_32x32x16_bf16 v[16:31], v[64:67], v[88:91], v[16:31]
    s_waitcnt vmcnt(12)
    s_barrier
    ds_read_b64_tr_b16 v[48:49], v168 offset:8192
    ds_read_b64_tr_b16 v[50:51], v169 offset:8192
    v_mfma_f32_32x32x16_bf16 v[32:47], v[68:71], v[88:91], v[32:47]
    ds_read_b64_tr_b16 v[52:53], v168 offset:10240
    ds_read_b64_tr_b16 v[54:55], v169 offset:10240
    buffer_load_dwordx4 v162, s[92:95], s101 offen offset:2048 lds
    s_waitcnt lgkmcnt(4)
    v_mfma_f32_32x32x16_bf16 v[16:31], v[72:75], v[92:95], v[16:31]
    ds_read_b64_tr_b16 v[56:57], v168 offset:8448
    ds_read_b64_tr_b16 v[58:59], v169 offset:8448
    v_mfma_f32_32x32x16_bf16 v[32:47], v[76:79], v[92:95], v[32:47]
    ds_read_b64_tr_b16 v[60:61], v168 offset:10496
    ds_read_b64_tr_b16 v[62:63], v169 offset:10496
    buffer_load_dwordx4 v163, s[92:95], s101 offen offset:3072 lds
    s_waitcnt lgkmcnt(4)
    v_mfma_f32_32x32x16_bf16 v[16:31], v[48:51], a[144:147], v[16:31]
    ds_read_b64_tr_b16 v[64:65], v168 offset:12288
    ds_read_b64_tr_b16 v[66:67], v169 offset:12288
    v_mfma_f32_32x32x16_bf16 v[32:47], v[52:55], a[144:147], v[32:47]
    ds_read_b64_tr_b16 v[68:69], v168 offset:14336
    ds_read_b64_tr_b16 v[70:71], v169 offset:14336
    s_add_u32 m0, s63, 40960
    s_add_u32 s62, s64, 90112
    buffer_load_dwordx4 v3, s[28:31], s62 offen offset:0 sc1 lds
    s_waitcnt lgkmcnt(4)
    v_mfma_f32_32x32x16_bf16 v[16:31], v[56:59], a[148:151], v[16:31]
    ds_read_b64_tr_b16 v[72:73], v168 offset:12544
    ds_read_b64_tr_b16 v[74:75], v169 offset:12544
    v_mfma_f32_32x32x16_bf16 v[32:47], v[60:63], a[148:151], v[32:47]
    ds_read_b64_tr_b16 v[76:77], v168 offset:14592
    ds_read_b64_tr_b16 v[78:79], v169 offset:14592
    buffer_load_dwordx4 v3, s[28:31], s62 offen offset:1024 sc1 lds
    s_waitcnt lgkmcnt(4)
    v_mfma_f32_32x32x16_bf16 v[16:31], v[64:67], a[152:155], v[16:31]
    s_waitcnt vmcnt(14)
    s_barrier
    ds_read_b64_tr_b16 v[48:49], v168 offset:16384
    ds_read_b64_tr_b16 v[50:51], v169 offset:16384
    ds_read_b128 v[80:83], v164 offset:16384
    v_mfma_f32_32x32x16_bf16 v[32:47], v[68:71], a[152:155], v[32:47]
    ds_read_b64_tr_b16 v[52:53], v168 offset:18432
    ds_read_b64_tr_b16 v[54:55], v169 offset:18432
    s_add_u32 m0, s63, 0
    s_add_u32 s62, s64, 212992
    buffer_load_dwordx4 v3, s[28:31], s62 offen offset:0 sc1 lds
    s_waitcnt lgkmcnt(5)
    v_mfma_f32_32x32x16_bf16 v[16:31], v[72:75], a[156:159], v[16:31]
    ds_read_b64_tr_b16 v[56:57], v168 offset:16640
    ds_read_b64_tr_b16 v[58:59], v169 offset:16640
    ds_read_b128 v[84:87], v165 offset:16384
    v_mfma_f32_32x32x16_bf16 v[32:47], v[76:79], a[156:159], v[32:47]
    ds_read_b64_tr_b16 v[60:61], v168 offset:18688
    ds_read_b64_tr_b16 v[62:63], v169 offset:18688
    buffer_load_dwordx4 v3, s[28:31], s62 offen offset:1024 sc1 lds
    s_waitcnt lgkmcnt(5)
    v_mfma_f32_32x32x16_bf16 v[16:31], v[48:51], v[80:83], v[16:31]
    ds_read_b64_tr_b16 v[64:65], v168 offset:20480
    ds_read_b64_tr_b16 v[66:67], v169 offset:20480
    ds_read_b128 v[88:91], v166 offset:16384
    v_mfma_f32_32x32x16_bf16 v[32:47], v[52:55], v[80:83], v[32:47]
    ds_read_b64_tr_b16 v[68:69], v168 offset:22528
    ds_read_b64_tr_b16 v[70:71], v169 offset:22528
    s_add_u32 m0, s66, 12288
    s_movk_i32 s101, 3712
    buffer_load_dwordx4 v160, s[92:95], s101 offen offset:0 lds
    s_waitcnt lgkmcnt(5)
    v_mfma_f32_32x32x16_bf16 v[16:31], v[56:59], v[84:87], v[16:31]
    ds_read_b64_tr_b16 v[72:73], v168 offset:20736
    ds_read_b64_tr_b16 v[74:75], v169 offset:20736
    ds_read_b128 v[92:95], v167 offset:16384
    v_mfma_f32_32x32x16_bf16 v[32:47], v[60:63], v[84:87], v[32:47]
    ds_read_b64_tr_b16 v[76:77], v168 offset:22784
    ds_read_b64_tr_b16 v[78:79], v169 offset:22784
    buffer_load_dwordx4 v161, s[92:95], s101 offen offset:1024 lds
    s_waitcnt lgkmcnt(5)
    v_mfma_f32_32x32x16_bf16 v[16:31], v[64:67], v[88:91], v[16:31]
    s_waitcnt vmcnt(12)
    s_barrier
    ds_read_b64_tr_b16 v[48:49], v168 offset:24576
    ds_read_b64_tr_b16 v[50:51], v169 offset:24576
    v_mfma_f32_32x32x16_bf16 v[32:47], v[68:71], v[88:91], v[32:47]
    ds_read_b64_tr_b16 v[52:53], v168 offset:26624
    ds_read_b64_tr_b16 v[54:55], v169 offset:26624
    buffer_load_dwordx4 v162, s[92:95], s101 offen offset:2048 lds
    s_waitcnt lgkmcnt(4)
    v_mfma_f32_32x32x16_bf16 v[16:31], v[72:75], v[92:95], v[16:31]
    ds_read_b64_tr_b16 v[56:57], v168 offset:24832
    ds_read_b64_tr_b16 v[58:59], v169 offset:24832
    v_mfma_f32_32x32x16_bf16 v[32:47], v[76:79], v[92:95], v[32:47]
    ds_read_b64_tr_b16 v[60:61], v168 offset:26880
    ds_read_b64_tr_b16 v[62:63], v169 offset:26880
    buffer_load_dwordx4 v163, s[92:95], s101 offen offset:3072 lds
    s_waitcnt lgkmcnt(4)
    v_mfma_f32_32x32x16_bf16 v[16:31], v[48:51], a[160:163], v[16:31]
    ds_read_b64_tr_b16 v[64:65], v168 offset:28672
    ds_read_b64_tr_b16 v[66:67], v169 offset:28672
    v_mfma_f32_32x32x16_bf16 v[32:47], v[52:55], a[160:163], v[32:47]
    ds_read_b64_tr_b16 v[68:69], v168 offset:30720
    ds_read_b64_tr_b16 v[70:71], v169 offset:30720
    s_add_u32 m0, s63, 8192
    s_add_u32 s62, s64, 98304
    buffer_load_dwordx4 v3, s[28:31], s62 offen offset:0 sc1 lds
    s_waitcnt lgkmcnt(4)
    v_mfma_f32_32x32x16_bf16 v[16:31], v[56:59], a[164:167], v[16:31]
    ds_read_b64_tr_b16 v[72:73], v168 offset:28928
    ds_read_b64_tr_b16 v[74:75], v169 offset:28928
    v_mfma_f32_32x32x16_bf16 v[32:47], v[60:63], a[164:167], v[32:47]
    ds_read_b64_tr_b16 v[76:77], v168 offset:30976
    ds_read_b64_tr_b16 v[78:79], v169 offset:30976
    buffer_load_dwordx4 v3, s[28:31], s62 offen offset:1024 sc1 lds
    s_waitcnt lgkmcnt(4)
    v_mfma_f32_32x32x16_bf16 v[16:31], v[64:67], a[168:171], v[16:31]
    s_waitcnt vmcnt(14)
    s_barrier
    ds_read_b64_tr_b16 v[48:49], v168 offset:32768
    ds_read_b64_tr_b16 v[50:51], v169 offset:32768
    ds_read_b128 v[80:83], v164 offset:20480
    v_mfma_f32_32x32x16_bf16 v[32:47], v[68:71], a[168:171], v[32:47]
    ds_read_b64_tr_b16 v[52:53], v168 offset:34816
    ds_read_b64_tr_b16 v[54:55], v169 offset:34816
    s_add_u32 m0, s63, 16384
    s_add_u32 s62, s64, 221184
    buffer_load_dwordx4 v3, s[28:31], s62 offen offset:0 sc1 lds
    s_waitcnt lgkmcnt(5)
    v_mfma_f32_32x32x16_bf16 v[16:31], v[72:75], a[172:175], v[16:31]
    ds_read_b64_tr_b16 v[56:57], v168 offset:33024
    ds_read_b64_tr_b16 v[58:59], v169 offset:33024
    ds_read_b128 v[84:87], v165 offset:20480
    v_mfma_f32_32x32x16_bf16 v[32:47], v[76:79], a[172:175], v[32:47]
    ds_read_b64_tr_b16 v[60:61], v168 offset:35072
    ds_read_b64_tr_b16 v[62:63], v169 offset:35072
    buffer_load_dwordx4 v3, s[28:31], s62 offen offset:1024 sc1 lds
    s_waitcnt lgkmcnt(5)
    v_mfma_f32_32x32x16_bf16 v[16:31], v[48:51], v[80:83], v[16:31]
    ds_read_b64_tr_b16 v[64:65], v168 offset:36864
    ds_read_b64_tr_b16 v[66:67], v169 offset:36864
    ds_read_b128 v[88:91], v166 offset:20480
    v_mfma_f32_32x32x16_bf16 v[32:47], v[52:55], v[80:83], v[32:47]
    ds_read_b64_tr_b16 v[68:69], v168 offset:38912
    ds_read_b64_tr_b16 v[70:71], v169 offset:38912
    s_add_u32 m0, s66, 16384
    s_movk_i32 s101, 3840
    buffer_load_dwordx4 v160, s[92:95], s101 offen offset:0 lds
    s_waitcnt lgkmcnt(5)
    v_mfma_f32_32x32x16_bf16 v[16:31], v[56:59], v[84:87], v[16:31]
    ds_read_b64_tr_b16 v[72:73], v168 offset:37120
    ds_read_b64_tr_b16 v[74:75], v169 offset:37120
    ds_read_b128 v[92:95], v167 offset:20480
    v_mfma_f32_32x32x16_bf16 v[32:47], v[60:63], v[84:87], v[32:47]
    ds_read_b64_tr_b16 v[76:77], v168 offset:39168
    ds_read_b64_tr_b16 v[78:79], v169 offset:39168
    buffer_load_dwordx4 v161, s[92:95], s101 offen offset:1024 lds
    s_waitcnt lgkmcnt(5)
    v_mfma_f32_32x32x16_bf16 v[16:31], v[64:67], v[88:91], v[16:31]
    s_waitcnt vmcnt(12)
    s_barrier
    ds_read_b64_tr_b16 v[48:49], v168 offset:40960
    ds_read_b64_tr_b16 v[50:51], v169 offset:40960
    v_mfma_f32_32x32x16_bf16 v[32:47], v[68:71], v[88:91], v[32:47]
    ds_read_b64_tr_b16 v[52:53], v168 offset:43008
    ds_read_b64_tr_b16 v[54:55], v169 offset:43008
    buffer_load_dwordx4 v162, s[92:95], s101 offen offset:2048 lds
    s_waitcnt lgkmcnt(4)
    v_mfma_f32_32x32x16_bf16 v[16:31], v[72:75], v[92:95], v[16:31]
    ds_read_b64_tr_b16 v[56:57], v168 offset:41216
    ds_read_b64_tr_b16 v[58:59], v169 offset:41216
    v_mfma_f32_32x32x16_bf16 v[32:47], v[76:79], v[92:95], v[32:47]
    ds_read_b64_tr_b16 v[60:61], v168 offset:43264
    ds_read_b64_tr_b16 v[62:63], v169 offset:43264
    buffer_load_dwordx4 v163, s[92:95], s101 offen offset:3072 lds
    s_waitcnt lgkmcnt(4)
    v_mfma_f32_32x32x16_bf16 v[16:31], v[48:51], a[176:179], v[16:31]
    ds_read_b64_tr_b16 v[64:65], v168 offset:45056
    ds_read_b64_tr_b16 v[66:67], v169 offset:45056
    v_mfma_f32_32x32x16_bf16 v[32:47], v[52:55], a[176:179], v[32:47]
    ds_read_b64_tr_b16 v[68:69], v168 offset:47104
    ds_read_b64_tr_b16 v[70:71], v169 offset:47104
    s_add_u32 m0, s63, 24576
    s_add_u32 s62, s64, 106496
    buffer_load_dwordx4 v3, s[28:31], s62 offen offset:0 sc1 lds
    s_waitcnt lgkmcnt(4)
    v_mfma_f32_32x32x16_bf16 v[16:31], v[56:59], a[180:183], v[16:31]
    ds_read_b64_tr_b16 v[72:73], v168 offset:45312
    ds_read_b64_tr_b16 v[74:75], v169 offset:45312
    v_mfma_f32_32x32x16_bf16 v[32:47], v[60:63], a[180:183], v[32:47]
    ds_read_b64_tr_b16 v[76:77], v168 offset:47360
    ds_read_b64_tr_b16 v[78:79], v169 offset:47360
    buffer_load_dwordx4 v3, s[28:31], s62 offen offset:1024 sc1 lds
    s_waitcnt lgkmcnt(4)
    v_mfma_f32_32x32x16_bf16 v[16:31], v[64:67], a[184:187], v[16:31]
    s_waitcnt vmcnt(14)
    s_barrier
    ds_read_b64_tr_b16 v[48:49], v168 offset:0
    ds_read_b64_tr_b16 v[50:51], v169 offset:0
    ds_read_b128 v[80:83], v164 offset:0
    v_mfma_f32_32x32x16_bf16 v[32:47], v[68:71], a[184:187], v[32:47]
    ds_read_b64_tr_b16 v[52:53], v168 offset:2048
    ds_read_b64_tr_b16 v[54:55], v169 offset:2048
    s_add_u32 m0, s63, 32768
    s_add_u32 s62, s64, 229376
    buffer_load_dwordx4 v3, s[28:31], s62 offen offset:0 sc1 lds
    s_waitcnt lgkmcnt(5)
    v_mfma_f32_32x32x16_bf16 v[16:31], v[72:75], a[188:191], v[16:31]
    ds_read_b64_tr_b16 v[56:57], v168 offset:256
    ds_read_b64_tr_b16 v[58:59], v169 offset:256
    ds_read_b128 v[84:87], v165 offset:0
    v_mfma_f32_32x32x16_bf16 v[32:47], v[76:79], a[188:191], v[32:47]
    ds_read_b64_tr_b16 v[60:61], v168 offset:2304
    ds_read_b64_tr_b16 v[62:63], v169 offset:2304
    buffer_load_dwordx4 v3, s[28:31], s62 offen offset:1024 sc1 lds
    s_waitcnt lgkmcnt(5)
    v_mfma_f32_32x32x16_bf16 v[16:31], v[48:51], v[80:83], v[16:31]
    ds_read_b64_tr_b16 v[64:65], v168 offset:4096
    ds_read_b64_tr_b16 v[66:67], v169 offset:4096
    ds_read_b128 v[88:91], v166 offset:0
    v_mfma_f32_32x32x16_bf16 v[32:47], v[52:55], v[80:83], v[32:47]
    ds_read_b64_tr_b16 v[68:69], v168 offset:6144
    ds_read_b64_tr_b16 v[70:71], v169 offset:6144
    s_add_u32 m0, s66, 20480
    s_movk_i32 s101, 3968
    buffer_load_dwordx4 v160, s[92:95], s101 offen offset:0 lds
    s_waitcnt lgkmcnt(5)
    v_mfma_f32_32x32x16_bf16 v[16:31], v[56:59], v[84:87], v[16:31]
    ds_read_b64_tr_b16 v[72:73], v168 offset:4352
    ds_read_b64_tr_b16 v[74:75], v169 offset:4352
    ds_read_b128 v[92:95], v167 offset:0
    v_mfma_f32_32x32x16_bf16 v[32:47], v[60:63], v[84:87], v[32:47]
    ds_read_b64_tr_b16 v[76:77], v168 offset:6400
    ds_read_b64_tr_b16 v[78:79], v169 offset:6400
    buffer_load_dwordx4 v161, s[92:95], s101 offen offset:1024 lds
    s_waitcnt lgkmcnt(5)
    v_mfma_f32_32x32x16_bf16 v[16:31], v[64:67], v[88:91], v[16:31]
    s_waitcnt vmcnt(12)
    s_barrier
    ds_read_b64_tr_b16 v[48:49], v168 offset:8192
    ds_read_b64_tr_b16 v[50:51], v169 offset:8192
    v_mfma_f32_32x32x16_bf16 v[32:47], v[68:71], v[88:91], v[32:47]
    ds_read_b64_tr_b16 v[52:53], v168 offset:10240
    ds_read_b64_tr_b16 v[54:55], v169 offset:10240
    buffer_load_dwordx4 v162, s[92:95], s101 offen offset:2048 lds
    s_waitcnt lgkmcnt(4)
    v_mfma_f32_32x32x16_bf16 v[16:31], v[72:75], v[92:95], v[16:31]
    ds_read_b64_tr_b16 v[56:57], v168 offset:8448
    ds_read_b64_tr_b16 v[58:59], v169 offset:8448
    v_mfma_f32_32x32x16_bf16 v[32:47], v[76:79], v[92:95], v[32:47]
    ds_read_b64_tr_b16 v[60:61], v168 offset:10496
    ds_read_b64_tr_b16 v[62:63], v169 offset:10496
    buffer_load_dwordx4 v163, s[92:95], s101 offen offset:3072 lds
    s_waitcnt lgkmcnt(4)
    v_mfma_f32_32x32x16_bf16 v[16:31], v[48:51], a[192:195], v[16:31]
    ds_read_b64_tr_b16 v[64:65], v168 offset:12288
    ds_read_b64_tr_b16 v[66:67], v169 offset:12288
    v_mfma_f32_32x32x16_bf16 v[32:47], v[52:55], a[192:195], v[32:47]
    ds_read_b64_tr_b16 v[68:69], v168 offset:14336
    ds_read_b64_tr_b16 v[70:71], v169 offset:14336
    s_add_u32 m0, s63, 40960
    s_add_u32 s62, s64, 237568
    buffer_load_dwordx4 v3, s[28:31], s62 offen offset:0 sc1 lds
    s_waitcnt lgkmcnt(4)
    v_mfma_f32_32x32x16_bf16 v[16:31], v[56:59], a[196:199], v[16:31]
    ds_read_b64_tr_b16 v[72:73], v168 offset:12544
    ds_read_b64_tr_b16 v[74:75], v169 offset:12544
    v_mfma_f32_32x32x16_bf16 v[32:47], v[60:63], a[196:199], v[32:47]
    ds_read_b64_tr_b16 v[76:77], v168 offset:14592
    ds_read_b64_tr_b16 v[78:79], v169 offset:14592
    buffer_load_dwordx4 v3, s[28:31], s62 offen offset:1024 sc1 lds
    s_waitcnt lgkmcnt(4)
    v_mfma_f32_32x32x16_bf16 v[16:31], v[64:67], a[200:203], v[16:31]
    s_waitcnt vmcnt(14)
    s_barrier
    ds_read_b64_tr_b16 v[48:49], v168 offset:16384
    ds_read_b64_tr_b16 v[50:51], v169 offset:16384
    ds_read_b128 v[80:83], v164 offset:4096
    v_mfma_f32_32x32x16_bf16 v[32:47], v[68:71], a[200:203], v[32:47]
    ds_read_b64_tr_b16 v[52:53], v168 offset:18432
    ds_read_b64_tr_b16 v[54:55], v169 offset:18432
    s_add_u32 m0, s63, 0
    s_add_u32 s62, s64, 245760
    buffer_load_dwordx4 v3, s[28:31], s62 offen offset:0 sc1 lds
    s_waitcnt lgkmcnt(5)
    v_mfma_f32_32x32x16_bf16 v[16:31], v[72:75], a[204:207], v[16:31]
    ds_read_b64_tr_b16 v[56:57], v168 offset:16640
    ds_read_b64_tr_b16 v[58:59], v169 offset:16640
    ds_read_b128 v[84:87], v165 offset:4096
    v_mfma_f32_32x32x16_bf16 v[32:47], v[76:79], a[204:207], v[32:47]
    ds_read_b64_tr_b16 v[60:61], v168 offset:18688
    ds_read_b64_tr_b16 v[62:63], v169 offset:18688
    buffer_load_dwordx4 v3, s[28:31], s62 offen offset:1024 sc1 lds
    s_waitcnt lgkmcnt(5)
    v_mfma_f32_32x32x16_bf16 v[16:31], v[48:51], v[80:83], v[16:31]
    ds_read_b64_tr_b16 v[64:65], v168 offset:20480
    ds_read_b64_tr_b16 v[66:67], v169 offset:20480
    ds_read_b128 v[88:91], v166 offset:4096
    v_mfma_f32_32x32x16_bf16 v[32:47], v[52:55], v[80:83], v[32:47]
    ds_read_b64_tr_b16 v[68:69], v168 offset:22528
    ds_read_b64_tr_b16 v[70:71], v169 offset:22528
    s_add_u32 m0, s66, 0
    s_mov_b32 s62, 0
    buffer_load_dwordx4 v170, s[96:99], s62 offen offset:0 lds
    s_waitcnt lgkmcnt(5)
    v_mfma_f32_32x32x16_bf16 v[16:31], v[56:59], v[84:87], v[16:31]
    ds_read_b64_tr_b16 v[72:73], v168 offset:20736
    ds_read_b64_tr_b16 v[74:75], v169 offset:20736
    ds_read_b128 v[92:95], v167 offset:4096
    v_mfma_f32_32x32x16_bf16 v[32:47], v[60:63], v[84:87], v[32:47]
    ds_read_b64_tr_b16 v[76:77], v168 offset:22784
    ds_read_b64_tr_b16 v[78:79], v169 offset:22784
    buffer_load_dwordx4 v171, s[96:99], s62 offen offset:1024 lds
    s_waitcnt lgkmcnt(5)
    v_mfma_f32_32x32x16_bf16 v[16:31], v[64:67], v[88:91], v[16:31]
    s_waitcnt vmcnt(12)
    s_barrier
    ds_read_b64_tr_b16 v[48:49], v168 offset:24576
    ds_read_b64_tr_b16 v[50:51], v169 offset:24576
    v_mfma_f32_32x32x16_bf16 v[32:47], v[68:71], v[88:91], v[32:47]
    ds_read_b64_tr_b16 v[52:53], v168 offset:26624
    ds_read_b64_tr_b16 v[54:55], v169 offset:26624
    s_branch L_pg11
    .p2align 12
L_stub11:
    s_setpc_b64 s[70:71]
L_pg11:
    s_add_u32 m0, s66, 2048
    s_mov_b32 s62, 14336
    buffer_load_dwordx4 v170, s[96:99], s62 offen offset:0 lds
    s_waitcnt lgkmcnt(4)
    v_mfma_f32_32x32x16_bf16 v[16:31], v[72:75], v[92:95], v[16:31]
    ds_read_b64_tr_b16 v[56:57], v168 offset:24832
    ds_read_b64_tr_b16 v[58:59], v169 offset:24832
    v_mfma_f32_32x32x16_bf16 v[32:47], v[76:79], v[92:95], v[32:47]
    ds_read_b64_tr_b16 v[60:61], v168 offset:26880
    ds_read_b64_tr_b16 v[62:63], v169 offset:26880
    buffer_load_dwordx4 v171, s[96:99], s62 offen offset:1024 lds
    s_waitcnt lgkmcnt(4)
    v_mfma_f32_32x32x16_bf16 v[16:31], v[48:51], a[208:211], v[16:31]
    ds_read_b64_tr_b16 v[64:65], v168 offset:28672
    ds_read_b64_tr_b16 v[66:67], v169 offset:28672
    v_mfma_f32_32x32x16_bf16 v[32:47], v[52:55], a[208:211], v[32:47]
    ds_read_b64_tr_b16 v[68:69], v168 offset:30720
    ds_read_b64_tr_b16 v[70:71], v169 offset:30720
    s_add_u32 m0, s63, 8192
    s_add_u32 s62, s64, 253952
    buffer_load_dwordx4 v3, s[28:31], s62 offen offset:0 sc1 lds
    s_waitcnt lgkmcnt(4)
    v_mfma_f32_32x32x16_bf16 v[16:31], v[56:59], a[212:215], v[16:31]
    ds_read_b64_tr_b16 v[72:73], v168 offset:28928
    ds_read_b64_tr_b16 v[74:75], v169 offset:28928
    v_mfma_f32_32x32x16_bf16 v[32:47], v[60:63], a[212:215], v[32:47]
    ds_read_b64_tr_b16 v[76:77], v168 offset:30976
    ds_read_b64_tr_b16 v[78:79], v169 offset:30976
    buffer_load_dwordx4 v3, s[28:31], s62 offen offset:1024 sc1 lds
    s_waitcnt lgkmcnt(4)
    v_mfma_f32_32x32x16_bf16 v[16:31], v[64:67], a[216:219], v[16:31]
    s_waitcnt vmcnt(14)
    s_barrier
    ds_read_b64_tr_b16 v[48:49], v168 offset:32768
    ds_read_b64_tr_b16 v[50:51], v169 offset:32768
    ds_read_b128 v[80:83], v164 offset:8192
    v_mfma_f32_32x32x16_bf16 v[32:47], v[68:71], a[216:219], v[32:47]
    ds_read_b64_tr_b16 v[52:53], v168 offset:34816
    ds_read_b64_tr_b16 v[54:55], v169 offset:34816
    s_add_u32 m0, s66, 4096
    s_mov_b32 s62, 28672
    buffer_load_dwordx4 v170, s[96:99], s62 offen offset:0 lds
    s_waitcnt lgkmcnt(5)
    v_mfma_f32_32x32x16_bf16 v[16:31], v[72:75], a[220:223], v[16:31]
    ds_read_b64_tr_b16 v[56:57], v168 offset:33024
    ds_read_b64_tr_b16 v[58:59], v169 offset:33024
    ds_read_b128 v[84:87], v165 offset:8192
    v_mfma_f32_32x32x16_bf16 v[32:47], v[76:79], a[220:223], v[32:47]
    ds_read_b64_tr_b16 v[60:61], v168 offset:35072
    ds_read_b64_tr_b16 v[62:63], v169 offset:35072
    buffer_load_dwordx4 v171, s[96:99], s62 offen offset:1024 lds
    s_waitcnt lgkmcnt(5)
    v_mfma_f32_32x32x16_bf16 v[16:31], v[48:51], v[80:83], v[16:31]
    ds_read_b64_tr_b16 v[64:65], v168 offset:36864
    ds_read_b64_tr_b16 v[66:67], v169 offset:36864
    ds_read_b128 v[88:91], v166 offset:8192
    v_mfma_f32_32x32x16_bf16 v[32:47], v[52:55], v[80:83], v[32:47]
    ds_read_b64_tr_b16 v[68:69], v168 offset:38912
    ds_read_b64_tr_b16 v[70:71], v169 offset:38912
    s_add_u32 m0, s66, 6144
    s_mov_b32 s62, 43008
    buffer_load_dwordx4 v170, s[96:99], s62 offen offset:0 lds
    s_waitcnt lgkmcnt(5)
    v_mfma_f32_32x32x16_bf16 v[16:31], v[56:59], v[84:87], v[16:31]
    ds_read_b64_tr_b16 v[72:73], v168 offset:37120
    ds_read_b64_tr_b16 v[74:75], v169 offset:37120
    ds_read_b128 v[92:95], v167 offset:8192
    v_mfma_f32_32x32x16_bf16 v[32:47], v[60:63], v[84:87], v[32:47]
    ds_read_b64_tr_b16 v[76:77], v168 offset:39168
    ds_read_b64_tr_b16 v[78:79], v169 offset:39168
    buffer_load_dwordx4 v171, s[96:99], s62 offen offset:1024 lds
    s_waitcnt lgkmcnt(5)
    v_mfma_f32_32x32x16_bf16 v[16:31], v[64:67], v[88:91], v[16:31]
    s_waitcnt vmcnt(12)
    s_barrier
    ds_read_b64_tr_b16 v[48:49], v168 offset:40960
    ds_read_b64_tr_b16 v[50:51], v169 offset:40960
    ds_read_b128 v[80:83], v164 offset:12288
    v_mfma_f32_32x32x16_bf16 v[32:47], v[68:71], v[88:91], v[32:47]
    ds_read_b64_tr_b16 v[52:53], v168 offset:43008
    ds_read_b64_tr_b16 v[54:55], v169 offset:43008
    s_waitcnt lgkmcnt(5)
    v_mfma_f32_32x32x16_bf16 v[16:31], v[72:75], v[92:95], v[16:31]
    ds_read_b64_tr_b16 v[56:57], v168 offset:41216
    ds_read_b64_tr_b16 v[58:59], v169 offset:41216
    ds_read_b128 v[84:87], v165 offset:12288
    v_mfma_f32_32x32x16_bf16 v[32:47], v[76:79], v[92:95], v[32:47]
    ds_read_b64_tr_b16 v[60:61], v168 offset:43264
    ds_read_b64_tr_b16 v[62:63], v169 offset:43264
    s_waitcnt lgkmcnt(5)
    v_mfma_f32_32x32x16_bf16 v[16:31], v[48:51], v[80:83], v[16:31]
    ds_read_b64_tr_b16 v[64:65], v168 offset:45056
    ds_read_b64_tr_b16 v[66:67], v169 offset:45056
    ds_read_b128 v[88:91], v166 offset:12288
    v_mfma_f32_32x32x16_bf16 v[32:47], v[52:55], v[80:83], v[32:47]
    ds_read_b64_tr_b16 v[68:69], v168 offset:47104
    ds_read_b64_tr_b16 v[70:71], v169 offset:47104
    s_waitcnt lgkmcnt(5)
    v_mfma_f32_32x32x16_bf16 v[16:31], v[56:59], v[84:87], v[16:31]
    ds_read_b64_tr_b16 v[72:73], v168 offset:45312
    ds_read_b64_tr_b16 v[74:75], v169 offset:45312
    ds_read_b128 v[92:95], v167 offset:12288
    v_mfma_f32_32x32x16_bf16 v[32:47], v[60:63], v[84:87], v[32:47]
    ds_read_b64_tr_b16 v[76:77], v168 offset:47360
    ds_read_b64_tr_b16 v[78:79], v169 offset:47360
    s_waitcnt lgkmcnt(5)
    v_mfma_f32_32x32x16_bf16 v[16:31], v[64:67], v[88:91], v[16:31]
    s_waitcnt vmcnt(10)
    s_barrier
    ds_read_b64_tr_b16 v[48:49], v168 offset:0
    ds_read_b64_tr_b16 v[50:51], v169 offset:0
    ds_read_b128 v[80:83], v164 offset:16384
    v_mfma_f32_32x32x16_bf16 v[32:47], v[68:71], v[88:91], v[32:47]
    ds_read_b64_tr_b16 v[52:53], v168 offset:2048
    ds_read_b64_tr_b16 v[54:55], v169 offset:2048
    s_add_u32 m0, s66, 8192
    s_mov_b32 s62, 57344
    buffer_load_dwordx4 v170, s[96:99], s62 offen offset:0 lds
    s_waitcnt lgkmcnt(5)
    v_mfma_f32_32x32x16_bf16 v[16:31], v[72:75], v[92:95], v[16:31]
    ds_read_b64_tr_b16 v[56:57], v168 offset:256
    ds_read_b64_tr_b16 v[58:59], v169 offset:256
    ds_read_b128 v[84:87], v165 offset:16384
    v_mfma_f32_32x32x16_bf16 v[32:47], v[76:79], v[92:95], v[32:47]
    ds_read_b64_tr_b16 v[60:61], v168 offset:2304
    ds_read_b64_tr_b16 v[62:63], v169 offset:2304
    buffer_load_dwordx4 v171, s[96:99], s62 offen offset:1024 lds
    s_waitcnt lgkmcnt(5)
    v_mfma_f32_32x32x16_bf16 v[16:31], v[48:51], v[80:83], v[16:31]
    ds_read_b64_tr_b16 v[64:65], v168 offset:4096
    ds_read_b64_tr_b16 v[66:67], v169 offset:4096
    ds_read_b128 v[88:91], v166 offset:16384
    v_mfma_f32_32x32x16_bf16 v[32:47], v[52:55], v[80:83], v[32:47]
    ds_read_b64_tr_b16 v[68:69], v168 offset:6144
    ds_read_b64_tr_b16 v[70:71], v169 offset:6144
    s_add_u32 m0, s66, 10240
    s_mov_b32 s62, 71680
    buffer_load_dwordx4 v170, s[96:99], s62 offen offset:0 lds
    s_waitcnt lgkmcnt(5)
    v_mfma_f32_32x32x16_bf16 v[16:31], v[56:59], v[84:87], v[16:31]
    ds_read_b64_tr_b16 v[72:73], v168 offset:4352
    ds_read_b64_tr_b16 v[74:75], v169 offset:4352
    ds_read_b128 v[92:95], v167 offset:16384
    v_mfma_f32_32x32x16_bf16 v[32:47], v[60:63], v[84:87], v[32:47]
    ds_read_b64_tr_b16 v[76:77], v168 offset:6400
    ds_read_b64_tr_b16 v[78:79], v169 offset:6400
    buffer_load_dwordx4 v171, s[96:99], s62 offen offset:1024 lds
    s_waitcnt lgkmcnt(5)
    v_mfma_f32_32x32x16_bf16 v[16:31], v[64:67], v[88:91], v[16:31]
    s_waitcnt vmcnt(8)
    s_barrier
    ds_read_b64_tr_b16 v[48:49], v168 offset:8192
    ds_read_b64_tr_b16 v[50:51], v169 offset:8192
    ds_read_b128 v[80:83], v164 offset:20480
    v_mfma_f32_32x32x16_bf16 v[32:47], v[68:71], v[88:91], v[32:47]
    ds_read_b64_tr_b16 v[52:53], v168 offset:10240
    ds_read_b64_tr_b16 v[54:55], v169 offset:10240
    s_add_u32 m0, s66, 12288
    s_mov_b32 s62, 86016
    buffer_load_dwordx4 v170, s[96:99], s62 offen offset:0 lds
    s_waitcnt lgkmcnt(5)
    v_mfma_f32_32x32x16_bf16 v[16:31], v[72:75], v[92:95], v[16:31]
    ds_read_b64_tr_b16 v[56:57], v168 offset:8448
    ds_read_b64_tr_b16 v[58:59], v169 offset:8448
    ds_read_b128 v[84:87], v165 offset:20480
    v_mfma_f32_32x32x16_bf16 v[32:47], v[76:79], v[92:95], v[32:47]
    ds_read_b64_tr_b16 v[60:61], v168 offset:10496
    ds_read_b64_tr_b16 v[62:63], v169 offset:10496
    buffer_load_dwordx4 v171, s[96:99], s62 offen offset:1024 lds
    s_waitcnt lgkmcnt(5)
    v_mfma_f32_32x32x16_bf16 v[16:31], v[48:51], v[80:83], v[16:31]
    ds_read_b64_tr_b16 v[64:65], v168 offset:12288
    ds_read_b64_tr_b16 v[66:67], v169 offset:12288
    ds_read_b128 v[88:91], v166 offset:20480
    v_mfma_f32_32x32x16_bf16 v[32:47], v[52:55], v[80:83], v[32:47]
    ds_read_b64_tr_b16 v[68:69], v168 offset:14336
    ds_read_b64_tr_b16 v[70:71], v169 offset:14336
    s_add_u32 m0, s66, 14336
    s_mov_b32 s62, 100352
    buffer_load_dwordx4 v170, s[96:99], s62 offen offset:0 lds
    s_waitcnt lgkmcnt(5)
    v_mfma_f32_32x32x16_bf16 v[16:31], v[56:59], v[84:87], v[16:31]
    ds_read_b64_tr_b16 v[72:73], v168 offset:12544
    ds_read_b64_tr_b16 v[74:75], v169 offset:12544
    ds_read_b128 v[92:95], v167 offset:20480
    v_mfma_f32_32x32x16_bf16 v[32:47], v[60:63], v[84:87], v[32:47]
    ds_read_b64_tr_b16 v[76:77], v168 offset:14592
    ds_read_b64_tr_b16 v[78:79], v169 offset:14592
    buffer_load_dwordx4 v171, s[96:99], s62 offen offset:1024 lds
    s_waitcnt lgkmcnt(5)
    v_mfma_f32_32x32x16_bf16 v[16:31], v[64:67], v[88:91], v[16:31]
    v_mfma_f32_32x32x16_bf16 v[32:47], v[68:71], v[88:91], v[32:47]
    s_waitcnt lgkmcnt(0)
    v_mfma_f32_32x32x16_bf16 v[16:31], v[72:75], v[92:95], v[16:31]
    v_mfma_f32_32x32x16_bf16 v[32:47], v[76:79], v[92:95], v[32:47]
    s_mul_i32 s64, s54, 57344
    s_lshl_b32 s63, s44, 12
    s_add_u32 s64, s64, s63
    s_add_u32 s64, s64, 14680064
    s_add_u32 s67, s77, 12288
    s_nop 5
    v_pk_add_f32 v[16:17], v[16:17], v[252:253] op_sel_hi:[1,0]
    v_pk_mul_f32 v[16:17], v[16:17], v[192:193]
    v_pk_add_f32 v[18:19], v[18:19], v[252:253] op_sel_hi:[1,0]
    v_pk_mul_f32 v[18:19], v[18:19], v[194:195]
    v_pk_add_f32 v[20:21], v[20:21], v[252:253] op_sel_hi:[1,0]
    v_pk_mul_f32 v[20:21], v[20:21], v[196:197]
    v_pk_add_f32 v[22:23], v[22:23], v[252:253] op_sel_hi:[1,0]
    v_pk_mul_f32 v[22:23], v[22:23], v[198:199]
    v_pk_add_f32 v[24:25], v[24:25], v[252:253] op_sel_hi:[1,0]
    v_pk_mul_f32 v[24:25], v[24:25], v[200:201]
    v_pk_add_f32 v[26:27], v[26:27], v[252:253] op_sel_hi:[1,0]
    v_pk_mul_f32 v[26:27], v[26:27], v[202:203]
    v_pk_add_f32 v[28:29], v[28:29], v[252:253] op_sel_hi:[1,0]
    v_pk_mul_f32 v[28:29], v[28:29], v[204:205]
    v_pk_add_f32 v[30:31], v[30:31], v[252:253] op_sel_hi:[1,0]
    v_pk_mul_f32 v[30:31], v[30:31], v[206:207]
    v_pk_add_f32 v[32:33], v[32:33], v[252:253] op_sel_hi:[1,0]
    v_pk_mul_f32 v[32:33], v[32:33], v[208:209]
    v_pk_add_f32 v[34:35], v[34:35], v[252:253] op_sel_hi:[1,0]
    v_pk_mul_f32 v[34:35], v[34:35], v[210:211]
    v_pk_add_f32 v[36:37], v[36:37], v[252:253] op_sel_hi:[1,0]
    v_pk_mul_f32 v[36:37], v[36:37], v[212:213]
    v_pk_add_f32 v[38:39], v[38:39], v[252:253] op_sel_hi:[1,0]
    v_pk_mul_f32 v[38:39], v[38:39], v[214:215]
    v_pk_add_f32 v[40:41], v[40:41], v[252:253] op_sel_hi:[1,0]
    v_pk_mul_f32 v[40:41], v[40:41], v[216:217]
    v_pk_add_f32 v[42:43], v[42:43], v[252:253] op_sel_hi:[1,0]
    v_pk_mul_f32 v[42:43], v[42:43], v[218:219]
    v_pk_add_f32 v[44:45], v[44:45], v[252:253] op_sel_hi:[1,0]
    v_pk_mul_f32 v[44:45], v[44:45], v[220:221]
    v_pk_add_f32 v[46:47], v[46:47], v[252:253] op_sel_hi:[1,0]
    v_pk_mul_f32 v[46:47], v[46:47], v[222:223]
    v_cvt_pk_bf16_f32 v48, v16, v17
    v_cvt_pk_bf16_f32 v49, v18, v19
    v_cvt_pk_bf16_f32 v50, v20, v21
    v_cvt_pk_bf16_f32 v51, v22, v23
    v_cvt_pk_bf16_f32 v52, v24, v25
    v_cvt_pk_bf16_f32 v53, v26, v27
    v_cvt_pk_bf16_f32 v54, v28, v29
    v_cvt_pk_bf16_f32 v55, v30, v31
    v_cvt_pk_bf16_f32 v56, v32, v33
    v_cvt_pk_bf16_f32 v57, v34, v35
    v_cvt_pk_bf16_f32 v58, v36, v37
    v_cvt_pk_bf16_f32 v59, v38, v39
    v_cvt_pk_bf16_f32 v60, v40, v41
    v_cvt_pk_bf16_f32 v61, v42, v43
    v_cvt_pk_bf16_f32 v62, v44, v45
    v_cvt_pk_bf16_f32 v63, v46, v47
    buffer_store_dwordx4 v[48:51], v3, s[28:31], s64 offen offset:0 sc1
    buffer_store_dwordx4 v[52:55], v3, s[28:31], s64 offen offset:1024 sc1
    buffer_store_dwordx4 v[56:59], v3, s[28:31], s64 offen offset:2048 sc1
    buffer_store_dwordx4 v[60:63], v3, s[28:31], s64 offen offset:3072 sc1
    s_add_u32 m0, s66, 16384
    s_mov_b32 s62, 114688
    buffer_load_dwordx4 v170, s[96:99], s62 offen offset:0 lds
    buffer_load_dwordx4 v171, s[96:99], s62 offen offset:1024 lds
    s_add_u32 m0, s66, 18432
    s_mov_b32 s62, 129024
    buffer_load_dwordx4 v170, s[96:99], s62 offen offset:0 lds
    buffer_load_dwordx4 v171, s[96:99], s62 offen offset:1024 lds
    s_add_u32 m0, s66, 20480
    s_mov_b32 s62, 143360
    buffer_load_dwordx4 v170, s[96:99], s62 offen offset:0 lds
    buffer_load_dwordx4 v171, s[96:99], s62 offen offset:1024 lds
    s_add_u32 m0, s66, 22528
    s_mov_b32 s62, 157696
    buffer_load_dwordx4 v170, s[96:99], s62 offen offset:0 lds
    buffer_load_dwordx4 v171, s[96:99], s62 offen offset:1024 lds
    s_mul_i32 s62, s56, 49152
    s_add_u32 s62, s62, 57344
    s_lshl_b32 s63, s56, 6
    v_xor_b32 v208, s63, v4
    v_xor_b32 v209, s63, v5
    v_add_u32 v208, s62, v208
    v_add_u32 v209, s62, v209
    s_mul_i32 s62, s56, 8192
    s_add_u32 s62, s62, 16384
    s_lshl_b32 s63, s56, 6
    v_xor_b32 v210, s63, v4
    v_xor_b32 v211, s63, v5
    v_add_u32 v210, s62, v210
    v_add_u32 v211, s62, v211
    s_lshl_b32 s62, s26, 12
    s_add_u32 s62, s62, 0
    v_add_u32 v212, s62, v3
    v_xor_b32 v213, 0x2000, v212
    s_mov_b32 s32, s20
    s_mov_b32 s33, s21
    s_mov_b32 s34, 0x1c0000
    s_mov_b32 s35, 0x20000
    s_mul_i32 s65, s57, 28672
    s_lshl_b32 s63, s55, 7
    s_add_u32 s65, s65, s63
    s_lshl_b32 s63, s56, 6
    s_add_u32 s65, s65, s63
    v_mul_u32_u24 v11, 896, v2
    v_lshl_add_u32 v11, v1, 4, v11
    s_mul_i32 s64, s57, 57344
    s_mul_i32 s63, s56, 28672
    s_add_u32 s64, s64, s63
    s_add_u32 s64, s64, 14680064
    s_lshl_b32 s68, s27, 7
    s_add_u32 s68, s68, 12288
    s_and_b32 s62, s26, 1
    s_lshl_b32 s62, s62, 12
    s_add_u32 s62, s62, 32768
    s_lshl_b32 s63, s56, 2
    v_add_u32 v7, s63, v1
    v_and_b32 v8, 7, v0
    v_xor_b32 v7, v7, v8
    v_lshlrev_b32 v7, 4, v7
    v_lshl_add_u32 v7, v2, 7, v7
    v_add_u32 v216, s62, v7
    v_xor_b32 v217, 32, v216
    s_lshl_b32 s62, s26, 11
    s_add_u32 s62, s62, 32768
    v_add_u32 v218, s62, v3
    v_lshrrev_b32 v7, 3, v0
    v_xor_b32 v8, v8, v7
    v_mul_u32_u24 v7, 896, v7
    v_lshl_add_u32 v219, v8, 4, v7
    v_add_u32 v220, 7168, v219
    s_and_b32 s62, s57, -2
    s_lshl_b32 s62, s62, 1
    s_add_u32 s62, s62, s26
    s_mul_i32 s66, s62, 14336
    s_lshl_b32 s63, s55, 7
    s_add_u32 s66, s66, s63
    v_mov_b32 v8, s46
    v_mov_b32 v9, s47
    s_cmp_eq_u32 s26, 0
    s_waitcnt vmcnt(8)
    s_barrier
    s_cbranch_scc0 L_pub_31
    s_mov_b64 exec, 1
    s_cmp_eq_u32 s48, 1
    s_cbranch_scc1 L_plain_32
    buffer_store_dwordx2 v[8:9], v0, s[28:31], s67 offen sc1
    s_branch L_join_33
L_plain_32:
    buffer_store_dwordx2 v[8:9], v0, s[28:31], s67 offen
L_join_33:
    s_mov_b64 exec, -1
L_pub_31:
    s_lshl_b32 s62, s26, 12
    s_add_u32 m0, s62, 16384
    s_mov_b32 s62, 172032
    buffer_load_dwordx4 v170, s[96:99], s62 offen offset:0 lds
    buffer_load_dwordx4 v171, s[96:99], s62 offen offset:1024 lds
    s_lshl_b32 s62, s26, 12
    s_add_u32 m0, s62, 18432
    s_mov_b32 s62, 186368
    buffer_load_dwordx4 v170, s[96:99], s62 offen offset:0 lds
    buffer_load_dwordx4 v171, s[96:99], s62 offen offset:1024 lds
    s_waitcnt vmcnt(0)
    s_cmp_eq_u32 s26, 0
    s_cbranch_scc0 L_pollskip_34
    v_lshlrev_b32 v7, 3, v0
    s_mov_b64 exec, 0x3fff
    s_mov_b32 s72, 0
L_poll_35:
    buffer_load_dwordx2 v[8:9], v7, s[28:31], s68 offen sc1
    s_add_u32 s72, s72, 1
    s_waitcnt vmcnt(0)
    v_cmp_ne_u64 vcc, s[46:47], v[8:9]
    s_cbranch_vccz L_poll_35_d
    s_cmp_lt_u32 s72, 100000
    s_cbranch_scc1 L_poll_35
L_poll_35_d:
    s_mov_b64 exec, -1
L_pollskip_34:
    s_barrier
    buffer_load_dwordx4 v[16:19], v3, s[28:31], s64 offen offset:0 sc1
    buffer_load_dwordx4 v[20:23], v3, s[28:31], s64 offen offset:1024 sc1
    buffer_load_dwordx4 v[24:27], v3, s[28:31], s64 offen offset:2048 sc1
    buffer_load_dwordx4 v[28:31], v3, s[28:31], s64 offen offset:3072 sc1
    s_add_u32 s64, s64, 4096
    buffer_load_dwordx4 v[32:35], v3, s[28:31], s64 offen offset:0 sc1
    buffer_load_dwordx4 v[36:39], v3, s[28:31], s64 offen offset:1024 sc1
    buffer_load_dwordx4 v[40:43], v3, s[28:31], s64 offen offset:2048 sc1
    buffer_load_dwordx4 v[44:47], v3, s[28:31], s64 offen offset:3072 sc1
    s_add_u32 s64, s64, 4096
    buffer_load_dwordx4 v[48:51], v3, s[28:31], s64 offen offset:0 sc1
    buffer_load_dwordx4 v[52:55], v3, s[28:31], s64 offen offset:1024 sc1
    buffer_load_dwordx4 v[56:59], v3, s[28:31], s64 offen offset:2048 sc1
    ds_read_b64_tr_b16 v[128:129], v208 offset:0
    ds_read_b64_tr_b16 v[130:131], v208 offset:512
    ds_read_b64_tr_b16 v[132:133], v209 offset:0
    ds_read_b64_tr_b16 v[134:135], v209 offset:512
    ds_read_b64_tr_b16 v[136:137], v208 offset:2048
    ds_read_b64_tr_b16 v[138:139], v208 offset:2560
    ds_read_b64_tr_b16 v[140:141], v209 offset:2048
    ds_read_b64_tr_b16 v[142:143], v209 offset:2560
    ds_read_b64_tr_b16 v[144:145], v208 offset:4096
    ds_read_b64_tr_b16 v[146:147], v208 offset:4608
    ds_read_b64_tr_b16 v[148:149], v209 offset:4096
    ds_read_b64_tr_b16 v[150:151], v209 offset:4608
    s_waitcnt vmcnt(10)
    s_waitcnt lgkmcnt(8)
    v_mfma_f32_32x32x16_bf16 v[176:191], v[128:131], v[16:19], 0
    ds_read_b64_tr_b16 v[152:153], v208 offset:6144
    ds_read_b64_tr_b16 v[154:155], v208 offset:6656
    v_mfma_f32_32x32x16_bf16 v[192:207], v[132:135], v[16:19], 0
    ds_read_b64_tr_b16 v[156:157], v209 offset:6144
    ds_read_b64_tr_b16 v[158:159], v209 offset:6656
    buffer_load_dwordx4 v[60:63], v3, s[28:31], s64 offen offset:3072 sc1
    s_waitcnt vmcnt(10)
    s_waitcnt lgkmcnt(8)
    v_mfma_f32_32x32x16_bf16 v[176:191], v[136:139], v[20:23], v[176:191]
    ds_read_b64_tr_b16 v[128:129], v208 offset:8192
    ds_read_b64_tr_b16 v[130:131], v208 offset:8704
    v_mfma_f32_32x32x16_bf16 v[192:207], v[140:143], v[20:23], v[192:207]
    ds_read_b64_tr_b16 v[132:133], v209 offset:8192
    ds_read_b64_tr_b16 v[134:135], v209 offset:8704
    s_add_u32 s64, s64, 4096
    buffer_load_dwordx4 v[64:67], v3, s[28:31], s64 offen offset:0 sc1
    s_waitcnt vmcnt(10)
    s_waitcnt lgkmcnt(8)
    v_mfma_f32_32x32x16_bf16 v[176:191], v[144:147], v[24:27], v[176:191]
    ds_read_b64_tr_b16 v[136:137], v208 offset:10240
    ds_read_b64_tr_b16 v[138:139], v208 offset:10752
    v_mfma_f32_32x32x16_bf16 v[192:207], v[148:151], v[24:27], v[192:207]
    ds_read_b64_tr_b16 v[140:141], v209 offset:10240
    ds_read_b64_tr_b16 v[142:143], v209 offset:10752
    buffer_load_dwordx4 v[68:71], v3, s[28:31], s64 offen offset:1024 sc1
    s_waitcnt vmcnt(10)
    s_waitcnt lgkmcnt(8)
    v_mfma_f32_32x32x16_bf16 v[176:191], v[152:155], v[28:31], v[176:191]
    ds_read_b64_tr_b16 v[144:145], v208 offset:12288
    ds_read_b64_tr_b16 v[146:147], v208 offset:12800
    v_mfma_f32_32x32x16_bf16 v[192:207], v[156:159], v[28:31], v[192:207]
    ds_read_b64_tr_b16 v[148:149], v209 offset:12288
    ds_read_b64_tr_b16 v[150:151], v209 offset:12800
    buffer_load_dwordx4 v[72:75], v3, s[28:31], s64 offen offset:2048 sc1
    s_waitcnt vmcnt(10)
    s_waitcnt lgkmcnt(8)
    v_mfma_f32_32x32x16_bf16 v[176:191], v[128:131], v[32:35], v[176:191]
    ds_read_b64_tr_b16 v[152:153], v208 offset:14336
    ds_read_b64_tr_b16 v[154:155], v208 offset:14848
    v_mfma_f32_32x32x16_bf16 v[192:207], v[132:135], v[32:35], v[192:207]
    ds_read_b64_tr_b16 v[156:157], v209 offset:14336
    ds_read_b64_tr_b16 v[158:159], v209 offset:14848
    buffer_load_dwordx4 v[76:79], v3, s[28:31], s64 offen offset:3072 sc1
    s_waitcnt vmcnt(10)
    s_waitcnt lgkmcnt(8)
    v_mfma_f32_32x32x16_bf16 v[176:191], v[136:139], v[36:39], v[176:191]
    ds_read_b64_tr_b16 v[128:129], v208 offset:16384
    ds_read_b64_tr_b16 v[130:131], v208 offset:16896
    v_mfma_f32_32x32x16_bf16 v[192:207], v[140:143], v[36:39], v[192:207]
    ds_read_b64_tr_b16 v[132:133], v209 offset:16384
    ds_read_b64_tr_b16 v[134:135], v209 offset:16896
    s_add_u32 s64, s64, 4096
    buffer_load_dwordx4 v[80:83], v3, s[28:31], s64 offen offset:0 sc1
    s_waitcnt vmcnt(10)
    s_waitcnt lgkmcnt(8)
    v_mfma_f32_32x32x16_bf16 v[176:191], v[144:147], v[40:43], v[176:191]
    ds_read_b64_tr_b16 v[136:137], v208 offset:18432
    ds_read_b64_tr_b16 v[138:139], v208 offset:18944
    v_mfma_f32_32x32x16_bf16 v[192:207], v[148:151], v[40:43], v[192:207]
    ds_read_b64_tr_b16 v[140:141], v209 offset:18432
    ds_read_b64_tr_b16 v[142:143], v209 offset:18944
    buffer_load_dwordx4 v[84:87], v3, s[28:31], s64 offen offset:1024 sc1
    s_waitcnt vmcnt(10)
    s_waitcnt lgkmcnt(8)
    v_mfma_f32_32x32x16_bf16 v[176:191], v[152:155], v[44:47], v[176:191]
    ds_read_b64_tr_b16 v[144:145], v208 offset:20480
    ds_read_b64_tr_b16 v[146:147], v208 offset:20992
    v_mfma_f32_32x32x16_bf16 v[192:207], v[156:159], v[44:47], v[192:207]
    ds_read_b64_tr_b16 v[148:149], v209 offset:20480
    ds_read_b64_tr_b16 v[150:151], v209 offset:20992
    buffer_load_dwordx4 v[88:91], v3, s[28:31], s64 offen offset:2048 sc1
    s_waitcnt vmcnt(10)
    s_waitcnt lgkmcnt(8)
    v_mfma_f32_32x32x16_bf16 v[176:191], v[128:131], v[48:51], v[176:191]
    ds_read_b64_tr_b16 v[152:153], v208 offset:22528
    ds_read_b64_tr_b16 v[154:155], v208 offset:23040
    v_mfma_f32_32x32x16_bf16 v[192:207], v[132:135], v[48:51], v[192:207]
    ds_read_b64_tr_b16 v[156:157], v209 offset:22528
    ds_read_b64_tr_b16 v[158:159], v209 offset:23040
    buffer_load_dwordx4 v[92:95], v3, s[28:31], s64 offen offset:3072 sc1
    s_waitcnt vmcnt(10)
    s_waitcnt lgkmcnt(8)
    v_mfma_f32_32x32x16_bf16 v[176:191], v[136:139], v[52:55], v[176:191]
    ds_read_b64_tr_b16 v[128:129], v210 offset:0
    ds_read_b64_tr_b16 v[130:131], v210 offset:512
    v_mfma_f32_32x32x16_bf16 v[192:207], v[140:143], v[52:55], v[192:207]
    ds_read_b64_tr_b16 v[132:133], v211 offset:0
    ds_read_b64_tr_b16 v[134:135], v211 offset:512
    s_add_u32 s64, s64, 4096
    buffer_load_dwordx4 v[96:99], v3, s[28:31], s64 offen offset:0 sc1
    s_waitcnt vmcnt(10)
    s_waitcnt lgkmcnt(8)
    v_mfma_f32_32x32x16_bf16 v[176:191], v[144:147], v[56:59], v[176:191]
    ds_read_b64_tr_b16 v[136:137], v210 offset:2048
    ds_read_b64_tr_b16 v[138:139], v210 offset:2560
    v_mfma_f32_32x32x16_bf16 v[192:207], v[148:151], v[56:59], v[192:207]
    ds_read_b64_tr_b16 v[140:141], v211 offset:2048
    ds_read_b64_tr_b16 v[142:143], v211 offset:2560
    buffer_load_dwordx4 v[100:103], v3, s[28:31], s64 offen offset:1024 sc1
    s_waitcnt vmcnt(10)
    s_waitcnt lgkmcnt(8)
    v_mfma_f32_32x32x16_bf16 v[176:191], v[152:155], v[60:63], v[176:191]
    ds_read_b64_tr_b16 v[144:145], v208 offset:24576
    ds_read_b64_tr_b16 v[146:147], v208 offset:25088
    v_mfma_f32_32x32x16_bf16 v[192:207], v[156:159], v[60:63], v[192:207]
    ds_read_b64_tr_b16 v[148:149], v209 offset:24576
    ds_read_b64_tr_b16 v[150:151], v209 offset:25088
    buffer_load_dwordx4 v[104:107], v3, s[28:31], s64 offen offset:2048 sc1
    s_waitcnt vmcnt(10)
    s_waitcnt lgkmcnt(8)
    v_mfma_f32_32x32x16_bf16 v[176:191], v[128:131], v[64:67], v[176:191]
    ds_read_b64_tr_b16 v[152:153], v208 offset:26624
    ds_read_b64_tr_b16 v[154:155], v208 offset:27136
    v_mfma_f32_32x32x16_bf16 v[192:207], v[132:135], v[64:67], v[192:207]
    ds_read_b64_tr_b16 v[156:157], v209 offset:26624
    ds_read_b64_tr_b16 v[158:159], v209 offset:27136
    buffer_load_dwordx4 v[108:111], v3, s[28:31], s64 offen offset:3072 sc1
    s_waitcnt vmcnt(10)
    s_waitcnt lgkmcnt(8)
    v_mfma_f32_32x32x16_bf16 v[176:191], v[136:139], v[68:71], v[176:191]
    ds_read_b64_tr_b16 v[128:129], v208 offset:28672
    ds_read_b64_tr_b16 v[130:131], v208 offset:29184
    v_mfma_f32_32x32x16_bf16 v[192:207], v[140:143], v[68:71], v[192:207]
    ds_read_b64_tr_b16 v[132:133], v209 offset:28672
    ds_read_b64_tr_b16 v[134:135], v209 offset:29184
    s_add_u32 s64, s64, 4096
    buffer_load_dwordx4 v[112:115], v3, s[28:31], s64 offen offset:0 sc1
    s_waitcnt vmcnt(10)
    s_waitcnt lgkmcnt(8)
    v_mfma_f32_32x32x16_bf16 v[176:191], v[144:147], v[72:75], v[176:191]
    ds_read_b64_tr_b16 v[136:137], v208 offset:30720
    ds_read_b64_tr_b16 v[138:139], v208 offset:31232
    v_mfma_f32_32x32x16_bf16 v[192:207], v[148:151], v[72:75], v[192:207]
    ds_read_b64_tr_b16 v[140:141], v209 offset:30720
    ds_read_b64_tr_b16 v[142:143], v209 offset:31232
    buffer_load_dwordx4 v[116:119], v3, s[28:31], s64 offen offset:1024 sc1
    s_waitcnt vmcnt(10)
    s_waitcnt lgkmcnt(8)
    v_mfma_f32_32x32x16_bf16 v[176:191], v[152:155], v[76:79], v[176:191]
    ds_read_b64_tr_b16 v[144:145], v208 offset:32768
    ds_read_b64_tr_b16 v[146:147], v208 offset:33280
    v_mfma_f32_32x32x16_bf16 v[192:207], v[156:159], v[76:79], v[192:207]
    ds_read_b64_tr_b16 v[148:149], v209 offset:32768
    ds_read_b64_tr_b16 v[150:151], v209 offset:33280
    buffer_load_dwordx4 v[120:123], v3, s[28:31], s64 offen offset:2048 sc1
    s_waitcnt vmcnt(10)
    s_waitcnt lgkmcnt(8)
    v_mfma_f32_32x32x16_bf16 v[176:191], v[128:131], v[80:83], v[176:191]
    ds_read_b64_tr_b16 v[152:153], v208 offset:34816
    ds_read_b64_tr_b16 v[154:155], v208 offset:35328
    v_mfma_f32_32x32x16_bf16 v[192:207], v[132:135], v[80:83], v[192:207]
    ds_read_b64_tr_b16 v[156:157], v209 offset:34816
    ds_read_b64_tr_b16 v[158:159], v209 offset:35328
    buffer_load_dwordx4 v[124:127], v3, s[28:31], s64 offen offset:3072 sc1
    s_waitcnt vmcnt(10)
    s_waitcnt lgkmcnt(8)
    v_mfma_f32_32x32x16_bf16 v[176:191], v[136:139], v[84:87], v[176:191]
    ds_read_b64_tr_b16 v[128:129], v208 offset:36864
    ds_read_b64_tr_b16 v[130:131], v208 offset:37376
    v_mfma_f32_32x32x16_bf16 v[192:207], v[140:143], v[84:87], v[192:207]
    ds_read_b64_tr_b16 v[132:133], v209 offset:36864
    ds_read_b64_tr_b16 v[134:135], v209 offset:37376
    s_waitcnt vmcnt(9)
    s_waitcnt lgkmcnt(8)
    v_mfma_f32_32x32x16_bf16 v[176:191], v[144:147], v[88:91], v[176:191]
    ds_read_b64_tr_b16 v[136:137], v208 offset:38912
    ds_read_b64_tr_b16 v[138:139], v208 offset:39424
    v_mfma_f32_32x32x16_bf16 v[192:207], v[148:151], v[88:91], v[192:207]
    ds_read_b64_tr_b16 v[140:141], v209 offset:38912
    ds_read_b64_tr_b16 v[142:143], v209 offset:39424
    s_waitcnt vmcnt(8)
    s_waitcnt lgkmcnt(8)
    v_mfma_f32_32x32x16_bf16 v[176:191], v[152:155], v[92:95], v[176:191]
    ds_read_b64_tr_b16 v[144:145], v208 offset:40960
    ds_read_b64_tr_b16 v[146:147], v208 offset:41472
    v_mfma_f32_32x32x16_bf16 v[192:207], v[156:159], v[92:95], v[192:207]
    ds_read_b64_tr_b16 v[148:149], v209 offset:40960
    ds_read_b64_tr_b16 v[150:151], v209 offset:41472
    s_waitcnt vmcnt(7)
    s_waitcnt lgkmcnt(8)
    v_mfma_f32_32x32x16_bf16 v[176:191], v[128:131], v[96:99], v[176:191]
    ds_read_b64_tr_b16 v[152:153], v208 offset:43008
    ds_read_b64_tr_b16 v[154:155], v208 offset:43520
    v_mfma_f32_32x32x16_bf16 v[192:207], v[132:135], v[96:99], v[192:207]
    ds_read_b64_tr_b16 v[156:157], v209 offset:43008
    s_branch L_pg12
    .p2align 12
L_stub12:
    s_setpc_b64 s[70:71]
L_pg12:
    ds_read_b64_tr_b16 v[158:159], v209 offset:43520
    s_waitcnt vmcnt(6)
    s_waitcnt lgkmcnt(8)
    v_mfma_f32_32x32x16_bf16 v[176:191], v[136:139], v[100:103], v[176:191]
    ds_read_b64_tr_b16 v[128:129], v208 offset:45056
    ds_read_b64_tr_b16 v[130:131], v208 offset:45568
    v_mfma_f32_32x32x16_bf16 v[192:207], v[140:143], v[100:103], v[192:207]
    ds_read_b64_tr_b16 v[132:133], v209 offset:45056
    ds_read_b64_tr_b16 v[134:135], v209 offset:45568
    s_waitcnt vmcnt(5)
    s_waitcnt lgkmcnt(8)
    v_mfma_f32_32x32x16_bf16 v[176:191], v[144:147], v[104:107], v[176:191]
    ds_read_b64_tr_b16 v[136:137], v208 offset:47104
    ds_read_b64_tr_b16 v[138:139], v208 offset:47616
    v_mfma_f32_32x32x16_bf16 v[192:207], v[148:151], v[104:107], v[192:207]
    ds_read_b64_tr_b16 v[140:141], v209 offset:47104
    ds_read_b64_tr_b16 v[142:143], v209 offset:47616
    s_waitcnt vmcnt(4)
    s_waitcnt lgkmcnt(8)
    v_mfma_f32_32x32x16_bf16 v[176:191], v[152:155], v[108:111], v[176:191]
    ds_read_b64_tr_b16 v[144:145], v210 offset:4096
    ds_read_b64_tr_b16 v[146:147], v210 offset:4608
    v_mfma_f32_32x32x16_bf16 v[192:207], v[156:159], v[108:111], v[192:207]
    ds_read_b64_tr_b16 v[148:149], v211 offset:4096
    ds_read_b64_tr_b16 v[150:151], v211 offset:4608
    s_waitcnt vmcnt(3)
    s_waitcnt lgkmcnt(8)
    v_mfma_f32_32x32x16_bf16 v[176:191], v[128:131], v[112:115], v[176:191]
    ds_read_b64_tr_b16 v[152:153], v210 offset:6144
    ds_read_b64_tr_b16 v[154:155], v210 offset:6656
    v_mfma_f32_32x32x16_bf16 v[192:207], v[132:135], v[112:115], v[192:207]
    ds_read_b64_tr_b16 v[156:157], v211 offset:6144
    ds_read_b64_tr_b16 v[158:159], v211 offset:6656
    s_waitcnt vmcnt(2)
    s_waitcnt lgkmcnt(8)
    v_mfma_f32_32x32x16_bf16 v[176:191], v[136:139], v[116:119], v[176:191]
    v_mfma_f32_32x32x16_bf16 v[192:207], v[140:143], v[116:119], v[192:207]
    s_waitcnt vmcnt(1)
    s_waitcnt lgkmcnt(4)
    v_mfma_f32_32x32x16_bf16 v[176:191], v[144:147], v[120:123], v[176:191]
    v_mfma_f32_32x32x16_bf16 v[192:207], v[148:151], v[120:123], v[192:207]
    s_waitcnt vmcnt(0)
    s_waitcnt lgkmcnt(0)
    v_mfma_f32_32x32x16_bf16 v[176:191], v[152:155], v[124:127], v[176:191]
    v_mfma_f32_32x32x16_bf16 v[192:207], v[156:159], v[124:127], v[192:207]
    v_lshlrev_b32 v144, 16, v244
    v_and_b32 v145, 0xffff0000, v244
    v_lshlrev_b32 v146, 16, v245
    v_and_b32 v147, 0xffff0000, v245
    v_lshlrev_b32 v148, 16, v246
    v_and_b32 v149, 0xffff0000, v246
    v_lshlrev_b32 v150, 16, v247
    v_and_b32 v151, 0xffff0000, v247
    v_lshlrev_b32 v152, 16, v248
    v_and_b32 v153, 0xffff0000, v248
    v_lshlrev_b32 v154, 16, v249
    v_and_b32 v155, 0xffff0000, v249
    v_lshlrev_b32 v156, 16, v250
    v_and_b32 v157, 0xffff0000, v250
    v_lshlrev_b32 v158, 16, v251
    v_and_b32 v159, 0xffff0000, v251
    ds_write_b128 v212, v[192:195] offset:0
    ds_write_b128 v212, v[196:199] offset:1024
    ds_write_b128 v212, v[200:203] offset:2048
    ds_write_b128 v212, v[204:207] offset:3072
    v_pk_add_f32 v[176:177], v[176:177], v[144:145]
    v_pk_add_f32 v[178:179], v[178:179], v[146:147]
    v_pk_add_f32 v[180:181], v[180:181], v[148:149]
    v_pk_add_f32 v[182:183], v[182:183], v[150:151]
    v_pk_add_f32 v[184:185], v[184:185], v[152:153]
    v_pk_add_f32 v[186:187], v[186:187], v[154:155]
    v_pk_add_f32 v[188:189], v[188:189], v[156:157]
    v_pk_add_f32 v[190:191], v[190:191], v[158:159]
    s_waitcnt lgkmcnt(0)
    s_barrier
    ds_read_b128 v[128:131], v213 offset:0
    ds_read_b128 v[132:135], v213 offset:1024
    ds_read_b128 v[136:139], v213 offset:2048
    ds_read_b128 v[140:143], v213 offset:3072
    s_waitcnt lgkmcnt(3)
    v_pk_add_f32 v[176:177], v[176:177], v[128:129]
    v_pk_add_f32 v[178:179], v[178:179], v[130:131]
    s_waitcnt lgkmcnt(2)
    v_pk_add_f32 v[180:181], v[180:181], v[132:133]
    v_pk_add_f32 v[182:183], v[182:183], v[134:135]
    s_waitcnt lgkmcnt(1)
    v_pk_add_f32 v[184:185], v[184:185], v[136:137]
    v_pk_add_f32 v[186:187], v[186:187], v[138:139]
    s_waitcnt lgkmcnt(0)
    v_pk_add_f32 v[188:189], v[188:189], v[140:141]
    v_pk_add_f32 v[190:191], v[190:191], v[142:143]
    v_cvt_pk_bf16_f32 v128, v176, v177
    v_cvt_pk_bf16_f32 v129, v178, v179
    v_cvt_pk_bf16_f32 v130, v180, v181
    v_cvt_pk_bf16_f32 v131, v182, v183
    v_cvt_pk_bf16_f32 v132, v184, v185
    v_cvt_pk_bf16_f32 v133, v186, v187
    v_cvt_pk_bf16_f32 v134, v188, v189
    v_cvt_pk_bf16_f32 v135, v190, v191
    ds_write_b128 v216, v[128:131]
    ds_write_b128 v217, v[132:135]
    s_waitcnt lgkmcnt(0)
    s_barrier
    ds_read_b128 v[136:139], v218
    ds_read_b128 v[140:143], v218 offset:1024
    s_waitcnt lgkmcnt(1)
    buffer_store_dwordx4 v[136:139], v219, s[32:35], s66 offen offset:0 sc1
    s_waitcnt lgkmcnt(0)
    buffer_store_dwordx4 v[140:143], v220, s[32:35], s66 offen offset:0 sc1
L_fin:
L_end:
    s_endpgm
L_att_slow:
    s_waitcnt vmcnt(0)
    s_lshr_b32 s62, s44, 1
    s_mul_i32 s66, s62, 229376
    s_and_b32 s62, s44, 1
    s_mul_i32 s62, s62, 1536
    s_add_u32 s66, s66, s62
    s_add_u32 s66, s66, 2097152
    s_mul_i32 s63, s44, 114688
    s_add_u32 s63, s63, 4194304
    v_mul_u32_u24 v7, 448, v1
    v_lshl_add_u32 v7, v6, 4, v7
    v_add_u32 v7, s63, v7
    s_lshl_b32 s62, s76, 10
    s_add_u32 s62, s62, 262144
    v_mov_b32 v8, s62
    v_cmp_lt_u32 vcc, 28, v2
    v_mov_b32 v9, 0x7ff00000
    s_nop 0
    v_cndmask_b32 v8, v8, v9, vcc
    v_mov_b32 v9, 1792
    v_cmp_gt_u32 vcc, 28, v2
    s_nop 1
    v_cndmask_b32 v217, v8, v7, vcc
    v_cndmask_b32 v218, 0, v9, vcc
    s_mov_b32 s67, s66
    v_mov_b32 v10, 0xff800000
    s_mov_b32 s72, 0
L_slow1:
    buffer_load_dwordx4 v[152:155], v3, s[28:31], s67 offen sc1
    buffer_load_dwordx4 v[156:159], v3, s[28:31], s67 offen offset:1024 sc1
    s_add_u32 s67, s67, 3584
    s_waitcnt vmcnt(0)
    v_mfma_f32_32x32x16_bf16 v[112:127], v[152:155], v[40:43], 0
    v_mfma_f32_32x32x16_bf16 v[112:127], v[156:159], v[44:47], v[112:127]
    s_nop 11
    v_max3_f32 v10, v10, v112, v113
    v_max3_f32 v10, v10, v114, v115
    v_max3_f32 v10, v10, v116, v117
    v_max3_f32 v10, v10, v118, v119
    v_max3_f32 v10, v10, v120, v121
    v_max3_f32 v10, v10, v122, v123
    v_max3_f32 v10, v10, v124, v125
    v_max3_f32 v10, v10, v126, v127
    s_add_u32 s72, s72, 1
    s_cmp_lt_u32 s72, 64
    s_cbranch_scc1 L_slow1
    v_mov_b32 v11, v10
    s_nop 1
    v_permlane32_swap_b32 v11, v10
    v_max_f32 v10, v10, v11
    v_mov_b32 v96, 0
    v_mov_b32 v97, 0
    v_mov_b32 v98, 0
    v_mov_b32 v99, 0
    v_mov_b32 v100, 0
    v_mov_b32 v101, 0
    v_mov_b32 v102, 0
    v_mov_b32 v103, 0
    v_mov_b32 v104, 0
    v_mov_b32 v105, 0
    v_mov_b32 v106, 0
    v_mov_b32 v107, 0
    v_mov_b32 v108, 0
    v_mov_b32 v109, 0
    v_mov_b32 v110, 0
    v_mov_b32 v111, 0
    s_mov_b32 s72, 0
L_slow2:
    buffer_load_dwordx4 v[152:155], v3, s[28:31], s66 offen sc1
    buffer_load_dwordx4 v[156:159], v3, s[28:31], s66 offen offset:1024 sc1
    buffer_load_dwordx4 v[160:163], v217, s[28:31], 0 offen sc1
    buffer_load_dwordx4 v[164:167], v217, s[28:31], 0 offen offset:896 sc1
    s_add_u32 s66, s66, 3584
    v_add_u32 v217, v218, v217
    s_waitcnt vmcnt(0)
    v_mfma_f32_32x32x16_bf16 v[112:127], v[152:155], v[40:43], 0
    v_mfma_f32_32x32x16_bf16 v[112:127], v[156:159], v[44:47], v[112:127]
    s_nop 11
    v_sub_f32 v112, v112, v10
    v_sub_f32 v113, v113, v10
    v_sub_f32 v114, v114, v10
    v_sub_f32 v115, v115, v10
    v_sub_f32 v116, v116, v10
    v_sub_f32 v117, v117, v10
    v_sub_f32 v118, v118, v10
    v_sub_f32 v119, v119, v10
    v_sub_f32 v120, v120, v10
    v_sub_f32 v121, v121, v10
    v_sub_f32 v122, v122, v10
    v_sub_f32 v123, v123, v10
    v_sub_f32 v124, v124, v10
    v_sub_f32 v125, v125, v10
    v_sub_f32 v126, v126, v10
    v_sub_f32 v127, v127, v10
    v_exp_f32 v112, v112
    v_exp_f32 v113, v113
    v_exp_f32 v114, v114
    v_exp_f32 v115, v115
    v_exp_f32 v116, v116
    v_exp_f32 v117, v117
    v_exp_f32 v118, v118
    v_exp_f32 v119, v119
    v_exp_f32 v120, v120
    v_exp_f32 v121, v121
    v_exp_f32 v122, v122
    v_exp_f32 v123, v123
    v_exp_f32 v124, v124
    v_exp_f32 v125, v125
    v_exp_f32 v126, v126
    v_exp_f32 v127, v127
    v_cvt_pk_bf16_f32 v144, v112, v113
    v_cvt_pk_bf16_f32 v145, v114, v115
    v_cvt_pk_bf16_f32 v146, v116, v117
    v_cvt_pk_bf16_f32 v147, v118, v119
    v_cvt_pk_bf16_f32 v148, v120, v121
    v_cvt_pk_bf16_f32 v149, v122, v123
    v_cvt_pk_bf16_f32 v150, v124, v125
    v_cvt_pk_bf16_f32 v151, v126, v127
    v_mfma_f32_32x32x16_bf16 v[96:111], v[160:163], v[144:147], v[96:111]
    s_nop 0
    v_mfma_f32_32x32x16_bf16 v[96:111], v[164:167], v[148:151], v[96:111]
    s_add_u32 s72, s72, 1
    s_cmp_lt_u32 s72, 64
    s_cbranch_scc1 L_slow2
    s_nop 8
    v_mov_b32 v7, v108
    v_mov_b32 v8, v108
    s_nop 1
    v_permlane32_swap_b32 v7, v8
    s_branch L_att_ok
L_again_3:
    s_mov_b32 s72, 0
L_again_3_l:
    v_mov_b32 v208, 0
    buffer_load_dwordx2 v[208:209], v208, s[40:43], 0 offen sc1
    s_add_u32 s72, s72, 1
    s_waitcnt vmcnt(0)
    v_cmp_eq_u32 vcc, 0, v209
    s_cbranch_vccz L_have_4
    s_cmp_lt_u32 s72, 100000
    s_cbranch_scc1 L_again_3_l
    s_branch L_have_4
L_again_5:
    s_mov_b32 s72, 0
L_again_5_l:
    buffer_load_dwordx4 v[160:163], v222, s[28:31], s88 offen offset:0 sc1
    buffer_load_dwordx4 v[164:167], v222, s[28:31], s88 offen offset:1024 sc1
    buffer_load_dwordx4 v[168:171], v222, s[28:31], s88 offen offset:2048 sc1
    buffer_load_dwordx4 v[172:175], v223, s[28:31], s88 offen offset:3072 sc1
    s_add_u32 s72, s72, 1
    s_waitcnt vmcnt(0)
    v_cmp_ne_u64 vcc, s[46:47], v[162:163]
    v_cmp_ne_u64 s[62:63], s[46:47], v[166:167]
    v_cmp_ne_u64 s[90:91], s[46:47], v[170:171]
    v_cmp_ne_u64 s[68:69], s[46:47], v[174:175]
    s_nop 0
    s_or_b64 s[62:63], s[62:63], s[90:91]
    s_or_b64 vcc, vcc, s[68:69]
    s_or_b64 vcc, vcc, s[62:63]
    s_cbranch_vccz L_have_6
    s_cmp_lt_u32 s72, 100000
    s_cbranch_scc1 L_again_5_l
    s_branch L_have_6
L_again_7:
    s_mov_b32 s72, 0
L_again_7_l:
    v_mov_b32 v208, 0
    buffer_load_dwordx2 v[208:209], v208, s[40:43], 0 offen sc1
    s_add_u32 s72, s72, 1
    s_waitcnt vmcnt(0)
    v_cmp_eq_u32 vcc, 0, v209
    s_cbranch_vccz L_have_8
    s_cmp_lt_u32 s72, 100000
    s_cbranch_scc1 L_again_7_l
    s_branch L_have_8
L_again_9:
    s_mov_b32 s72, 0
L_again_9_l:
    buffer_load_dwordx4 v[160:163], v222, s[28:31], s88 offen offset:0 sc1
    buffer_load_dwordx4 v[164:167], v222, s[28:31], s88 offen offset:1024 sc1
    buffer_load_dwordx4 v[168:171], v222, s[28:31], s88 offen offset:2048 sc1
    buffer_load_dwordx4 v[172:175], v223, s[28:31], s88 offen offset:3072 sc1
    s_add_u32 s72, s72, 1
    s_waitcnt vmcnt(0)
    v_cmp_ne_u64 vcc, s[46:47], v[162:163]
    v_cmp_ne_u64 s[62:63], s[46:47], v[166:167]
    v_cmp_ne_u64 s[90:91], s[46:47], v[170:171]
    v_cmp_ne_u64 s[68:69], s[46:47], v[174:175]
    s_nop 0
    s_or_b64 s[62:63], s[62:63], s[90:91]
    s_or_b64 vcc, vcc, s[68:69]
    s_or_b64 vcc, vcc, s[62:63]
    s_cbranch_vccz L_have_10
    s_cmp_lt_u32 s72, 100000
    s_cbranch_scc1 L_again_9_l
    s_branch L_have_10
L_code_end:
.section .rodata,"a"
.p2align 6
.amdhsa_kernel sequential_preLN__mha_block__mixer_gmlp__prompt_kernel
  .amdhsa_next_free_vgpr 512
  .amdhsa_next_free_sgpr 102
  .amdhsa_accum_offset 256
  .amdhsa_group_segment_fixed_size 0
  .amdhsa_kernarg_size 88
  .amdhsa_user_sgpr_count 2
  .amdhsa_user_sgpr_kernarg_segment_ptr 1
  .amdhsa_system_sgpr_workgroup_id_x 1
.end_amdhsa_kernel
```
